```python
import torch

def _softmax(x, axis=-1):
    return torch.softmax(x, dim=axis)
def _gelu(x):
    return torch.nn.functional.gelu(x, approximate="tanh")
def _silu(x):
    return torch.nn.functional.silu(x)
def _sigmoid(x):
    return torch.sigmoid(x)
def _layernorm(x, axis=-1, eps=1e-5):
    m = x.mean(dim=axis, keepdim=True)
    v = x.var(dim=axis, keepdim=True, unbiased=False)
    return (x - m) / torch.sqrt(v + eps)
def _scatter_add(tgt, idx, src, axis=0):
    return tgt.clone().index_add_(axis, idx, src)
def _segment_sum(src, seg, n):
    out = torch.zeros((n,) + src.shape[1:], dtype=src.dtype)
    return out.index_add_(0, seg, src)
def _pad(x, pw):
    flat = tuple(v for pair in reversed(pw) for v in pair)
    return torch.nn.functional.pad(x, flat)

kernel_name = 'gated_mix__ssm_conv_h3__glu_gated_swiglu__prompt'

def setup_inputs():

    _w = (lambda a: (lambda t: t.to(torch.bfloat16) if t.is_floating_point() else t)(torch.as_tensor(a)))
    def _A_setup():
        B, S, D = 1, 2048, 640
        ks = 4
        return {
            "q": _w((lambda *s: torch.randn(*s, dtype=torch.bfloat16) * 0.05)(B, S, D)),
            "k": _w((lambda *s: torch.randn(*s, dtype=torch.bfloat16) * 0.2)(B, S, D)),
            "v": _w((lambda *s: torch.randn(*s, dtype=torch.bfloat16) * 0.2)(B, S, D)),
            "shift_k": _w((lambda *s: torch.randn(*s, dtype=torch.bfloat16) * 0.2)(D, ks) * 0.5),
            "ssm_k": _w((lambda *s: torch.randn(*s, dtype=torch.bfloat16) * 0.2)(D, S) * (1.0 / S ** 0.5)),
            "ssm_D": _w((lambda *s: torch.randn(*s, dtype=torch.bfloat16) * 0.2)(D)),
        }
    _A_in = _A_setup()

    def _B_setup():
        B, S, D, F = 1, 2048, 640, 1728
        return {
            "x": _w((lambda *s: torch.randn(*s, dtype=torch.bfloat16) * 0.05)(B, S, D)),
            "w1": _w((lambda *s: torch.randn(*s, dtype=torch.bfloat16) * 0.4)(D, F) * (2.0 / D) ** 0.5),
            "w3": _w((lambda *s: torch.randn(*s, dtype=torch.bfloat16) * 0.4)(D, F) * (2.0 / D) ** 0.5),
            "w2": _w((lambda *s: torch.randn(*s, dtype=torch.bfloat16) * 0.4)(F, D) * (2.0 / F) ** 0.5),
        }
    _B_in = _B_setup()

    return {
        "A_q": _A_in["q"],
        "A_k": _A_in["k"],
        "A_v": _A_in["v"],
        "A_shift_k": _A_in["shift_k"],
        "A_ssm_k": _A_in["ssm_k"],
        "A_ssm_D": _A_in["ssm_D"],
        "B_x": _B_in["x"],
        "B_w1": _B_in["w1"],
        "B_w3": _B_in["w3"],
        "B_w2": _B_in["w2"],
        "gate_w": _w((lambda *s: torch.randn(*s, dtype=torch.bfloat16) * 0.05)(640) * 16.0),
    }

def reference(A_q, A_k, A_v, A_shift_k, A_ssm_k, A_ssm_D, B_x, B_w1, B_w3, B_w2, gate_w):
    def _A_ref(q, k, v, shift_k, ssm_k, ssm_D):
        B, S, D = q.shape
        ks = shift_k.shape[-1]
        k_pad = _pad(k, ((0, 0), (ks - 1, 0), (0, 0)))
        k_shift = torch.zeros_like(k)
        for t in range(ks):
            k_shift = k_shift + k_pad[:, t:t + S, :] * shift_k[:, ks - 1 - t][None, None, :]
        kv = k_shift * v
        L = 2 * S
        kv_pad = _pad(kv, ((0, 0), (0, S), (0, 0)))
        kf_pad = _pad(ssm_k, ((0, 0), (0, S)))
        kv_f = (lambda x, axes=(-2,-1): torch.fft.rfft2(x.float(), dim=axes))(kv_pad[:, None, :, :], axes=(1, 2))
        kf_f = (lambda x, axes=(-2,-1): torch.fft.rfft2(x.float(), dim=axes))(kf_pad[:, None, :], axes=(1, 2))
        kf_f = (lambda x, *d: x.permute(*d))(kf_f, 1, 2, 0)
        y_f = kv_f * kf_f[None, :, :, :]
        y = (lambda x, s, axes=(-2,-1): torch.fft.irfft2(x, s=s, dim=axes).to(torch.bfloat16))(y_f, (1, L), axes=(1, 2))[:, 0, :S, :]
        y = y + kv * ssm_D[None, None, :]
        return q * y

    def _B_ref(x, w1, w3, w2):
        gate = torch.einsum("bsd,df->bsf", x, w1)
        up = torch.einsum("bsd,df->bsf", x, w3)
        h = _silu(gate) * up
        out = torch.einsum("bsf,fd->bsd", h, w2)
        return out

    x = A_q
    g = _sigmoid((x * gate_w).sum(-1, keepdims=True))
    a = _A_ref(x, A_k, A_v, A_shift_k, A_ssm_k, A_ssm_D)
    b = _B_ref(x, B_w1, B_w3, B_w2)
    return g * a + (1 - g) * b
```

```asm
; @launch grid=(256,1,1) block=(256,1,1) lds=163840
.amdgcn_target "amdgcn-amd-amdhsa--gfx950"
.text
.globl gated_mix__ssm_conv_h3__glu_gated_swiglu__prompt_kernel
.p2align 12
.p2align 8
.type gated_mix__ssm_conv_h3__glu_gated_swiglu__prompt_kernel,@function
gated_mix__ssm_conv_h3__glu_gated_swiglu__prompt_kernel:
    s_memrealtime s[56:57]
    s_cmp_ge_u32 s2, 256
    s_cbranch_scc1 Lend
    s_load_dwordx2 s[4:5], s[0:1], 0
    s_load_dwordx2 s[24:25], s[0:1], 8
    s_load_dwordx2 s[28:29], s[0:1], 16
    s_load_dwordx2 s[40:41], s[0:1], 24
    s_load_dwordx2 s[32:33], s[0:1], 32
    s_load_dwordx2 s[52:53], s[0:1], 40
    s_load_dwordx2 s[8:9], s[0:1], 56
    s_load_dwordx2 s[12:13], s[0:1], 64
    s_load_dwordx2 s[16:17], s[0:1], 72
    s_load_dwordx2 s[44:45], s[0:1], 80
    s_load_dwordx2 s[36:37], s[0:1], 88
    s_load_dwordx2 s[48:49], s[0:1], 96
    s_load_dwordx2 s[20:21], s[0:1], 104
    v_lshrrev_b32 v4, 6, v0
    v_and_b32 v1, 63, v0
    v_mov_b32 v16, 0
    v_readfirstlane_b32 s3, v4
    s_and_b32 s92, s2, 7
    s_lshl_b32 s92, s92, 5
    s_lshr_b32 s93, s2, 3
    s_add_u32 s58, s92, s93
    s_lshr_b32 s63, s58, 7
    s_and_b32 s92, s58, 31
    s_bfe_u32 s100, s58, 0x20005
    s_mul_i32 s93, s92, 205
    s_lshr_b32 s93, s93, 10
    s_mul_i32 s94, s93, 5
    s_sub_u32 s94, s92, s94
    s_mul_i32 s95, s100, 5
    s_add_u32 s93, s93, s95
    s_mul_i32 s95, s94, 192
    s_mul_i32 s96, s100, 7
    s_add_u32 s96, s96, s92
    s_sub_u32 s96, s96, 25
    s_lshr_b32 s97, s96, 2
    s_add_u32 s97, s97, 20
    s_and_b32 s98, s96, 3
    s_lshl_b32 s99, s98, 8
    s_add_u32 s96, s96, 20
    s_cmp_lt_u32 s92, 25
    s_cselect_b32 s59, s93, s97
    s_cselect_b32 s60, s94, s98
    s_cselect_b32 s61, s95, s99
    s_cselect_b32 s96, s93, s96
    s_cselect_b32 s89, s94, 4
    s_lshl_b32 s95, s63, 10
    s_add_u32 s61, s61, s95
    s_mul_i32 s95, s63, 48
    s_add_u32 s96, s96, s95
    s_mul_i32 s95, s63, 80
    s_lshl_b32 s97, s59, 2
    s_add_u32 s95, s95, s97
    s_add_u32 s95, s95, s60
    s_cmp_lt_u32 s89, 4
    s_cselect_b32 s62, s95, s96
    s_mov_b32 s6, 2621440
    s_mov_b32 s7, 0x20000
    s_mov_b32 s26, 2621440
    s_mov_b32 s27, 0x20000
    s_mov_b32 s30, 2621440
    s_mov_b32 s31, 0x20000
    s_mov_b32 s42, 5120
    s_mov_b32 s43, 0x20000
    s_mov_b32 s10, 2211840
    s_mov_b32 s11, 0x20000
    s_mov_b32 s14, 2211840
    s_mov_b32 s15, 0x20000
    s_mov_b32 s50, 256
    s_mov_b32 s51, 0x20000
    s_cmp_lt_u32 s89, 4
    s_cbranch_scc0 Lheavy
    s_and_b32 s92, s62, 15
    s_lshl_b32 s92, s92, 7
    s_lshr_b32 s93, s62, 4
    v_lshrrev_b32 v4, 3, v0
    v_lshlrev_b32 v4, 2, v4
    v_add_u32 v4, s92, v4
    v_and_b32 v5, 7, v0
    v_lshlrev_b32 v6, 4, v5
    s_lshl_b32 s94, s93, 7
    v_add_u32 v6, s94, v6
    s_movk_i32 s95, 1280
    v_mad_u32_u24 v112, v4, s95, v6
    v_subrev_u32 v116, 3840, v112
    v_subrev_u32 v117, 2560, v112
    v_subrev_u32 v118, 1280, v112
    v_lshlrev_b32 v119, 6, v5
    s_lshl_b32 s94, s3, 10
    s_add_u32 s94, s94, 159104
    v_add_u32 v119, s94, v119
    s_lshl_b32 s92, s62, 2
    s_add_u32 s92, s92, s3
    s_lshl_b32 s77, s92, 12
    s_mul_i32 s78, s3, 4160
    v_lshlrev_b32 v24, 4, v1
    v_lshrrev_b32 v4, 3, v1
    v_and_b32 v5, 7, v1
    v_lshlrev_b32 v5, 4, v5
    v_and_b32 v6, 1, v4
    v_lshrrev_b32 v7, 1, v4
    v_lshl_add_u32 v8, v7, 4, v6
    s_lshl_b32 s92, s3, 2
    s_add_u32 s92, s92, s61
    v_add_u32 v8, s92, v8
    s_movk_i32 s93, 1280
    v_mad_u32_u24 v17, v8, s93, v5
    v_lshl_add_u32 v8, v7, 2, v6
    s_lshl_b32 s92, s3, 4
    v_add_u32 v8, s92, v8
    s_movk_i32 s93, 3456
    v_mad_u32_u24 v8, v8, s93, v5
    s_lshl_b32 s92, s59, 7
    v_add_u32 v18, s92, v8
    v_add_u32 v127, 6912, v18
    s_mul_i32 s72, s3, 1040
    s_mul_i32 s73, s3, 4256
    v_add_u32 v114, 81920, v17
    v_add_u32 v115, 163840, v17
    s_lshr_b32 s92, s58, 5
    s_lshl_b32 s92, s92, 2
    s_lshr_b32 s64, 0x30858530, s92
    s_and_b32 s64, s64, 15
    s_cmp_ge_u32 s64, 10
    s_cselect_b32 s92, 10, 0
    s_sub_u32 s64, s64, s92
    s_waitcnt lgkmcnt(0)
    s_add_u32 m0, s73, 0
    s_mul_i32 s66, s64, 221184
    buffer_load_dwordx4 v18, s[8:11], s66 offen lds
    s_add_u32 m0, s73, 1056
    s_nop 0
    buffer_load_dwordx4 v127, s[8:11], s66 offen lds
    s_add_u32 m0, s73, 2112
    s_nop 0
    buffer_load_dwordx4 v18, s[12:15], s66 offen lds
    s_add_u32 m0, s73, 3168
    s_nop 0
    buffer_load_dwordx4 v127, s[12:15], s66 offen lds
    s_add_u32 m0, s72, 16960
    s_lshl_b32 s65, s64, 7
    buffer_load_dwordx4 v17, s[4:7], s65 offen offset:0 lds
    s_add_u32 s64, s64, 1
    s_cmp_eq_u32 s64, 10
    s_cselect_b32 s64, 0, s64
    s_add_u32 m0, s72, 18560
    s_nop 0
    buffer_load_dwordx4 v17, s[4:7], s65 offen offset:2560 lds
    s_add_u32 m0, s72, 25280
    s_nop 0
    buffer_load_dwordx4 v114, s[4:7], s65 offen offset:0 lds
    s_add_u32 m0, s72, 26880
    s_nop 0
    buffer_load_dwordx4 v114, s[4:7], s65 offen offset:2560 lds
    s_add_u32 m0, s72, 33600
    s_nop 0
    buffer_load_dwordx4 v115, s[4:7], s65 offen offset:0 lds
    s_add_u32 m0, s72, 35200
    s_nop 0
    buffer_load_dwordx4 v115, s[4:7], s65 offen offset:2560 lds
    s_or_b32 s92, s58, s3
    s_cmp_lg_u32 s92, 0
    s_cbranch_scc1 Lnn1
    s_or_b32 s92, s56, 1
    v_mov_b32 v14, s92
    v_mov_b32 v15, s57
    s_mov_b64 exec, 1
    buffer_store_dwordx2 v[14:15], v16, s[48:51], 0 offen sc1
    s_mov_b64 exec, -1
Lnn1:
    s_and_b32 s93, s58, 31
    s_lshl_b32 s93, s93, 2
    s_add_u32 s93, s93, s3
    s_getpc_b64 s[68:69]
Lpcl:
    s_cmp_ge_u32 s93, 115
    s_cbranch_scc1 Lhdl
    s_lshl_b32 s92, s93, 2
    s_add_u32 s92, s92, Ltab-Lpcl
    s_add_u32 s94, s68, s92
    s_addc_u32 s95, s69, 0
    s_add_u32 s93, s93, 128
    s_mov_b64 exec, 0
    s_setpc_b64 s[94:95]
Lhdl:
    s_branch Llight2
Lheavy:
    v_lshrrev_b32 v4, 3, v1
    v_and_b32 v5, 7, v1
    v_lshlrev_b32 v5, 4, v5
    v_and_b32 v6, 1, v4
    v_lshrrev_b32 v7, 1, v4
    v_lshl_add_u32 v8, v7, 4, v6
    s_lshl_b32 s92, s3, 2
    s_add_u32 s92, s92, s61
    v_add_u32 v8, s92, v8
    s_movk_i32 s93, 1280
    v_mad_u32_u24 v17, v8, s93, v5
    v_lshl_add_u32 v8, v7, 2, v6
    s_lshl_b32 s92, s3, 4
    v_add_u32 v8, s92, v8
    s_movk_i32 s93, 3456
    v_mad_u32_u24 v8, v8, s93, v5
    s_lshl_b32 s92, s59, 7
    v_add_u32 v18, s92, v8
    v_add_u32 v127, 6912, v18
    s_mul_i32 s72, s3, 1040
    s_mul_i32 s73, s3, 4256
    v_add_u32 v114, 81920, v17
    v_add_u32 v115, 163840, v17
    v_add_u32 v126, 245760, v17
    s_lshr_b32 s92, s58, 5
    s_lshl_b32 s92, s92, 2
    s_lshr_b32 s64, 0x30858530, s92
    s_and_b32 s64, s64, 15
    s_add_u32 s64, s64, 1
    s_cmp_ge_u32 s64, 10
    s_cselect_b32 s92, 10, 0
    s_sub_u32 s64, s64, s92
    s_mov_b32 s75, s64
    s_waitcnt lgkmcnt(0)
    s_add_u32 m0, s73, 0
    s_mul_i32 s66, s64, 221184
    buffer_load_dwordx4 v18, s[8:11], s66 offen lds
    s_add_u32 m0, s73, 1056
    s_nop 0
    buffer_load_dwordx4 v127, s[8:11], s66 offen lds
    s_add_u32 m0, s73, 2112
    s_nop 0
    buffer_load_dwordx4 v18, s[12:15], s66 offen lds
    s_add_u32 m0, s73, 3168
    s_nop 0
    buffer_load_dwordx4 v127, s[12:15], s66 offen lds
    s_add_u32 m0, s72, 16960
    s_lshl_b32 s65, s64, 7
    buffer_load_dwordx4 v17, s[4:7], s65 offen offset:0 lds
    s_add_u32 s64, s64, 1
    s_cmp_eq_u32 s64, 10
    s_cselect_b32 s64, 0, s64
    s_add_u32 m0, s72, 18560
    s_nop 0
    buffer_load_dwordx4 v17, s[4:7], s65 offen offset:2560 lds
    s_add_u32 m0, s72, 25280
    s_nop 0
    buffer_load_dwordx4 v114, s[4:7], s65 offen offset:0 lds
    s_add_u32 m0, s72, 26880
    s_nop 0
    buffer_load_dwordx4 v114, s[4:7], s65 offen offset:2560 lds
    s_add_u32 m0, s72, 33600
    s_nop 0
    buffer_load_dwordx4 v115, s[4:7], s65 offen offset:0 lds
    s_add_u32 m0, s72, 35200
    s_nop 0
    buffer_load_dwordx4 v115, s[4:7], s65 offen offset:2560 lds
    s_add_u32 m0, s72, 41920
    s_nop 0
    buffer_load_dwordx4 v126, s[4:7], s65 offen offset:0 lds
    s_add_u32 m0, s72, 43520
    s_nop 0
    buffer_load_dwordx4 v126, s[4:7], s65 offen offset:2560 lds
    s_and_b32 s93, s58, 31
    s_lshl_b32 s93, s93, 2
    s_add_u32 s93, s93, s3
    s_getpc_b64 s[68:69]
Lpch:
    s_cmp_ge_u32 s93, 115
    s_cbranch_scc1 Lhdh
    s_lshl_b32 s92, s93, 2
    s_add_u32 s92, s92, Ltab-Lpch
    s_add_u32 s94, s68, s92
    s_addc_u32 s95, s69, 0
    s_add_u32 s93, s93, 128
    s_mov_b64 exec, 0
    s_setpc_b64 s[94:95]
Lhdh:
    s_branch Lheavy2
Lhret:
    s_mov_b64 exec, -1
    s_setpc_b64 s[68:69]
Ltabl:
    s_branch Lpad6
    s_branch Lpad17
    s_branch Lpad28
    s_branch Lpad39
    s_branch Lpad50
    s_branch Lpad99
    s_branch Lpad107
    s_branch Lhret
Ltabh:
    s_branch Lpad62
    s_branch Lpad73
    s_branch Lpad84
    s_branch Lpad95
    s_branch Lpad107
    s_branch Lhret
    s_branch Lhret
    s_branch Lhret
Ltab:
    s_branch Lpad0
    s_branch Lpad1
    s_branch Lpad2
    s_branch Lpad3
    s_branch Lpad4
    s_branch Lpad5
    s_branch Lpad6
    s_branch Lpad7
    s_branch Lpad8
    s_branch Lpad9
    s_branch Lpad10
    s_branch Lpad11
    s_branch Lpad12
    s_branch Lpad13
    s_branch Lpad14
    s_branch Lpad15
    s_branch Lpad16
    s_branch Lpad17
    s_branch Lpad18
    s_branch Lpad19
    s_branch Lpad20
    s_branch Lpad21
    s_branch Lpad22
    s_branch Lpad23
    s_branch Lpad24
    s_branch Lpad25
    s_branch Lpad26
    s_branch Lpad27
    s_branch Lpad28
    s_branch Lpad29
    s_branch Lpad30
    s_branch Lpad31
    s_branch Lpad32
    s_branch Lpad33
    s_branch Lpad34
    s_branch Lpad35
    s_branch Lpad36
    s_branch Lpad37
    s_branch Lpad38
    s_branch Lpad39
    s_branch Lpad40
    s_branch Lpad41
    s_branch Lpad42
    s_branch Lpad43
    s_branch Lpad44
    s_branch Lpad45
    s_branch Lpad46
    s_branch Lpad47
    s_branch Lpad48
    s_branch Lpad49
    s_branch Lpad50
    s_branch Lpad51
    s_branch Lpad52
    s_branch Lpad53
    s_branch Lpad54
    s_branch Lpad55
    s_branch Lpad56
    s_branch Lpad57
    s_branch Lpad58
    s_branch Lpad59
    s_branch Lpad60
    s_branch Lpad61
    s_branch Lpad62
    s_branch Lpad63
    s_branch Lpad64
    s_branch Lpad65
    s_branch Lpad66
    s_branch Lpad67
    s_branch Lpad68
    s_branch Lpad69
    s_branch Lpad70
    s_branch Lpad71
    s_branch Lpad72
    s_branch Lpad73
    s_branch Lpad74
    s_branch Lpad75
    s_branch Lpad76
    s_branch Lpad77
    s_branch Lpad78
    s_branch Lpad79
    s_branch Lpad80
    s_branch Lpad81
    s_branch Lpad82
    s_branch Lpad83
    s_branch Lpad84
    s_branch Lpad85
    s_branch Lpad86
    s_branch Lpad87
    s_branch Lpad88
    s_branch Lpad89
    s_branch Lpad90
    s_branch Lpad91
    s_branch Lpad92
    s_branch Lpad93
    s_branch Lpad94
    s_branch Lpad95
    s_branch Lpad96
    s_branch Lpad97
    s_branch Lpad98
    s_branch Lpad99
    s_branch Lpad100
    s_branch Lpad101
    s_branch Lpad102
    s_branch Lpad103
    s_branch Lpad104
    s_branch Lpad105
    s_branch Lpad106
    s_branch Lpad107
    s_branch Lpad108
    s_branch Lpad109
    s_branch Lpad110
    s_branch Lpad111
    s_branch Lpad112
    s_branch Lpad113
    s_branch Lpad114
    s_branch Lhret
    s_branch Lhret
    s_branch Lhret
    s_branch Lhret
    s_branch Lhret
Llight2:
Lpad0:
    s_cbranch_execz Lhret
    s_lshl_b32 s92, s3, 10
    s_add_u32 m0, s92, 159104
    s_lshr_b32 s76, s62, 4
    s_lshl_b32 s76, s76, 9
    buffer_load_dwordx4 v24, s[40:43], s76 offen lds
    buffer_load_dwordx4 v[52:55], v112, s[24:27], 0 offen offset:0
    buffer_load_dwordx4 v[56:59], v112, s[24:27], 0 offen offset:1280
    buffer_load_dwordx4 v[40:43], v116, s[24:27], 0 offen
    buffer_load_dwordx4 v[60:63], v112, s[24:27], 0 offen offset:2560
    buffer_load_dwordx4 v[44:47], v117, s[24:27], 0 offen
    buffer_load_dwordx4 v[64:67], v112, s[24:27], 0 offen offset:3840
    buffer_load_dwordx4 v[48:51], v118, s[24:27], 0 offen
    buffer_load_dwordx4 v[68:71], v112, s[28:31], 0 offen offset:0
    buffer_load_dwordx4 v[72:75], v112, s[28:31], 0 offen offset:1280
    buffer_load_dwordx4 v[76:79], v112, s[28:31], 0 offen offset:2560
    buffer_load_dwordx4 v[80:83], v112, s[28:31], 0 offen offset:3840
    s_mov_b32 s34, 2621440
    s_mov_b32 s35, 0x20000
    s_mov_b32 s54, 1280
    s_mov_b32 s55, 0x20000
    s_mov_b32 s18, 2211840
    s_mov_b32 s19, 0x20000
    s_mov_b32 s46, 1280
    s_mov_b32 s47, 0x20000
    s_mov_b32 s38, 2621440
    s_mov_b32 s39, 0x20000
    s_mov_b32 s22, 15204352
    s_mov_b32 s23, 0x20000
    s_add_u32 s92, s62, 384
    s_mul_i32 s93, s92, 6554
    s_lshr_b32 s93, s93, 16
    s_mul_i32 s94, s93, 10
    s_sub_u32 s94, s92, s94
    s_lshl_b32 s79, s94, 2
    s_mul_i32 s91, s93, 5
    s_add_u32 s91, s91, 12416
    s_cmp_lt_u32 s93, 54
    s_cselect_b32 s91, s91, 2080768
    s_lshl_b32 s95, s94, 6
    s_add_u32 s95, s95, s93
    s_lshl_b32 s95, s95, 7
    s_add_u32 s71, s95, 15073280
    s_mul_i32 s67, s93, 40960
    v_lshrrev_b32 v4, 3, v1
    v_mul_u32_u24 v4, 5120, v4
    v_and_b32 v5, 7, v1
    v_lshl_add_u32 v4, v5, 4, v4
    s_lshl_b32 s92, s94, 7
    v_add_u32 v25, s92, v4
    v_bfe_u32 v5, v1, 2, 2
    v_mul_u32_u24 v5, 1056, v5
    v_lshrrev_b32 v6, 4, v1
    v_lshl_add_u32 v5, v6, 7, v5
    v_and_b32 v6, 3, v1
    v_lshl_add_u32 v5, v6, 3, v5
    s_mov_b32 s75, 159104
    v_add_u32 v26, s75, v5
Lpad1:
    s_cbranch_execz Lhret
    v_and_b32 v5, 7, v0
    v_lshrrev_b32 v4, 3, v0
    v_lshl_add_u32 v4, v5, 1, v4
    v_and_b32 v4, 31, v4
    v_lshlrev_b32 v4, 3, v4
    v_lshl_add_u32 v4, v5, 11, v4
    v_add_u32 v125, 125712, v4
    v_lshrrev_b32 v4, 4, v0
    v_and_b32 v5, 15, v0
    v_lshrrev_b32 v6, 7, v0
    v_add_u32 v6, v6, v5
    v_lshlrev_b32 v7, 8, v4
    v_add_u32 v7, 125712, v7
    v_add_u32 v8, 0, v6
    v_and_b32 v8, 15, v8
    v_lshl_add_u32 v120, v8, 4, v7
    v_add_u32 v8, 2, v6
    v_and_b32 v8, 15, v8
    v_lshl_add_u32 v121, v8, 4, v7
    v_add_u32 v8, 4, v6
    v_and_b32 v8, 15, v8
    v_lshl_add_u32 v122, v8, 4, v7
    v_add_u32 v8, 6, v6
    v_and_b32 v8, 15, v8
    v_lshl_add_u32 v123, v8, 4, v7
    s_lshr_b32 s92, s62, 4
    s_lshl_b32 s92, s92, 18
    s_and_b32 s93, s62, 15
    s_lshl_b32 s93, s93, 8
    s_add_u32 s92, s92, s93
    v_lshlrev_b32 v4, 12, v4
    v_lshl_add_u32 v4, v5, 4, v4
    v_add_u32 v124, s92, v4
    s_lshl_b32 s74, s62, 7
    s_add_u32 s74, s74, 12386304
    s_cmp_eq_u32 s3, 0
    s_cselect_b32 s74, s74, 2130706432
    v_bfe_u32 v4, v1, 2, 2
    v_bfe_u32 v5, v1, 1, 1
    v_lshl_add_u32 v4, v5, 2, v4
    v_mul_u32_u24 v4, 1040, v4
    v_and_b32 v5, 1, v1
    v_lshl_add_u32 v4, v5, 7, v4
    v_bfe_u32 v7, v1, 4, 1
    v_lshrrev_b32 v6, 5, v1
    v_lshl_add_u32 v5, v7, 2, v6
    v_lshl_add_u32 v4, v5, 4, v4
    s_lshr_b32 s92, s3, 1
    s_lshl_b32 s92, s92, 9
    s_add_u32 s92, s92, 16960
    v_add_u32 v19, s92, v4
    v_mul_u32_u24 v4, 8512, v7
    v_bfe_u32 v5, v1, 3, 1
    v_mul_u32_u24 v5, 1056, v5
    v_add_u32 v4, v4, v5
    v_bfe_u32 v5, v1, 2, 1
    v_lshl_add_u32 v5, v6, 2, v5
    v_lshl_add_u32 v4, v5, 7, v4
    v_and_b32 v5, 3, v1
    v_lshl_add_u32 v4, v5, 3, v4
    s_and_b32 s92, s3, 1
    s_lshl_b32 s92, s92, 6
    v_add_u32 v20, s92, v4
    v_mov_b32 v21, v19
    v_mov_b32 v22, v20
    s_getpc_b64 s[68:69]
Lq2:
    s_lshl_b32 s92, s3, 2
    s_sub_u32 s92, Lq2-Ltabl-0, s92
Lpad2:
    s_cbranch_execz Lhret
    s_sub_u32 s92, s68, s92
    s_subb_u32 s93, s69, 0
    s_add_u32 s68, s68, Lr2-Lq2
    s_addc_u32 s69, s69, 0
    s_mov_b64 exec, 0
    s_setpc_b64 s[92:93]
Lr2:
    s_getpc_b64 s[68:69]
Lq3:
    s_lshl_b32 s92, s3, 2
    s_sub_u32 s92, Lq3-Ltabl-16, s92
    s_sub_u32 s92, s68, s92
    s_subb_u32 s93, s69, 0
    s_add_u32 s68, s68, Lr3-Lq3
    s_addc_u32 s69, s69, 0
    s_mov_b64 exec, 0
    s_setpc_b64 s[92:93]
Lr3:
    s_mov_b32 s94, 0x05040100
    s_mov_b32 s95, 0x07060302
    s_waitcnt vmcnt(12) lgkmcnt(0)
    s_barrier
    ds_read_b64_tr_b16 a[160:161], v22 offset:0
    ds_read_b64_tr_b16 a[162:163], v22 offset:256
    ds_read_b64_tr_b16 a[164:165], v22 offset:32
    ds_read_b64_tr_b16 a[166:167], v22 offset:288
    ds_read_b64_tr_b16 a[168:169], v22 offset:2112
    ds_read_b64_tr_b16 a[170:171], v22 offset:2368
    ds_read_b64_tr_b16 a[172:173], v22 offset:2144
    ds_read_b64_tr_b16 a[174:175], v22 offset:2400
    ds_read_b128 a[176:179], v21 offset:0
    ds_read_b128 a[180:183], v21 offset:256
    ds_read_b128 a[184:187], v21 offset:8320
    ds_read_b128 a[188:191], v21 offset:8576
    ds_read_b128 a[192:195], v21 offset:16640
    ds_read_b128 a[196:199], v21 offset:16896
    s_waitcnt lgkmcnt(0)
    v_mfma_f32_16x16x32_bf16 v[128:131], a[160:163], a[176:179], 0
    ds_read_b64_tr_b16 a[208:209], v22 offset:4256
    s_waitcnt vmcnt(11)
    v_mfma_f32_16x16x32_bf16 v[132:135], a[164:167], a[176:179], 0
    ds_read_b64_tr_b16 a[210:211], v22 offset:4512
    v_mfma_f32_16x16x32_bf16 v[136:139], a[168:171], a[176:179], 0
    ds_read_b128 v[84:87], v119 offset:0
    v_mfma_f32_16x16x32_bf16 v[140:143], a[172:175], a[176:179], 0
    ds_read_b64_tr_b16 a[212:213], v22 offset:4288
    v_mfma_f32_16x16x32_bf16 v[156:159], a[172:175], a[180:183], 0
    ds_read_b64_tr_b16 a[214:215], v22 offset:4544
    v_mfma_f32_16x16x32_bf16 v[152:155], a[168:171], a[180:183], 0
    ds_read_b128 v[88:91], v119 offset:16
    v_mfma_f32_16x16x32_bf16 v[148:151], a[164:167], a[180:183], 0
    ds_read_b64_tr_b16 a[216:217], v22 offset:6368
    v_mfma_f32_16x16x32_bf16 v[144:147], a[160:163], a[180:183], 0
    ds_read_b64_tr_b16 a[218:219], v22 offset:6624
    v_mfma_f32_16x16x32_bf16 v[160:163], a[160:163], a[184:187], 0
    ds_read_b128 v[92:95], v119 offset:32
    v_mfma_f32_16x16x32_bf16 v[164:167], a[164:167], a[184:187], 0
    ds_read_b64_tr_b16 a[220:221], v22 offset:6400
    v_mfma_f32_16x16x32_bf16 v[168:171], a[168:171], a[184:187], 0
Lpad3:
    s_cbranch_execz Lhret
    ds_read_b64_tr_b16 a[222:223], v22 offset:6656
    v_add_u32 v22, 41904, v20
    v_mfma_f32_16x16x32_bf16 v[172:175], a[172:175], a[184:187], 0
    ds_read_b128 v[96:99], v119 offset:48
    v_mfma_f32_16x16x32_bf16 v[188:191], a[172:175], a[188:191], 0
    ds_read_b128 a[224:227], v21 offset:32
    v_mfma_f32_16x16x32_bf16 v[184:187], a[168:171], a[188:191], 0
    ds_read_b128 a[228:231], v21 offset:288
    v_mfma_f32_16x16x32_bf16 v[180:183], a[164:167], a[188:191], 0
    ds_read_b128 a[232:235], v21 offset:8352
    v_mfma_f32_16x16x32_bf16 v[176:179], a[160:163], a[188:191], 0
    ds_read_b128 a[236:239], v21 offset:8608
    v_mfma_f32_16x16x32_bf16 v[192:195], a[160:163], a[192:195], 0
    ds_read_b128 a[240:243], v21 offset:16672
    v_mfma_f32_16x16x32_bf16 v[196:199], a[164:167], a[192:195], 0
    ds_read_b128 a[244:247], v21 offset:16928
    v_add_u32 v21, 41904, v19
    v_mfma_f32_16x16x32_bf16 v[200:203], a[168:171], a[192:195], 0
    v_mfma_f32_16x16x32_bf16 v[204:207], a[172:175], a[192:195], 0
    v_mfma_f32_16x16x32_bf16 v[220:223], a[172:175], a[196:199], 0
    v_mfma_f32_16x16x32_bf16 v[216:219], a[168:171], a[196:199], 0
    v_mfma_f32_16x16x32_bf16 v[212:215], a[164:167], a[196:199], 0
    v_mfma_f32_16x16x32_bf16 v[208:211], a[160:163], a[196:199], 0
    s_waitcnt vmcnt(0) lgkmcnt(0)
    s_add_u32 m0, s73, 41904
    s_mul_i32 s66, s64, 221184
    buffer_load_dwordx4 v18, s[8:11], s66 offen lds
    v_perm_b32 v224, v40, v44, s94
    v_perm_b32 v225, v44, v48, s94
    v_perm_b32 v226, v48, v52, s94
    v_perm_b32 v227, v52, v56, s94
    v_perm_b32 v228, v56, v60, s94
    v_perm_b32 v229, v60, v64, s94
    v_dot2_f32_bf16 v230, v226, v84, 0
    v_dot2_f32_bf16 v231, v227, v84, 0
    v_dot2_f32_bf16 v232, v228, v84, 0
    s_add_u32 m0, s73, 42960
    s_nop 0
    buffer_load_dwordx4 v127, s[8:11], s66 offen lds
    v_dot2_f32_bf16 v233, v229, v84, 0
    v_dot2_f32_bf16 v230, v224, v85, v230
    v_dot2_f32_bf16 v231, v225, v85, v231
    v_dot2_f32_bf16 v232, v226, v85, v232
    v_dot2_f32_bf16 v233, v227, v85, v233
    v_lshlrev_b32 v234, 16, v68
    v_lshlrev_b32 v235, 16, v72
    v_lshlrev_b32 v236, 16, v76
    v_lshlrev_b32 v237, 16, v80
    s_add_u32 m0, s73, 44016
    s_nop 0
    buffer_load_dwordx4 v18, s[12:15], s66 offen lds
Lpad4:
    s_cbranch_execz Lhret
    v_pk_mul_f32 v[234:235], v[234:235], v[230:231]
    v_pk_mul_f32 v[236:237], v[236:237], v[232:233]
    v_cvt_pk_bf16_f32 v240, v234, v235
    v_cvt_pk_bf16_f32 v241, v236, v237
    ds_write_b64 v125, v[240:241] offset:0
    v_perm_b32 v224, v40, v44, s95
    v_perm_b32 v225, v44, v48, s95
    v_perm_b32 v226, v48, v52, s95
    v_perm_b32 v227, v52, v56, s95
    s_add_u32 m0, s73, 45072
    s_nop 0
    buffer_load_dwordx4 v127, s[12:15], s66 offen lds
    v_perm_b32 v228, v56, v60, s95
    v_perm_b32 v229, v60, v64, s95
    v_dot2_f32_bf16 v230, v226, v86, 0
    v_dot2_f32_bf16 v231, v227, v86, 0
    v_dot2_f32_bf16 v232, v228, v86, 0
    v_dot2_f32_bf16 v233, v229, v86, 0
    v_dot2_f32_bf16 v230, v224, v87, v230
    v_dot2_f32_bf16 v231, v225, v87, v231
    v_dot2_f32_bf16 v232, v226, v87, v232
    s_add_u32 m0, s72, 58864
    s_lshl_b32 s65, s64, 7
    buffer_load_dwordx4 v17, s[4:7], s65 offen offset:0 lds
    v_dot2_f32_bf16 v233, v227, v87, v233
    v_and_b32 v234, 0xffff0000, v68
    v_and_b32 v235, 0xffff0000, v72
    v_and_b32 v236, 0xffff0000, v76
    v_and_b32 v237, 0xffff0000, v80
    v_pk_mul_f32 v[234:235], v[234:235], v[230:231]
    v_pk_mul_f32 v[236:237], v[236:237], v[232:233]
    v_cvt_pk_bf16_f32 v242, v234, v235
    v_cvt_pk_bf16_f32 v243, v236, v237
    s_add_u32 s64, s64, 1
    s_cmp_eq_u32 s64, 10
    s_cselect_b32 s64, 0, s64
    s_add_u32 m0, s72, 60464
    s_nop 0
    buffer_load_dwordx4 v17, s[4:7], s65 offen offset:2560 lds
    ds_write_b64 v125, v[242:243] offset:256
    v_perm_b32 v224, v41, v45, s94
    v_perm_b32 v225, v45, v49, s94
    v_perm_b32 v226, v49, v53, s94
    v_perm_b32 v227, v53, v57, s94
    v_perm_b32 v228, v57, v61, s94
    v_perm_b32 v229, v61, v65, s94
    v_dot2_f32_bf16 v230, v226, v88, 0
    v_dot2_f32_bf16 v231, v227, v88, 0
    s_add_u32 m0, s72, 67184
    s_nop 0
    buffer_load_dwordx4 v114, s[4:7], s65 offen offset:0 lds
Lpad5:
    s_cbranch_execz Lhret
    v_dot2_f32_bf16 v232, v228, v88, 0
    v_dot2_f32_bf16 v233, v229, v88, 0
    v_dot2_f32_bf16 v230, v224, v89, v230
    v_dot2_f32_bf16 v231, v225, v89, v231
    v_dot2_f32_bf16 v232, v226, v89, v232
    v_dot2_f32_bf16 v233, v227, v89, v233
    v_lshlrev_b32 v234, 16, v69
    v_lshlrev_b32 v235, 16, v73
    v_lshlrev_b32 v236, 16, v77
    s_add_u32 m0, s72, 68784
    s_nop 0
    buffer_load_dwordx4 v114, s[4:7], s65 offen offset:2560 lds
Lpad6:
    s_cbranch_execz Lhret
    v_lshlrev_b32 v237, 16, v81
    v_pk_mul_f32 v[234:235], v[234:235], v[230:231]
    v_pk_mul_f32 v[236:237], v[236:237], v[232:233]
    v_cvt_pk_bf16_f32 v240, v234, v235
    v_cvt_pk_bf16_f32 v241, v236, v237
    ds_write_b64 v125, v[240:241] offset:512
    v_perm_b32 v224, v41, v45, s95
    v_perm_b32 v225, v45, v49, s95
    v_perm_b32 v226, v49, v53, s95
    s_add_u32 m0, s72, 75504
    s_nop 0
    buffer_load_dwordx4 v115, s[4:7], s65 offen offset:0 lds
    v_perm_b32 v227, v53, v57, s95
    v_perm_b32 v228, v57, v61, s95
    v_perm_b32 v229, v61, v65, s95
    v_dot2_f32_bf16 v230, v226, v90, 0
    v_dot2_f32_bf16 v231, v227, v90, 0
    v_dot2_f32_bf16 v232, v228, v90, 0
    v_dot2_f32_bf16 v233, v229, v90, 0
    v_dot2_f32_bf16 v230, v224, v91, v230
    v_dot2_f32_bf16 v231, v225, v91, v231
    s_add_u32 m0, s72, 77104
    s_nop 0
    buffer_load_dwordx4 v115, s[4:7], s65 offen offset:2560 lds
    v_dot2_f32_bf16 v232, v226, v91, v232
    v_dot2_f32_bf16 v233, v227, v91, v233
    v_and_b32 v234, 0xffff0000, v69
    v_and_b32 v235, 0xffff0000, v73
    v_and_b32 v236, 0xffff0000, v77
    v_and_b32 v237, 0xffff0000, v81
    v_pk_mul_f32 v[234:235], v[234:235], v[230:231]
    v_pk_mul_f32 v[236:237], v[236:237], v[232:233]
    v_cvt_pk_bf16_f32 v242, v234, v235
    s_add_u32 m0, s73, 83808
    s_mul_i32 s66, s64, 221184
    buffer_load_dwordx4 v18, s[8:11], s66 offen lds
    v_cvt_pk_bf16_f32 v243, v236, v237
    ds_write_b64 v125, v[242:243] offset:768
    v_perm_b32 v224, v42, v46, s94
    v_perm_b32 v225, v46, v50, s94
    v_perm_b32 v226, v50, v54, s94
    v_perm_b32 v227, v54, v58, s94
    v_perm_b32 v228, v58, v62, s94
    v_perm_b32 v229, v62, v66, s94
    v_dot2_f32_bf16 v230, v226, v92, 0
    v_dot2_f32_bf16 v231, v227, v92, 0
    s_add_u32 m0, s73, 84864
    s_nop 0
    buffer_load_dwordx4 v127, s[8:11], s66 offen lds
    v_dot2_f32_bf16 v232, v228, v92, 0
Lpad7:
    s_cbranch_execz Lhret
    v_dot2_f32_bf16 v233, v229, v92, 0
    v_dot2_f32_bf16 v230, v224, v93, v230
    v_dot2_f32_bf16 v231, v225, v93, v231
    v_dot2_f32_bf16 v232, v226, v93, v232
    v_dot2_f32_bf16 v233, v227, v93, v233
    v_lshlrev_b32 v234, 16, v70
    v_lshlrev_b32 v235, 16, v74
    v_lshlrev_b32 v236, 16, v78
    s_add_u32 m0, s73, 85920
    s_nop 0
    buffer_load_dwordx4 v18, s[12:15], s66 offen lds
    v_lshlrev_b32 v237, 16, v82
    v_pk_mul_f32 v[234:235], v[234:235], v[230:231]
    v_pk_mul_f32 v[236:237], v[236:237], v[232:233]
    v_cvt_pk_bf16_f32 v240, v234, v235
    v_cvt_pk_bf16_f32 v241, v236, v237
    ds_write_b64 v125, v[240:241] offset:1024
    v_perm_b32 v224, v42, v46, s95
    v_perm_b32 v225, v46, v50, s95
    v_perm_b32 v226, v50, v54, s95
    v_perm_b32 v227, v54, v58, s95
    s_add_u32 m0, s73, 86976
    s_nop 0
    buffer_load_dwordx4 v127, s[12:15], s66 offen lds
    v_perm_b32 v228, v58, v62, s95
    v_perm_b32 v229, v62, v66, s95
    v_dot2_f32_bf16 v230, v226, v94, 0
    v_dot2_f32_bf16 v231, v227, v94, 0
    v_dot2_f32_bf16 v232, v228, v94, 0
    v_dot2_f32_bf16 v233, v229, v94, 0
    v_dot2_f32_bf16 v230, v224, v95, v230
    v_dot2_f32_bf16 v231, v225, v95, v231
    v_dot2_f32_bf16 v232, v226, v95, v232
    s_add_u32 m0, s72, 100768
    s_lshl_b32 s65, s64, 7
    buffer_load_dwordx4 v17, s[4:7], s65 offen offset:0 lds
    v_dot2_f32_bf16 v233, v227, v95, v233
    v_and_b32 v234, 0xffff0000, v70
    v_and_b32 v235, 0xffff0000, v74
    v_and_b32 v236, 0xffff0000, v78
    v_and_b32 v237, 0xffff0000, v82
    v_pk_mul_f32 v[234:235], v[234:235], v[230:231]
    v_pk_mul_f32 v[236:237], v[236:237], v[232:233]
    v_cvt_pk_bf16_f32 v242, v234, v235
    v_cvt_pk_bf16_f32 v243, v236, v237
    s_add_u32 s64, s64, 1
    s_cmp_eq_u32 s64, 10
    s_cselect_b32 s64, 0, s64
    s_add_u32 m0, s72, 102368
    s_nop 0
    buffer_load_dwordx4 v17, s[4:7], s65 offen offset:2560 lds
    ds_write_b64 v125, v[242:243] offset:1280
    v_perm_b32 v224, v43, v47, s94
Lpad8:
    s_cbranch_execz Lhret
    v_perm_b32 v225, v47, v51, s94
    v_perm_b32 v226, v51, v55, s94
    v_perm_b32 v227, v55, v59, s94
    v_perm_b32 v228, v59, v63, s94
    v_perm_b32 v229, v63, v67, s94
    v_dot2_f32_bf16 v230, v226, v96, 0
    v_dot2_f32_bf16 v231, v227, v96, 0
    v_dot2_f32_bf16 v232, v228, v96, 0
    s_add_u32 m0, s72, 109088
    s_nop 0
    buffer_load_dwordx4 v114, s[4:7], s65 offen offset:0 lds
    v_dot2_f32_bf16 v233, v229, v96, 0
    v_dot2_f32_bf16 v230, v224, v97, v230
    v_dot2_f32_bf16 v231, v225, v97, v231
    v_dot2_f32_bf16 v232, v226, v97, v232
    v_dot2_f32_bf16 v233, v227, v97, v233
    v_lshlrev_b32 v234, 16, v71
    v_lshlrev_b32 v235, 16, v75
    v_lshlrev_b32 v236, 16, v79
    v_lshlrev_b32 v237, 16, v83
    s_add_u32 m0, s72, 110688
    s_nop 0
    buffer_load_dwordx4 v114, s[4:7], s65 offen offset:2560 lds
    v_pk_mul_f32 v[234:235], v[234:235], v[230:231]
    v_pk_mul_f32 v[236:237], v[236:237], v[232:233]
    v_cvt_pk_bf16_f32 v240, v234, v235
    v_cvt_pk_bf16_f32 v241, v236, v237
    ds_write_b64 v125, v[240:241] offset:1536
    v_perm_b32 v224, v43, v47, s95
    v_perm_b32 v225, v47, v51, s95
    v_perm_b32 v226, v51, v55, s95
    v_perm_b32 v227, v55, v59, s95
    v_perm_b32 v228, v59, v63, s95
    s_add_u32 m0, s72, 117408
    s_nop 0
    buffer_load_dwordx4 v115, s[4:7], s65 offen offset:0 lds
    v_perm_b32 v229, v63, v67, s95
    v_dot2_f32_bf16 v230, v226, v98, 0
    v_dot2_f32_bf16 v231, v227, v98, 0
    v_dot2_f32_bf16 v232, v228, v98, 0
    v_dot2_f32_bf16 v233, v229, v98, 0
    v_dot2_f32_bf16 v230, v224, v99, v230
    v_dot2_f32_bf16 v231, v225, v99, v231
    v_dot2_f32_bf16 v232, v226, v99, v232
    v_dot2_f32_bf16 v233, v227, v99, v233
    s_add_u32 m0, s72, 119008
    s_nop 0
    buffer_load_dwordx4 v115, s[4:7], s65 offen offset:2560 lds
    v_and_b32 v234, 0xffff0000, v71
    v_and_b32 v235, 0xffff0000, v75
    v_and_b32 v236, 0xffff0000, v79
    v_and_b32 v237, 0xffff0000, v83
Lpad9:
    s_cbranch_execz Lhret
    v_pk_mul_f32 v[234:235], v[234:235], v[230:231]
    v_pk_mul_f32 v[236:237], v[236:237], v[232:233]
    v_cvt_pk_bf16_f32 v242, v234, v235
    v_cvt_pk_bf16_f32 v243, v236, v237
    ds_write_b64 v125, v[242:243] offset:1792
    s_waitcnt lgkmcnt(0)
    s_waitcnt vmcnt(10)
    s_waitcnt lgkmcnt(8)
    s_barrier
    v_mfma_f32_16x16x32_bf16 v[128:131], a[208:211], a[224:227], v[128:131]
    ds_read_b64_tr_b16 a[160:161], v22 offset:0
    s_add_u32 m0, s73, 0
    s_mul_i32 s66, s64, 221184
    v_mfma_f32_16x16x32_bf16 v[132:135], a[212:215], a[224:227], v[132:135]
    ds_read_b64_tr_b16 a[162:163], v22 offset:256
    buffer_load_dwordx4 v18, s[8:11], s66 offen lds
    v_mfma_f32_16x16x32_bf16 v[136:139], a[216:219], a[224:227], v[136:139]
    s_add_u32 m0, s73, 1056
    s_nop 0
    buffer_load_dwordx4 v127, s[8:11], s66 offen lds
    s_add_u32 m0, s73, 2112
    v_mfma_f32_16x16x32_bf16 v[140:143], a[220:223], a[224:227], v[140:143]
    ds_read_b64_tr_b16 a[164:165], v22 offset:32
    buffer_load_dwordx4 v18, s[12:15], s66 offen lds
    v_mfma_f32_16x16x32_bf16 v[156:159], a[220:223], a[228:231], v[156:159]
    ds_read_b64_tr_b16 a[166:167], v22 offset:288
    s_add_u32 m0, s73, 3168
    v_mfma_f32_16x16x32_bf16 v[152:155], a[216:219], a[228:231], v[152:155]
    buffer_load_dwordx4 v127, s[12:15], s66 offen lds
    s_add_u32 m0, s72, 16960
    s_lshl_b32 s65, s64, 7
    v_mfma_f32_16x16x32_bf16 v[148:151], a[212:215], a[228:231], v[148:151]
    ds_read_b64_tr_b16 a[168:169], v22 offset:2112
    buffer_load_dwordx4 v17, s[4:7], s65 offen offset:0 lds
    v_mfma_f32_16x16x32_bf16 v[144:147], a[208:211], a[228:231], v[144:147]
    ds_read_b64_tr_b16 a[170:171], v22 offset:2368
    v_mfma_f32_16x16x32_bf16 v[160:163], a[208:211], a[232:235], v[160:163]
    s_cmp_lg_u32 s3, 0
    s_cbranch_scc1 Lo10
    s_sub_u32 m0, s75, 0
    s_nop 0
    buffer_load_dwordx4 v25, s[16:19], s67 offen offset:0 lds
    s_sub_u32 m0, s75, 224
    s_nop 0
    buffer_load_dwordx4 v25, s[16:19], s67 offen offset:1280 lds
Lo10:
    v_mfma_f32_16x16x32_bf16 v[164:167], a[212:215], a[232:235], v[164:167]
    ds_read_b64_tr_b16 a[172:173], v22 offset:2144
    v_mfma_f32_16x16x32_bf16 v[168:171], a[216:219], a[232:235], v[168:171]
    ds_read_b64_tr_b16 a[174:175], v22 offset:2400
    v_mfma_f32_16x16x32_bf16 v[172:175], a[220:223], a[232:235], v[172:175]
    s_cmp_lg_u32 s3, 0
    s_cbranch_scc1 Lo11
    s_sub_u32 m0, s75, 448
    s_nop 0
    buffer_load_dwordx4 v25, s[16:19], s67 offen offset:2560 lds
Lpad10:
    s_cbranch_execz Lhret
    s_sub_u32 m0, s75, 672
    s_nop 0
    buffer_load_dwordx4 v25, s[16:19], s67 offen offset:3840 lds
Lo11:
    v_mfma_f32_16x16x32_bf16 v[188:191], a[220:223], a[236:239], v[188:191]
    ds_read_b128 a[176:179], v21 offset:0
    ds_read_b128 v[88:91], v120 offset:0
    ds_read_b128 v[92:95], v121 offset:4096
    v_mfma_f32_16x16x32_bf16 v[184:187], a[216:219], a[236:239], v[184:187]
    ds_read_b128 a[180:183], v21 offset:256
    ds_read_b128 v[96:99], v122 offset:8192
    ds_read_b128 v[100:103], v123 offset:12288
    v_mfma_f32_16x16x32_bf16 v[180:183], a[212:215], a[236:239], v[180:183]
    buffer_load_dwordx2 v[2:3], v16, s[48:51], 0 offen sc1
    v_mfma_f32_16x16x32_bf16 v[176:179], a[208:211], a[236:239], v[176:179]
    ds_read_b128 a[184:187], v21 offset:8320
    s_add_u32 m0, s78, 142496
    s_nop 0
    buffer_load_dwordx4 v24, s[32:35], s77 offen offset:0 lds
    v_mfma_f32_16x16x32_bf16 v[192:195], a[208:211], a[240:243], v[192:195]
    ds_read_b128 a[188:191], v21 offset:8576
    s_add_u32 m0, s78, 142496
    s_nop 0
    buffer_load_dwordx4 v24, s[32:35], s77 offen offset:1024 lds
    v_mfma_f32_16x16x32_bf16 v[196:199], a[212:215], a[240:243], v[196:199]
    s_add_u32 m0, s78, 142496
    s_nop 0
    buffer_load_dwordx4 v24, s[32:35], s77 offen offset:2048 lds
    v_mfma_f32_16x16x32_bf16 v[200:203], a[216:219], a[240:243], v[200:203]
    ds_read_b128 a[192:195], v21 offset:16640
    s_add_u32 m0, s78, 142496
    s_nop 0
    buffer_load_dwordx4 v24, s[32:35], s77 offen offset:3072 lds
    v_mfma_f32_16x16x32_bf16 v[204:207], a[220:223], a[240:243], v[204:207]
    ds_read_b128 a[196:199], v21 offset:16896
    s_lshr_b32 s76, s77, 11
    buffer_load_ushort v31, v16, s[52:55], s76 offen
    s_lshr_b32 s92, s61, 4
    s_lshr_b32 s93, s3, 1
    v_mfma_f32_16x16x32_bf16 v[220:223], a[220:223], a[244:247], v[220:223]
    s_lshl_b32 s93, s93, 1
    s_add_u32 s92, s92, s93
    s_mul_i32 s92, s92, 54
    s_lshl_b32 s93, s59, 1
    s_add_u32 s92, s92, s93
    s_and_b32 s93, s3, 1
    s_add_u32 s92, s92, s93
    s_lshl_b32 s92, s92, 10
    v_mfma_f32_16x16x32_bf16 v[216:219], a[216:219], a[244:247], v[216:219]
    s_add_u32 s92, s92, 5242880
    v_lshlrev_b32 v4, 4, v1
    v_add_u32 v23, s92, v4
    s_mul_i32 s92, s63, 5
    s_add_u32 s92, s92, s60
    s_lshl_b32 s92, s92, 5
    s_add_u32 s92, s92, s59
    s_lshl_b32 s92, s92, 7
    v_mfma_f32_16x16x32_bf16 v[212:215], a[212:215], a[244:247], v[212:215]
    s_add_u32 s92, s92, 12451840
    s_cmp_eq_u32 s3, 0
    s_cselect_b32 s87, s92, 2130706432
Lpad11:
    s_cbranch_execz Lhret
    s_lshr_b32 s83, s58, 3
    s_and_b32 s82, s58, 7
    s_mul_i32 s85, s3, 14
    s_cmp_eq_u32 s3, 3
    s_subb_u32 s85, s85, 0
    v_mfma_f32_16x16x32_bf16 v[208:211], a[208:211], a[244:247], v[208:211]
    s_mul_i32 s86, s3, 5120
    s_mul_i32 s92, s82, 54
    s_add_u32 s92, s92, s85
    s_mul_i32 s92, s92, 5120
    s_add_u32 s80, s92, 12713984
    s_cmp_ge_u32 s3, 2
    s_cselect_b32 s81, 2130706432, s80
    s_mul_i32 s92, s83, 216
    s_add_u32 s92, s92, s85
    s_waitcnt lgkmcnt(0)
    v_mfma_f32_16x16x32_bf16 v[128:131], a[160:163], a[176:179], v[128:131]
    ds_read_b64_tr_b16 a[208:209], v22 offset:4256
    v_mfma_f32_16x16x32_bf16 v[132:135], a[164:167], a[176:179], v[132:135]
    ds_read_b64_tr_b16 a[210:211], v22 offset:4512
    v_mfma_f32_16x16x32_bf16 v[136:139], a[168:171], a[176:179], v[136:139]
    s_add_u32 s64, s64, 1
    s_cmp_eq_u32 s64, 10
    s_cselect_b32 s64, 0, s64
    s_add_u32 m0, s72, 18560
    v_mfma_f32_16x16x32_bf16 v[140:143], a[172:175], a[176:179], v[140:143]
    ds_read_b64_tr_b16 a[212:213], v22 offset:4288
    v_mfma_f32_16x16x32_bf16 v[156:159], a[172:175], a[180:183], v[156:159]
    ds_read_b64_tr_b16 a[214:215], v22 offset:4544
    v_mfma_f32_16x16x32_bf16 v[152:155], a[168:171], a[180:183], v[152:155]
    buffer_load_dwordx4 v17, s[4:7], s65 offen offset:2560 lds
    v_mfma_f32_16x16x32_bf16 v[148:151], a[164:167], a[180:183], v[148:151]
    ds_read_b64_tr_b16 a[216:217], v22 offset:6368
    v_mfma_f32_16x16x32_bf16 v[144:147], a[160:163], a[180:183], v[144:147]
    ds_read_b64_tr_b16 a[218:219], v22 offset:6624
    v_mfma_f32_16x16x32_bf16 v[160:163], a[160:163], a[184:187], v[160:163]
    s_waitcnt lgkmcnt(14)
    s_mov_b32 s76, 0
    buffer_store_dwordx4 v[88:91], v124, s[20:23], s76 offen sc1
    v_mfma_f32_16x16x32_bf16 v[164:167], a[164:167], a[184:187], v[164:167]
    ds_read_b64_tr_b16 a[220:221], v22 offset:6400
    s_lshl_b32 s92, s92, 10
    s_add_u32 s84, s92, 5242880
    v_mfma_f32_16x16x32_bf16 v[168:171], a[168:171], a[184:187], v[168:171]
    ds_read_b64_tr_b16 a[222:223], v22 offset:6656
    v_add_u32 v22, 83808, v20
    s_and_b32 s92, s83, 15
    v_mfma_f32_16x16x32_bf16 v[172:175], a[172:175], a[184:187], v[172:175]
    s_mul_i32 s93, s92, 43
    s_lshr_b32 s93, s93, 7
    s_add_u32 m0, s72, 25280
    v_mfma_f32_16x16x32_bf16 v[188:191], a[172:175], a[188:191], v[188:191]
    ds_read_b128 a[224:227], v21 offset:32
    buffer_load_dwordx4 v114, s[4:7], s65 offen offset:0 lds
    v_mfma_f32_16x16x32_bf16 v[184:187], a[168:171], a[188:191], v[184:187]
    ds_read_b128 a[228:231], v21 offset:288
    s_min_u32 s93, s93, 4
    s_lshr_b32 s92, s92, 2
Lpad12:
    s_cbranch_execz Lhret
    s_lshr_b32 s94, s83, 4
    v_mfma_f32_16x16x32_bf16 v[180:183], a[164:167], a[188:191], v[180:183]
    s_mul_i32 s94, s94, 5
    s_add_u32 s92, s92, s94
    s_add_u32 s93, s93, s94
    s_add_u32 m0, s72, 26880
    v_mfma_f32_16x16x32_bf16 v[176:179], a[160:163], a[188:191], v[176:179]
    ds_read_b128 a[232:235], v21 offset:8352
    buffer_load_dwordx4 v114, s[4:7], s65 offen offset:2560 lds
    v_mfma_f32_16x16x32_bf16 v[192:195], a[160:163], a[192:195], v[192:195]
    ds_read_b128 a[236:239], v21 offset:8608
    v_and_b32 v8, 31, v1
    v_min_u32 v7, 26, v8
    v_mfma_f32_16x16x32_bf16 v[196:199], a[164:167], a[192:195], v[196:199]
    v_cmp_gt_u32 vcc, 20, v7
    v_mov_b32 v4, s92
    v_mov_b32 v5, s93
    v_cndmask_b32 v6, v4, v5, vcc
    v_lshl_add_u32 v7, v6, 5, v7
    v_mfma_f32_16x16x32_bf16 v[200:203], a[168:171], a[192:195], v[200:203]
    ds_read_b128 a[240:243], v21 offset:16672
    v_lshlrev_b32 v7, 7, v7
    v_add_u32 v32, 12451840, v7
    s_add_u32 m0, s72, 33600
    v_mfma_f32_16x16x32_bf16 v[204:207], a[172:175], a[192:195], v[204:207]
    ds_read_b128 a[244:247], v21 offset:16928
    v_add_u32 v21, 83808, v19
    v_mfma_f32_16x16x32_bf16 v[220:223], a[172:175], a[196:199], v[220:223]
    buffer_load_dwordx4 v115, s[4:7], s65 offen offset:0 lds
    s_lshl_b32 s92, s83, 3
    v_and_b32 v9, 7, v1
    v_add_u32 v9, s92, v9
    v_mfma_f32_16x16x32_bf16 v[216:219], a[168:171], a[196:199], v[216:219]
    v_lshlrev_b32 v9, 7, v9
    v_add_u32 v9, 12517376, v9
    s_mul_i32 s92, s82, 80
    s_add_u32 m0, s72, 35200
    v_mfma_f32_16x16x32_bf16 v[212:215], a[164:167], a[196:199], v[212:215]
    buffer_load_dwordx4 v115, s[4:7], s65 offen offset:2560 lds
    s_mul_i32 s93, s3, 20
    s_add_u32 s92, s92, s93
    v_min_u32 v5, 19, v8
    v_add_u32 v5, s92, v5
    v_lshlrev_b32 v5, 7, v5
    v_mfma_f32_16x16x32_bf16 v[208:211], a[160:163], a[196:199], v[208:211]
    v_cmp_lt_u32 vcc, 31, v1
    v_add_u32 v5, 14942208, v5
    s_lshl_b32 s92, s92, 12
    v_cndmask_b32 v38, v5, v9, vcc
    s_lshl_b32 s93, s83, 7
    s_add_u32 s92, s92, s93
    s_add_u32 s90, s92, 2621440
    s_waitcnt lgkmcnt(15)
    s_waitcnt vmcnt(17)
    s_waitcnt lgkmcnt(0)
    s_barrier
    v_mfma_f32_16x16x32_bf16 v[128:131], a[208:211], a[224:227], v[128:131]
    ds_read_b64_tr_b16 a[160:161], v22 offset:0
    v_mfma_f32_16x16x32_bf16 v[132:135], a[212:215], a[224:227], v[132:135]
    ds_read_b64_tr_b16 a[162:163], v22 offset:256
    v_mfma_f32_16x16x32_bf16 v[136:139], a[216:219], a[224:227], v[136:139]
    s_add_u32 m0, s73, 41904
Lpad13:
    s_cbranch_execz Lhret
    s_mul_i32 s66, s64, 221184
    v_mfma_f32_16x16x32_bf16 v[140:143], a[220:223], a[224:227], v[140:143]
    ds_read_b64_tr_b16 a[164:165], v22 offset:32
    v_mfma_f32_16x16x32_bf16 v[156:159], a[220:223], a[228:231], v[156:159]
    ds_read_b64_tr_b16 a[166:167], v22 offset:288
    v_mfma_f32_16x16x32_bf16 v[152:155], a[216:219], a[228:231], v[152:155]
    buffer_load_dwordx4 v18, s[8:11], s66 offen lds
    v_mfma_f32_16x16x32_bf16 v[148:151], a[212:215], a[228:231], v[148:151]
    ds_read_b64_tr_b16 a[168:169], v22 offset:2112
    v_mfma_f32_16x16x32_bf16 v[144:147], a[208:211], a[228:231], v[144:147]
    ds_read_b64_tr_b16 a[170:171], v22 offset:2368
    v_mfma_f32_16x16x32_bf16 v[160:163], a[208:211], a[232:235], v[160:163]
    s_waitcnt lgkmcnt(15)
    s_mov_b32 s76, 65536
    buffer_store_dwordx4 v[92:95], v124, s[20:23], s76 offen sc1
    v_mfma_f32_16x16x32_bf16 v[164:167], a[212:215], a[232:235], v[164:167]
    ds_read_b64_tr_b16 a[172:173], v22 offset:2144
    v_lshlrev_b32 v24, 4, v1
    v_and_b32 v4, 15, v1
    v_mfma_f32_16x16x32_bf16 v[168:171], a[216:219], a[232:235], v[168:171]
    ds_read_b64_tr_b16 a[174:175], v22 offset:2400
    v_lshrrev_b32 v6, 4, v1
    v_add_u32 v33, s86, v24
    v_mfma_f32_16x16x32_bf16 v[172:175], a[220:223], a[232:235], v[172:175]
    s_mul_i32 s92, s82, 5
    s_add_u32 m0, s73, 42960
    v_mfma_f32_16x16x32_bf16 v[188:191], a[220:223], a[236:239], v[188:191]
    ds_read_b128 a[176:179], v21 offset:0
    v_mfma_f32_16x16x32_bf16 v[184:187], a[216:219], a[236:239], v[184:187]
    ds_read_b128 a[180:183], v21 offset:256
    buffer_load_dwordx4 v127, s[8:11], s66 offen lds
    v_mfma_f32_16x16x32_bf16 v[180:183], a[212:215], a[236:239], v[180:183]
    v_and_b32 v5, 1, v6
    v_lshlrev_b32 v5, 2, v5
    v_add_u32 v5, s92, v5
    v_lshrrev_b32 v5, 2, v5
    v_min_u32 v7, 13, v4
    v_mfma_f32_16x16x32_bf16 v[176:179], a[208:211], a[236:239], v[176:179]
    ds_read_b128 a[184:187], v21 offset:8320
    v_add_u32 v7, s85, v7
    s_add_u32 m0, s73, 44016
    v_mfma_f32_16x16x32_bf16 v[192:195], a[208:211], a[240:243], v[192:195]
    ds_read_b128 a[188:191], v21 offset:8576
    buffer_load_dwordx4 v18, s[12:15], s66 offen lds
    v_mfma_f32_16x16x32_bf16 v[196:199], a[212:215], a[240:243], v[196:199]
    v_min_u32 v7, 53, v7
    v_lshl_add_u32 v5, v5, 6, v7
    v_lshlrev_b32 v5, 7, v5
    v_add_u32 v35, 15073280, v5
    s_lshl_b32 s92, s62, 2
    v_mfma_f32_16x16x32_bf16 v[200:203], a[216:219], a[240:243], v[200:203]
    ds_read_b128 a[192:195], v21 offset:16640
    s_add_u32 s92, s92, s3
    s_add_u32 m0, s73, 45072
    v_mfma_f32_16x16x32_bf16 v[204:207], a[220:223], a[240:243], v[204:207]
    ds_read_b128 a[196:199], v21 offset:16896
Lpad14:
    s_cbranch_execz Lhret
    buffer_load_dwordx4 v127, s[12:15], s66 offen lds
    v_mfma_f32_16x16x32_bf16 v[220:223], a[220:223], a[244:247], v[220:223]
    s_lshl_b32 s77, s92, 12
    s_lshl_b32 s92, s92, 7
    s_add_u32 s88, s92, 14942208
    s_mul_i32 s78, s3, 4160
    s_mov_b32 s92, 79872
    v_mfma_f32_16x16x32_bf16 v[216:219], a[216:219], a[244:247], v[216:219]
    s_cmp_eq_u32 s3, 1
    s_cselect_b32 s92, 75264, s92
    s_add_u32 m0, s72, 58864
    s_lshl_b32 s65, s64, 7
    v_mfma_f32_16x16x32_bf16 v[212:215], a[212:215], a[244:247], v[212:215]
    buffer_load_dwordx4 v17, s[4:7], s65 offen offset:0 lds
    s_cmp_eq_u32 s3, 2
    s_cselect_b32 s92, 118624, s92
    s_cmp_eq_u32 s3, 3
    s_cselect_b32 s92, 159104, s92
    v_mfma_f32_16x16x32_bf16 v[208:211], a[208:211], a[244:247], v[208:211]
    v_add_u32 v30, s92, v24
    v_bfe_u32 v5, v1, 3, 1
    v_mul_u32_u24 v5, 16704, v5
    v_bfe_u32 v7, v1, 2, 1
    v_mul_u32_u24 v7, 83840, v7
    v_add_u32 v5, v5, v7
    v_lshlrev_b32 v7, 4, v6
    s_waitcnt lgkmcnt(0)
    v_mfma_f32_16x16x32_bf16 v[128:131], a[160:163], a[176:179], v[128:131]
    ds_read_b64_tr_b16 a[208:209], v22 offset:4256
    v_mfma_f32_16x16x32_bf16 v[132:135], a[164:167], a[176:179], v[132:135]
    ds_read_b64_tr_b16 a[210:211], v22 offset:4512
    v_mfma_f32_16x16x32_bf16 v[136:139], a[168:171], a[176:179], v[136:139]
    s_add_u32 s64, s64, 1
    s_cmp_eq_u32 s64, 10
    s_cselect_b32 s64, 0, s64
    s_add_u32 m0, s72, 60464
    v_mfma_f32_16x16x32_bf16 v[140:143], a[172:175], a[176:179], v[140:143]
    ds_read_b64_tr_b16 a[212:213], v22 offset:4288
    v_mfma_f32_16x16x32_bf16 v[156:159], a[172:175], a[180:183], v[156:159]
    ds_read_b64_tr_b16 a[214:215], v22 offset:4544
    buffer_load_dwordx4 v17, s[4:7], s65 offen offset:2560 lds
    v_mfma_f32_16x16x32_bf16 v[152:155], a[168:171], a[180:183], v[152:155]
    s_waitcnt lgkmcnt(15)
    s_mov_b32 s76, 131072
    buffer_store_dwordx4 v[96:99], v124, s[20:23], s76 offen sc1
    v_mfma_f32_16x16x32_bf16 v[148:151], a[164:167], a[180:183], v[148:151]
    ds_read_b64_tr_b16 a[216:217], v22 offset:6368
    v_add_u32 v5, v5, v7
    v_and_b32 v8, 3, v1
    v_lshlrev_b32 v8, 3, v8
    v_mfma_f32_16x16x32_bf16 v[144:147], a[160:163], a[180:183], v[144:147]
    ds_read_b64_tr_b16 a[218:219], v22 offset:6624
    v_sub_u32 v5, v8, v5
    s_add_u32 s93, s78, 142520
    v_add_u32 v27, s93, v5
    v_mfma_f32_16x16x32_bf16 v[160:163], a[160:163], a[184:187], v[160:163]
    s_add_u32 m0, s72, 67184
Lpad15:
    s_cbranch_execz Lhret
    s_nop 0
    buffer_load_dwordx4 v114, s[4:7], s65 offen offset:0 lds
    v_lshl_add_u32 v7, v4, 5, v7
    v_mfma_f32_16x16x32_bf16 v[164:167], a[164:167], a[184:187], v[164:167]
    ds_read_b64_tr_b16 a[220:221], v22 offset:6400
    s_add_u32 s93, s92, 32
    v_add_u32 v28, s93, v7
    v_lshlrev_b32 v8, 5, v4
    v_mfma_f32_16x16x32_bf16 v[168:171], a[168:171], a[184:187], v[168:171]
    ds_read_b64_tr_b16 a[222:223], v22 offset:6656
    v_add_u32 v22, 0, v20
    v_lshl_add_u32 v8, v6, 3, v8
    s_add_u32 s93, s92, 512
    v_mfma_f32_16x16x32_bf16 v[172:175], a[172:175], a[184:187], v[172:175]
    v_add_u32 v29, s93, v8
    s_add_u32 m0, s72, 68784
    s_nop 0
    buffer_load_dwordx4 v114, s[4:7], s65 offen offset:2560 lds
    v_mfma_f32_16x16x32_bf16 v[188:191], a[172:175], a[188:191], v[188:191]
    ds_read_b128 a[224:227], v21 offset:32
    s_lshr_b32 s92, s62, 4
    s_lshl_b32 s92, s92, 11
    s_add_u32 s92, s92, 12386304
    v_mfma_f32_16x16x32_bf16 v[184:187], a[168:171], a[188:191], v[184:187]
    ds_read_b128 a[228:231], v21 offset:288
    v_lshlrev_b32 v5, 7, v4
    v_mfma_f32_16x16x32_bf16 v[180:183], a[164:167], a[188:191], v[180:183]
    v_cmp_lt_u32 vcc, 31, v1
    v_add_u32 v5, s92, v5
    s_nop 0
    v_cndmask_b32 v35, v35, v5, vcc
    s_add_u32 s92, s78, 125760
    v_mfma_f32_16x16x32_bf16 v[176:179], a[160:163], a[188:191], v[176:179]
    ds_read_b128 a[232:235], v21 offset:8352
    v_add_u32 v9, s92, v24
    s_add_u32 m0, s72, 75504
    v_mfma_f32_16x16x32_bf16 v[192:195], a[160:163], a[192:195], v[192:195]
    ds_read_b128 a[236:239], v21 offset:8608
    buffer_load_dwordx4 v115, s[4:7], s65 offen offset:0 lds
    v_mfma_f32_16x16x32_bf16 v[196:199], a[164:167], a[192:195], v[196:199]
    v_subrev_u32 v13, 83840, v9
    v_mov_b32 v248, 0
    v_mov_b32 v249, 0
    v_mov_b32 v250, 0
    v_mov_b32 v251, 0
    v_mfma_f32_16x16x32_bf16 v[200:203], a[168:171], a[192:195], v[200:203]
    ds_read_b128 a[240:243], v21 offset:16672
    v_lshrrev_b32 v4, 4, v1
    v_lshl_add_u32 v4, v4, 4, v27
    s_add_u32 m0, s72, 77104
    v_mfma_f32_16x16x32_bf16 v[204:207], a[172:175], a[192:195], v[204:207]
    ds_read_b128 a[244:247], v21 offset:16928
    v_add_u32 v21, 0, v19
    buffer_load_dwordx4 v115, s[4:7], s65 offen offset:2560 lds
    v_mfma_f32_16x16x32_bf16 v[220:223], a[172:175], a[196:199], v[220:223]
    v_subrev_u32 v104, 56, v4
    v_mfma_f32_16x16x32_bf16 v[216:219], a[168:171], a[196:199], v[216:219]
    s_mov_b64 exec, 3
    ds_write_b128 v9, v[248:251] offset:16704
Lpad16:
    s_cbranch_execz Lhret
    s_mov_b64 exec, -1
    v_mfma_f32_16x16x32_bf16 v[212:215], a[164:167], a[196:199], v[212:215]
    s_waitcnt vmcnt(24)
    ds_read_b64_tr_b16 a[144:145], v26 offset:0
    ds_read_b64_tr_b16 a[146:147], v26 offset:512
    ds_read_b64_tr_b16 a[148:149], v26 offset:32
    v_mfma_f32_16x16x32_bf16 v[208:211], a[160:163], a[196:199], v[208:211]
    ds_read_b64_tr_b16 a[150:151], v26 offset:544
    ds_read_b64_tr_b16 a[152:153], v26 offset:64
    ds_read_b64_tr_b16 a[154:155], v26 offset:576
    ds_read_b64_tr_b16 a[156:157], v26 offset:96
    ds_read_b64_tr_b16 a[158:159], v26 offset:608
    s_waitcnt vmcnt(12)
    s_waitcnt lgkmcnt(9)
    s_barrier
    v_mfma_f32_16x16x32_bf16 v[128:131], a[208:211], a[224:227], v[128:131]
    ds_read_b64_tr_b16 a[160:161], v22 offset:0
    v_mfma_f32_16x16x32_bf16 v[132:135], a[212:215], a[224:227], v[132:135]
    ds_read_b64_tr_b16 a[162:163], v22 offset:256
    v_mfma_f32_16x16x32_bf16 v[136:139], a[216:219], a[224:227], v[136:139]
    s_add_u32 m0, s73, 83808
    s_mul_i32 s66, s64, 221184
    v_mfma_f32_16x16x32_bf16 v[140:143], a[220:223], a[224:227], v[140:143]
    ds_read_b64_tr_b16 a[164:165], v22 offset:32
    v_mfma_f32_16x16x32_bf16 v[156:159], a[220:223], a[228:231], v[156:159]
    ds_read_b64_tr_b16 a[166:167], v22 offset:288
    v_mfma_f32_16x16x32_bf16 v[152:155], a[216:219], a[228:231], v[152:155]
    buffer_load_dwordx4 v18, s[8:11], s66 offen lds
    v_mfma_f32_16x16x32_bf16 v[148:151], a[212:215], a[228:231], v[148:151]
    ds_read_b64_tr_b16 a[168:169], v22 offset:2112
    v_mfma_f32_16x16x32_bf16 v[144:147], a[208:211], a[228:231], v[144:147]
    ds_read_b64_tr_b16 a[170:171], v22 offset:2368
Lpad17:
    s_cbranch_execz Lhret
    v_mfma_f32_16x16x32_bf16 v[160:163], a[208:211], a[232:235], v[160:163]
    s_waitcnt lgkmcnt(15)
    s_mov_b32 s76, 196608
    buffer_store_dwordx4 v[100:103], v124, s[20:23], s76 offen sc1
    v_mfma_f32_16x16x32_bf16 v[164:167], a[212:215], a[232:235], v[164:167]
    ds_read_b64_tr_b16 a[172:173], v22 offset:2144
    s_waitcnt vmcnt(21)
    v_mfma_f32_16x16x32_bf16 v[168:171], a[216:219], a[232:235], v[168:171]
    ds_read_b64_tr_b16 a[174:175], v22 offset:2400
    s_add_u32 m0, s73, 84864
    v_mfma_f32_16x16x32_bf16 v[172:175], a[220:223], a[232:235], v[172:175]
    buffer_load_dwordx4 v127, s[8:11], s66 offen lds
    v_mfma_f32_16x16x32_bf16 v[188:191], a[220:223], a[236:239], v[188:191]
    ds_read_b128 a[176:179], v21 offset:0
    v_mfma_f32_16x16x32_bf16 v[184:187], a[216:219], a[236:239], v[184:187]
    ds_read_b128 a[180:183], v21 offset:256
    v_mfma_f32_16x16x32_bf16 v[180:183], a[212:215], a[236:239], v[180:183]
    ds_read_b128 v[224:227], v9 offset:16736
    v_mfma_f32_16x16x32_bf16 v[176:179], a[208:211], a[236:239], v[176:179]
    ds_read_b128 a[184:187], v21 offset:8320
    v_mfma_f32_16x16x32_bf16 v[192:195], a[208:211], a[240:243], v[192:195]
    ds_read_b128 a[188:191], v21 offset:8576
    v_mfma_f32_16x16x32_bf16 v[196:199], a[212:215], a[240:243], v[196:199]
    ds_read_b64 v[240:241], v9 offset:16728
    s_add_u32 m0, s73, 85920
    v_mfma_f32_16x16x32_bf16 v[200:203], a[216:219], a[240:243], v[200:203]
    ds_read_b128 a[192:195], v21 offset:16640
    v_mfma_f32_16x16x32_bf16 v[204:207], a[220:223], a[240:243], v[204:207]
    ds_read_b128 a[196:199], v21 offset:16896
    v_mfma_f32_16x16x32_bf16 v[220:223], a[220:223], a[244:247], v[220:223]
    buffer_load_dwordx4 v18, s[12:15], s66 offen lds
    ds_read_b128 v[228:231], v9 offset:17760
    v_mfma_f32_16x16x32_bf16 v[216:219], a[216:219], a[244:247], v[216:219]
    ds_read_b64 v[242:243], v9 offset:17752
    s_add_u32 m0, s73, 86976
    v_mfma_f32_16x16x32_bf16 v[212:215], a[212:215], a[244:247], v[212:215]
    buffer_load_dwordx4 v127, s[12:15], s66 offen lds
    v_readfirstlane_b32 s56, v2
    v_readfirstlane_b32 s57, v3
    v_mfma_f32_16x16x32_bf16 v[208:211], a[208:211], a[244:247], v[208:211]
    s_add_u32 m0, s72, 100768
    s_lshl_b32 s65, s64, 7
    buffer_load_dwordx4 v17, s[4:7], s65 offen offset:0 lds
    s_nop 1
    s_cmp_eq_u32 s56, 0
    s_cbranch_scc1 Lns4
Lnb5:
    s_waitcnt lgkmcnt(2)
    v_mfma_f32_16x16x32_bf16 v[128:131], a[160:163], a[176:179], v[128:131]
    ds_read_b64_tr_b16 a[208:209], v22 offset:4256
    v_mfma_f32_16x16x32_bf16 v[132:135], a[164:167], a[176:179], v[132:135]
    ds_read_b64_tr_b16 a[210:211], v22 offset:4512
    v_mfma_f32_16x16x32_bf16 v[136:139], a[168:171], a[176:179], v[136:139]
Lpad18:
    s_cbranch_execz Lhret
    s_add_u32 s64, s64, 1
    s_cmp_eq_u32 s64, 10
    s_cselect_b32 s64, 0, s64
    s_add_u32 m0, s72, 102368
    v_mfma_f32_16x16x32_bf16 v[140:143], a[172:175], a[176:179], v[140:143]
    ds_read_b64_tr_b16 a[212:213], v22 offset:4288
    v_mfma_f32_16x16x32_bf16 v[156:159], a[172:175], a[180:183], v[156:159]
    ds_read_b64_tr_b16 a[214:215], v22 offset:4544
    v_mfma_f32_16x16x32_bf16 v[152:155], a[168:171], a[180:183], v[152:155]
    buffer_load_dwordx4 v17, s[4:7], s65 offen offset:2560 lds
    s_waitcnt lgkmcnt(15)
    v_mfma_f32_16x16x32_bf16 v[148:151], a[164:167], a[180:183], v[148:151]
    ds_read_b64_tr_b16 a[216:217], v22 offset:6368
    v_mfma_f32_16x16x32_bf16 v[144:147], a[160:163], a[180:183], v[144:147]
    ds_read_b64_tr_b16 a[218:219], v22 offset:6624
    v_mfma_f32_16x16x32_bf16 v[160:163], a[160:163], a[184:187], v[160:163]
    s_cmp_lg_u32 s3, 0
    s_cbranch_scc1 Lo12
    s_add_u32 s70, s79, 0
    s_mul_i32 s76, s70, 52
    s_lshr_b32 s76, s76, 8
    s_mul_i32 s76, s76, 265
    s_add_u32 s70, s70, s91
    s_add_u32 s70, s70, s76
    s_lshl_b32 s70, s70, 10
    buffer_store_dwordx4 a[144:147], v24, s[20:23], s70 offen sc1
Lo12:
    v_mfma_f32_16x16x32_bf16 v[164:167], a[164:167], a[184:187], v[164:167]
    ds_read_b64_tr_b16 a[220:221], v22 offset:6400
    ds_read_b128 v[232:235], v9 offset:18784
    v_mfma_f32_16x16x32_bf16 v[168:171], a[168:171], a[184:187], v[168:171]
    ds_read_b64_tr_b16 a[222:223], v22 offset:6656
    v_add_u32 v22, 41904, v20
    v_mfma_f32_16x16x32_bf16 v[172:175], a[172:175], a[184:187], v[172:175]
    ds_read_b64 v[244:245], v9 offset:18776
    s_add_u32 m0, s72, 109088
    v_mfma_f32_16x16x32_bf16 v[188:191], a[172:175], a[188:191], v[188:191]
    ds_read_b128 a[224:227], v21 offset:32
    v_mfma_f32_16x16x32_bf16 v[184:187], a[168:171], a[188:191], v[184:187]
    ds_read_b128 a[228:231], v21 offset:288
    v_mfma_f32_16x16x32_bf16 v[180:183], a[164:167], a[188:191], v[180:183]
    buffer_load_dwordx4 v114, s[4:7], s65 offen offset:0 lds
    ds_read_b128 v[236:239], v9 offset:19808
    v_mfma_f32_16x16x32_bf16 v[176:179], a[160:163], a[188:191], v[176:179]
    ds_read_b128 a[232:235], v21 offset:8352
    ds_read_b64 v[246:247], v9 offset:19800
    s_waitcnt lgkmcnt(15)
    v_mfma_f32_16x16x32_bf16 v[192:195], a[160:163], a[192:195], v[192:195]
    ds_read_b128 a[236:239], v21 offset:8608
    v_alignbit_b32 v40, v224, v241, 16
    s_add_u32 m0, s72, 110688
    v_mfma_f32_16x16x32_bf16 v[196:199], a[164:167], a[192:195], v[196:199]
    buffer_load_dwordx4 v114, s[4:7], s65 offen offset:2560 lds
    v_alignbit_b32 v41, v225, v224, 16
    v_alignbit_b32 v42, v226, v225, 16
Lpad19:
    s_cbranch_execz Lhret
    v_mfma_f32_16x16x32_bf16 v[200:203], a[168:171], a[192:195], v[200:203]
    ds_read_b128 a[240:243], v21 offset:16672
    v_alignbit_b32 v43, v227, v226, 16
    v_alignbit_b32 v72, v241, v240, 16
    s_add_u32 m0, s72, 117408
    v_mfma_f32_16x16x32_bf16 v[204:207], a[172:175], a[192:195], v[204:207]
    ds_read_b128 a[244:247], v21 offset:16928
    v_add_u32 v21, 41904, v19
    v_mfma_f32_16x16x32_bf16 v[220:223], a[172:175], a[196:199], v[220:223]
    buffer_load_dwordx4 v115, s[4:7], s65 offen offset:0 lds
    v_mov_b32 v73, v40
    v_mov_b32 v74, v41
    v_mov_b32 v75, v42
    v_mfma_f32_16x16x32_bf16 v[216:219], a[168:171], a[196:199], v[216:219]
    v_mov_b32 v56, v241
    s_add_u32 m0, s72, 119008
    s_nop 0
    buffer_load_dwordx4 v115, s[4:7], s65 offen offset:2560 lds
    v_mov_b32 v57, v224
    v_mfma_f32_16x16x32_bf16 v[212:215], a[164:167], a[196:199], v[212:215]
    v_mov_b32 v58, v225
    v_mov_b32 v59, v226
    v_mfma_f32_16x16x32_bf16 v[208:211], a[160:163], a[196:199], v[208:211]
    s_cmp_lg_u32 s3, 0
    s_cbranch_scc1 Lo13
    s_add_u32 s70, s79, 1
    s_mul_i32 s76, s70, 52
    s_lshr_b32 s76, s76, 8
    s_mul_i32 s76, s76, 265
    s_add_u32 s70, s70, s91
    s_add_u32 s70, s70, s76
    s_lshl_b32 s70, s70, 10
    buffer_store_dwordx4 a[148:151], v24, s[20:23], s70 offen sc1
Lo13:
    s_waitcnt vmcnt(11)
    s_waitcnt lgkmcnt(0)
    s_barrier
    v_mfma_f32_16x16x32_bf16 v[128:131], a[208:211], a[224:227], v[128:131]
    ds_read_b64_tr_b16 a[160:161], v22 offset:0
    v_mfma_f32_16x16x32_bf16 v[132:135], a[212:215], a[224:227], v[132:135]
    ds_read_b64_tr_b16 a[162:163], v22 offset:256
    v_mfma_f32_16x16x32_bf16 v[136:139], a[216:219], a[224:227], v[136:139]
    s_add_u32 m0, s73, 0
    s_mul_i32 s66, s64, 221184
    v_mfma_f32_16x16x32_bf16 v[140:143], a[220:223], a[224:227], v[140:143]
    ds_read_b64_tr_b16 a[164:165], v22 offset:32
    v_mfma_f32_16x16x32_bf16 v[156:159], a[220:223], a[228:231], v[156:159]
    ds_read_b64_tr_b16 a[166:167], v22 offset:288
    v_mfma_f32_16x16x32_bf16 v[152:155], a[216:219], a[228:231], v[152:155]
    buffer_load_dwordx4 v18, s[8:11], s66 offen lds
    v_mfma_f32_16x16x32_bf16 v[148:151], a[212:215], a[228:231], v[148:151]
    ds_read_b64_tr_b16 a[168:169], v22 offset:2112
    v_mfma_f32_16x16x32_bf16 v[144:147], a[208:211], a[228:231], v[144:147]
    ds_read_b64_tr_b16 a[170:171], v22 offset:2368
    v_mfma_f32_16x16x32_bf16 v[160:163], a[208:211], a[232:235], v[160:163]
    s_cmp_lg_u32 s3, 0
    s_cbranch_scc1 Lo14
    s_add_u32 s70, s79, 2
    s_mul_i32 s76, s70, 52
    s_lshr_b32 s76, s76, 8
    s_mul_i32 s76, s76, 265
Lpad20:
    s_cbranch_execz Lhret
    s_add_u32 s70, s70, s91
    s_add_u32 s70, s70, s76
    s_lshl_b32 s70, s70, 10
    buffer_store_dwordx4 a[152:155], v24, s[20:23], s70 offen sc1
Lo14:
    v_mfma_f32_16x16x32_bf16 v[164:167], a[212:215], a[232:235], v[164:167]
    ds_read_b64_tr_b16 a[172:173], v22 offset:2144
    s_waitcnt lgkmcnt(15)
    v_mfma_f32_16x16x32_bf16 v[168:171], a[216:219], a[232:235], v[168:171]
    ds_read_b64_tr_b16 a[174:175], v22 offset:2400
    v_alignbit_b32 v44, v228, v243, 16
    v_mfma_f32_16x16x32_bf16 v[172:175], a[220:223], a[232:235], v[172:175]
    s_add_u32 m0, s73, 1056
    s_nop 0
    buffer_load_dwordx4 v127, s[8:11], s66 offen lds
    v_mfma_f32_16x16x32_bf16 v[188:191], a[220:223], a[236:239], v[188:191]
    ds_read_b128 a[176:179], v21 offset:0
    v_alignbit_b32 v45, v229, v228, 16
    v_alignbit_b32 v46, v230, v229, 16
    v_mfma_f32_16x16x32_bf16 v[184:187], a[216:219], a[236:239], v[184:187]
    ds_read_b128 a[180:183], v21 offset:256
    v_alignbit_b32 v47, v231, v230, 16
    s_add_u32 m0, s73, 2112
    v_mfma_f32_16x16x32_bf16 v[180:183], a[212:215], a[236:239], v[180:183]
    buffer_load_dwordx4 v18, s[12:15], s66 offen lds
    v_alignbit_b32 v76, v243, v242, 16
    v_mfma_f32_16x16x32_bf16 v[176:179], a[208:211], a[236:239], v[176:179]
    ds_read_b128 a[184:187], v21 offset:8320
    v_mov_b32 v77, v44
    v_mov_b32 v78, v45
    v_mfma_f32_16x16x32_bf16 v[192:195], a[208:211], a[240:243], v[192:195]
    ds_read_b128 a[188:191], v21 offset:8576
    s_add_u32 m0, s73, 3168
    v_mfma_f32_16x16x32_bf16 v[196:199], a[212:215], a[240:243], v[196:199]
    buffer_load_dwordx4 v127, s[12:15], s66 offen lds
    v_mov_b32 v79, v46
    v_mfma_f32_16x16x32_bf16 v[200:203], a[216:219], a[240:243], v[200:203]
    ds_read_b128 a[192:195], v21 offset:16640
    v_mov_b32 v60, v243
    v_mov_b32 v61, v228
    v_mfma_f32_16x16x32_bf16 v[204:207], a[220:223], a[240:243], v[204:207]
    ds_read_b128 a[196:199], v21 offset:16896
    s_add_u32 m0, s72, 16960
    s_lshl_b32 s65, s64, 7
    v_mfma_f32_16x16x32_bf16 v[220:223], a[220:223], a[244:247], v[220:223]
    buffer_load_dwordx4 v17, s[4:7], s65 offen offset:0 lds
    v_mov_b32 v62, v229
    v_mfma_f32_16x16x32_bf16 v[216:219], a[216:219], a[244:247], v[216:219]
    v_mov_b32 v63, v230
    v_mfma_f32_16x16x32_bf16 v[212:215], a[212:215], a[244:247], v[212:215]
    s_cmp_lg_u32 s3, 0
    s_cbranch_scc1 Lo15
    s_add_u32 s70, s79, 3
    s_mul_i32 s76, s70, 52
    s_lshr_b32 s76, s76, 8
    s_mul_i32 s76, s76, 265
    s_add_u32 s70, s70, s91
    s_add_u32 s70, s70, s76
    s_lshl_b32 s70, s70, 10
Lpad21:
    s_cbranch_execz Lhret
    buffer_store_dwordx4 a[156:159], v24, s[20:23], s70 offen sc1
Lo15:
    v_mfma_f32_16x16x32_bf16 v[208:211], a[208:211], a[244:247], v[208:211]
    s_waitcnt lgkmcnt(0)
    v_mfma_f32_16x16x32_bf16 v[128:131], a[160:163], a[176:179], v[128:131]
    ds_read_b64_tr_b16 a[208:209], v22 offset:4256
    v_mfma_f32_16x16x32_bf16 v[132:135], a[164:167], a[176:179], v[132:135]
    ds_read_b64_tr_b16 a[210:211], v22 offset:4512
    v_mfma_f32_16x16x32_bf16 v[136:139], a[168:171], a[176:179], v[136:139]
    s_add_u32 s64, s64, 1
    s_cmp_eq_u32 s64, 10
    s_cselect_b32 s64, 0, s64
    s_add_u32 m0, s72, 18560
    v_mfma_f32_16x16x32_bf16 v[140:143], a[172:175], a[176:179], v[140:143]
    ds_read_b64_tr_b16 a[212:213], v22 offset:4288
    v_mfma_f32_16x16x32_bf16 v[156:159], a[172:175], a[180:183], v[156:159]
    ds_read_b64_tr_b16 a[214:215], v22 offset:4544
    v_mfma_f32_16x16x32_bf16 v[152:155], a[168:171], a[180:183], v[152:155]
    buffer_load_dwordx4 v17, s[4:7], s65 offen offset:2560 lds
    v_mfma_f32_16x16x32_bf16 v[148:151], a[164:167], a[180:183], v[148:151]
    ds_read_b64_tr_b16 a[216:217], v22 offset:6368
    s_waitcnt lgkmcnt(15)
    v_mfma_f32_16x16x32_bf16 v[144:147], a[160:163], a[180:183], v[144:147]
    ds_read_b64_tr_b16 a[218:219], v22 offset:6624
    v_alignbit_b32 v48, v232, v245, 16
    v_mfma_f32_16x16x32_bf16 v[160:163], a[160:163], a[184:187], v[160:163]
    s_add_u32 m0, s72, 25280
    v_mfma_f32_16x16x32_bf16 v[164:167], a[164:167], a[184:187], v[164:167]
    ds_read_b64_tr_b16 a[220:221], v22 offset:6400
    v_mfma_f32_16x16x32_bf16 v[168:171], a[168:171], a[184:187], v[168:171]
    ds_read_b64_tr_b16 a[222:223], v22 offset:6656
    v_add_u32 v22, 83808, v20
    v_mfma_f32_16x16x32_bf16 v[172:175], a[172:175], a[184:187], v[172:175]
    buffer_load_dwordx4 v114, s[4:7], s65 offen offset:0 lds
    v_mfma_f32_16x16x32_bf16 v[188:191], a[172:175], a[188:191], v[188:191]
    ds_read_b128 a[224:227], v21 offset:32
    v_alignbit_b32 v49, v233, v232, 16
    v_mfma_f32_16x16x32_bf16 v[184:187], a[168:171], a[188:191], v[184:187]
    ds_read_b128 a[228:231], v21 offset:288
    v_alignbit_b32 v50, v234, v233, 16
    v_mfma_f32_16x16x32_bf16 v[180:183], a[164:167], a[188:191], v[180:183]
    s_add_u32 m0, s72, 26880
    v_mfma_f32_16x16x32_bf16 v[176:179], a[160:163], a[188:191], v[176:179]
    ds_read_b128 a[232:235], v21 offset:8352
    v_mfma_f32_16x16x32_bf16 v[192:195], a[160:163], a[192:195], v[192:195]
    ds_read_b128 a[236:239], v21 offset:8608
    v_mfma_f32_16x16x32_bf16 v[196:199], a[164:167], a[192:195], v[196:199]
    buffer_load_dwordx4 v114, s[4:7], s65 offen offset:2560 lds
    v_mfma_f32_16x16x32_bf16 v[200:203], a[168:171], a[192:195], v[200:203]
    ds_read_b128 a[240:243], v21 offset:16672
    v_alignbit_b32 v51, v235, v234, 16
Lpad22:
    s_cbranch_execz Lhret
    v_mfma_f32_16x16x32_bf16 v[204:207], a[172:175], a[192:195], v[204:207]
    ds_read_b128 a[244:247], v21 offset:16928
    v_add_u32 v21, 83808, v19
    v_mfma_f32_16x16x32_bf16 v[220:223], a[172:175], a[196:199], v[220:223]
    v_alignbit_b32 v80, v245, v244, 16
    s_add_u32 m0, s72, 33600
    v_mfma_f32_16x16x32_bf16 v[216:219], a[168:171], a[196:199], v[216:219]
    buffer_load_dwordx4 v115, s[4:7], s65 offen offset:0 lds
    v_mov_b32 v81, v48
    v_mfma_f32_16x16x32_bf16 v[212:215], a[164:167], a[196:199], v[212:215]
    v_mov_b32 v82, v49
    s_add_u32 m0, s72, 35200
    s_nop 0
    buffer_load_dwordx4 v115, s[4:7], s65 offen offset:2560 lds
    v_mfma_f32_16x16x32_bf16 v[208:211], a[160:163], a[196:199], v[208:211]
    v_mov_b32 v83, v50
    v_mov_b32 v64, v245
    v_mov_b32 v65, v232
    v_mov_b32 v66, v233
    v_mov_b32 v67, v234
    s_waitcnt vmcnt(10)
    s_waitcnt vmcnt(19)
    s_waitcnt lgkmcnt(0)
    s_barrier
    v_mfma_f32_16x16x32_bf16 v[128:131], a[208:211], a[224:227], v[128:131]
    ds_read_b64_tr_b16 a[160:161], v22 offset:0
    v_mfma_f32_16x16x32_bf16 v[132:135], a[212:215], a[224:227], v[132:135]
    ds_read_b64_tr_b16 a[162:163], v22 offset:256
    v_mfma_f32_16x16x32_bf16 v[136:139], a[216:219], a[224:227], v[136:139]
    s_add_u32 m0, s73, 41904
    s_mul_i32 s66, s64, 221184
    v_mfma_f32_16x16x32_bf16 v[140:143], a[220:223], a[224:227], v[140:143]
    ds_read_b64_tr_b16 a[164:165], v22 offset:32
    v_mfma_f32_16x16x32_bf16 v[156:159], a[220:223], a[228:231], v[156:159]
    ds_read_b64_tr_b16 a[166:167], v22 offset:288
    v_mfma_f32_16x16x32_bf16 v[152:155], a[216:219], a[228:231], v[152:155]
    buffer_load_dwordx4 v18, s[8:11], s66 offen lds
    v_mfma_f32_16x16x32_bf16 v[148:151], a[212:215], a[228:231], v[148:151]
    ds_read_b64_tr_b16 a[168:169], v22 offset:2112
    v_mov_b32 v10, s56
    v_mfma_f32_16x16x32_bf16 v[144:147], a[208:211], a[228:231], v[144:147]
    ds_read_b64_tr_b16 a[170:171], v22 offset:2368
    v_mov_b32 v11, s57
    v_mfma_f32_16x16x32_bf16 v[160:163], a[208:211], a[232:235], v[160:163]
    v_lshl_add_u32 v12, v1, 3, s74
    s_add_u32 m0, s73, 42960
    v_mfma_f32_16x16x32_bf16 v[164:167], a[212:215], a[232:235], v[164:167]
    ds_read_b64_tr_b16 a[172:173], v22 offset:2144
    v_mfma_f32_16x16x32_bf16 v[168:171], a[216:219], a[232:235], v[168:171]
    ds_read_b64_tr_b16 a[174:175], v22 offset:2400
    v_mfma_f32_16x16x32_bf16 v[172:175], a[220:223], a[232:235], v[172:175]
    buffer_load_dwordx4 v127, s[8:11], s66 offen lds
    v_mfma_f32_16x16x32_bf16 v[188:191], a[220:223], a[236:239], v[188:191]
    ds_read_b128 a[176:179], v21 offset:0
    v_mfma_f32_16x16x32_bf16 v[184:187], a[216:219], a[236:239], v[184:187]
Lpad23:
    s_cbranch_execz Lhret
    ds_read_b128 a[180:183], v21 offset:256
    v_mfma_f32_16x16x32_bf16 v[180:183], a[212:215], a[236:239], v[180:183]
    s_mov_b64 exec, 0xffff
    buffer_store_dwordx2 v[10:11], v12, s[20:23], 0 offen sc1
    s_mov_b64 exec, -1
    v_mfma_f32_16x16x32_bf16 v[176:179], a[208:211], a[236:239], v[176:179]
    ds_read_b128 a[184:187], v21 offset:8320
    s_waitcnt lgkmcnt(15)
    v_alignbit_b32 v52, v236, v247, 16
    v_mfma_f32_16x16x32_bf16 v[192:195], a[208:211], a[240:243], v[192:195]
    ds_read_b128 a[188:191], v21 offset:8576
    s_add_u32 m0, s73, 44016
    v_mfma_f32_16x16x32_bf16 v[196:199], a[212:215], a[240:243], v[196:199]
    buffer_load_dwordx4 v18, s[12:15], s66 offen lds
    v_alignbit_b32 v53, v237, v236, 16
    v_alignbit_b32 v54, v238, v237, 16
    v_mfma_f32_16x16x32_bf16 v[200:203], a[216:219], a[240:243], v[200:203]
    ds_read_b128 a[192:195], v21 offset:16640
    v_alignbit_b32 v55, v239, v238, 16
    s_add_u32 m0, s73, 45072
    v_mfma_f32_16x16x32_bf16 v[204:207], a[220:223], a[240:243], v[204:207]
    ds_read_b128 a[196:199], v21 offset:16896
    buffer_load_dwordx4 v127, s[12:15], s66 offen lds
    v_mfma_f32_16x16x32_bf16 v[220:223], a[220:223], a[244:247], v[220:223]
    v_alignbit_b32 v84, v247, v246, 16
    v_mov_b32 v85, v52
    v_mov_b32 v86, v53
    s_add_u32 m0, s72, 58864
    s_lshl_b32 s65, s64, 7
    v_mfma_f32_16x16x32_bf16 v[216:219], a[216:219], a[244:247], v[216:219]
    buffer_load_dwordx4 v17, s[4:7], s65 offen offset:0 lds
    v_mov_b32 v87, v54
    v_mov_b32 v68, v247
    v_mfma_f32_16x16x32_bf16 v[212:215], a[212:215], a[244:247], v[212:215]
    v_mov_b32 v69, v236
    v_mov_b32 v70, v237
    v_mov_b32 v71, v238
    v_mfma_f32_16x16x32_bf16 v[208:211], a[208:211], a[244:247], v[208:211]
    s_cmp_lg_u32 s3, 0
    s_cbranch_scc1 Lo16
    v_lshl_add_u32 v12, v1, 3, s71
    s_waitcnt vmcnt(11)
    s_mov_b64 exec, 0xffff
    buffer_store_dwordx2 v[10:11], v12, s[20:23], 0 offen sc1
    s_mov_b64 exec, -1
Lo16:
    s_waitcnt lgkmcnt(0)
    v_mfma_f32_16x16x32_bf16 v[128:131], a[160:163], a[176:179], v[128:131]
    ds_read_b64_tr_b16 a[208:209], v22 offset:4256
    v_mfma_f32_16x16x32_bf16 v[132:135], a[164:167], a[176:179], v[132:135]
    ds_read_b64_tr_b16 a[210:211], v22 offset:4512
    v_mfma_f32_16x16x32_bf16 v[136:139], a[168:171], a[176:179], v[136:139]
    s_add_u32 s64, s64, 1
    s_cmp_eq_u32 s64, 10
    s_cselect_b32 s64, 0, s64
    s_add_u32 m0, s72, 60464
    v_mfma_f32_16x16x32_bf16 v[140:143], a[172:175], a[176:179], v[140:143]
    ds_read_b64_tr_b16 a[212:213], v22 offset:4288
Lpad24:
    s_cbranch_execz Lhret
    v_mfma_f32_16x16x32_bf16 v[156:159], a[172:175], a[180:183], v[156:159]
    ds_read_b64_tr_b16 a[214:215], v22 offset:4544
    v_mfma_f32_16x16x32_bf16 v[152:155], a[168:171], a[180:183], v[152:155]
    buffer_load_dwordx4 v17, s[4:7], s65 offen offset:2560 lds
    v_mfma_f32_16x16x32_bf16 v[148:151], a[164:167], a[180:183], v[148:151]
    ds_read_b64_tr_b16 a[216:217], v22 offset:6368
    v_and_b32 v4, 15, v1
    v_mfma_f32_16x16x32_bf16 v[144:147], a[160:163], a[180:183], v[144:147]
    ds_read_b64_tr_b16 a[218:219], v22 offset:6624
    s_add_u32 m0, s72, 67184
    v_mfma_f32_16x16x32_bf16 v[160:163], a[160:163], a[184:187], v[160:163]
    buffer_load_dwordx4 v114, s[4:7], s65 offen offset:0 lds
    v_mfma_f32_16x16x32_bf16 v[164:167], a[164:167], a[184:187], v[164:167]
    ds_read_b64_tr_b16 a[220:221], v22 offset:6400
    v_lshrrev_b32 v5, 4, v1
    v_mfma_f32_16x16x32_bf16 v[168:171], a[168:171], a[184:187], v[168:171]
    ds_read_b64_tr_b16 a[222:223], v22 offset:6656
    v_add_u32 v22, 0, v20
    v_mfma_f32_16x16x32_bf16 v[172:175], a[172:175], a[184:187], v[172:175]
    s_add_u32 m0, s72, 68784
    v_mfma_f32_16x16x32_bf16 v[188:191], a[172:175], a[188:191], v[188:191]
    ds_read_b128 a[224:227], v21 offset:32
    v_mfma_f32_16x16x32_bf16 v[184:187], a[168:171], a[188:191], v[184:187]
    ds_read_b128 a[228:231], v21 offset:288
    v_mfma_f32_16x16x32_bf16 v[180:183], a[164:167], a[188:191], v[180:183]
    buffer_load_dwordx4 v114, s[4:7], s65 offen offset:2560 lds
    v_mfma_f32_16x16x32_bf16 v[176:179], a[160:163], a[188:191], v[176:179]
    ds_read_b128 a[232:235], v21 offset:8352
    v_lshlrev_b32 v5, 3, v5
    v_mfma_f32_16x16x32_bf16 v[192:195], a[160:163], a[192:195], v[192:195]
    ds_read_b128 a[236:239], v21 offset:8608
    s_add_u32 m0, s72, 75504
    v_mfma_f32_16x16x32_bf16 v[196:199], a[164:167], a[192:195], v[196:199]
    buffer_load_dwordx4 v115, s[4:7], s65 offen offset:0 lds
    v_mfma_f32_16x16x32_bf16 v[200:203], a[168:171], a[192:195], v[200:203]
    ds_read_b128 a[240:243], v21 offset:16672
    v_sub_u32 v4, v4, v5
    v_mfma_f32_16x16x32_bf16 v[204:207], a[172:175], a[192:195], v[204:207]
    ds_read_b128 a[244:247], v21 offset:16928
    v_add_u32 v21, 0, v19
    v_mfma_f32_16x16x32_bf16 v[220:223], a[172:175], a[196:199], v[220:223]
    s_add_u32 m0, s72, 77104
    v_mfma_f32_16x16x32_bf16 v[216:219], a[168:171], a[196:199], v[216:219]
    buffer_load_dwordx4 v115, s[4:7], s65 offen offset:2560 lds
    v_mfma_f32_16x16x32_bf16 v[212:215], a[164:167], a[196:199], v[212:215]
    v_add_u32 v4, 16, v4
    v_and_b32 v5, 1, v4
    v_mfma_f32_16x16x32_bf16 v[208:211], a[160:163], a[196:199], v[208:211]
    v_lshlrev_b32 v5, 4, v5
    v_lshlrev_b32 v5, v5, v31
    v_lshrrev_b32 v4, 1, v4
    s_waitcnt vmcnt(11)
    s_waitcnt lgkmcnt(0)
    s_barrier
    v_mfma_f32_16x16x32_bf16 v[128:131], a[208:211], a[224:227], v[128:131]
Lpad25:
    s_cbranch_execz Lhret
    ds_read_b64_tr_b16 a[160:161], v22 offset:0
    v_mfma_f32_16x16x32_bf16 v[132:135], a[212:215], a[224:227], v[132:135]
    ds_read_b64_tr_b16 a[162:163], v22 offset:256
    v_mfma_f32_16x16x32_bf16 v[136:139], a[216:219], a[224:227], v[136:139]
    s_add_u32 m0, s73, 83808
    s_mul_i32 s66, s64, 221184
    v_mfma_f32_16x16x32_bf16 v[140:143], a[220:223], a[224:227], v[140:143]
    ds_read_b64_tr_b16 a[164:165], v22 offset:32
    v_mfma_f32_16x16x32_bf16 v[156:159], a[220:223], a[228:231], v[156:159]
    ds_read_b64_tr_b16 a[166:167], v22 offset:288
    v_mfma_f32_16x16x32_bf16 v[152:155], a[216:219], a[228:231], v[152:155]
    buffer_load_dwordx4 v18, s[8:11], s66 offen lds
    v_mfma_f32_16x16x32_bf16 v[148:151], a[212:215], a[228:231], v[148:151]
    ds_read_b64_tr_b16 a[168:169], v22 offset:2112
    v_mfma_f32_16x16x32_bf16 v[144:147], a[208:211], a[228:231], v[144:147]
    ds_read_b64_tr_b16 a[170:171], v22 offset:2368
    v_mfma_f32_16x16x32_bf16 v[160:163], a[208:211], a[232:235], v[160:163]
    v_cmp_eq_u32 vcc, 0, v4
    s_nop 1
    v_cndmask_b32 v252, 0, v5, vcc
    v_mfma_f32_16x16x32_bf16 v[164:167], a[212:215], a[232:235], v[164:167]
    ds_read_b64_tr_b16 a[172:173], v22 offset:2144
    s_add_u32 m0, s73, 84864
    v_mfma_f32_16x16x32_bf16 v[168:171], a[216:219], a[232:235], v[168:171]
    ds_read_b64_tr_b16 a[174:175], v22 offset:2400
    v_mfma_f32_16x16x32_bf16 v[172:175], a[220:223], a[232:235], v[172:175]
    buffer_load_dwordx4 v127, s[8:11], s66 offen lds
    v_mfma_f32_16x16x32_bf16 v[188:191], a[220:223], a[236:239], v[188:191]
    ds_read_b128 a[176:179], v21 offset:0
    v_mfma_f32_16x16x32_bf16 v[184:187], a[216:219], a[236:239], v[184:187]
    ds_read_b128 a[180:183], v21 offset:256
    v_mfma_f32_16x16x32_bf16 v[180:183], a[212:215], a[236:239], v[180:183]
    v_cmp_eq_u32 vcc, 1, v4
    s_nop 1
    v_cndmask_b32 v253, 0, v5, vcc
    v_mfma_f32_16x16x32_bf16 v[176:179], a[208:211], a[236:239], v[176:179]
    ds_read_b128 a[184:187], v21 offset:8320
    s_add_u32 m0, s73, 85920
    v_mfma_f32_16x16x32_bf16 v[192:195], a[208:211], a[240:243], v[192:195]
    ds_read_b128 a[188:191], v21 offset:8576
    v_mfma_f32_16x16x32_bf16 v[196:199], a[212:215], a[240:243], v[196:199]
    buffer_load_dwordx4 v18, s[12:15], s66 offen lds
    v_mfma_f32_16x16x32_bf16 v[200:203], a[216:219], a[240:243], v[200:203]
    ds_read_b128 a[192:195], v21 offset:16640
    v_mfma_f32_16x16x32_bf16 v[204:207], a[220:223], a[240:243], v[204:207]
    ds_read_b128 a[196:199], v21 offset:16896
    v_mfma_f32_16x16x32_bf16 v[220:223], a[220:223], a[244:247], v[220:223]
    v_cmp_eq_u32 vcc, 2, v4
    s_nop 1
    v_cndmask_b32 v254, 0, v5, vcc
    s_add_u32 m0, s73, 86976
    v_mfma_f32_16x16x32_bf16 v[216:219], a[216:219], a[244:247], v[216:219]
Lpad26:
    s_cbranch_execz Lhret
    buffer_load_dwordx4 v127, s[12:15], s66 offen lds
    v_mfma_f32_16x16x32_bf16 v[212:215], a[212:215], a[244:247], v[212:215]
    v_cmp_eq_u32 vcc, 3, v4
    s_nop 1
    v_cndmask_b32 v255, 0, v5, vcc
    s_add_u32 m0, s72, 100768
    s_lshl_b32 s65, s64, 7
    v_mfma_f32_16x16x32_bf16 v[208:211], a[208:211], a[244:247], v[208:211]
    buffer_load_dwordx4 v17, s[4:7], s65 offen offset:0 lds
    ds_write_b128 v9, v[56:59] offset:32
    s_waitcnt lgkmcnt(1)
    v_mfma_f32_16x16x32_bf16 v[128:131], a[160:163], a[176:179], v[128:131]
    ds_read_b64_tr_b16 a[208:209], v22 offset:4256
    v_mfma_f32_16x16x32_bf16 v[132:135], a[164:167], a[176:179], v[132:135]
    ds_read_b64_tr_b16 a[210:211], v22 offset:4512
    v_mfma_f32_16x16x32_bf16 v[136:139], a[168:171], a[176:179], v[136:139]
    s_add_u32 s64, s64, 1
    s_cmp_eq_u32 s64, 10
    s_cselect_b32 s64, 0, s64
    s_add_u32 m0, s72, 102368
    v_mfma_f32_16x16x32_bf16 v[140:143], a[172:175], a[176:179], v[140:143]
    ds_read_b64_tr_b16 a[212:213], v22 offset:4288
    v_mfma_f32_16x16x32_bf16 v[156:159], a[172:175], a[180:183], v[156:159]
    ds_read_b64_tr_b16 a[214:215], v22 offset:4544
    v_mfma_f32_16x16x32_bf16 v[152:155], a[168:171], a[180:183], v[152:155]
    buffer_load_dwordx4 v17, s[4:7], s65 offen offset:2560 lds
    v_mfma_f32_16x16x32_bf16 v[148:151], a[164:167], a[180:183], v[148:151]
    ds_read_b64_tr_b16 a[216:217], v22 offset:6368
    v_mfma_f32_16x16x32_bf16 v[144:147], a[160:163], a[180:183], v[144:147]
    ds_read_b64_tr_b16 a[218:219], v22 offset:6624
    v_mfma_f32_16x16x32_bf16 v[160:163], a[160:163], a[184:187], v[160:163]
    ds_write_b128 v9, v[60:63] offset:1056
    v_mfma_f32_16x16x32_bf16 v[164:167], a[164:167], a[184:187], v[164:167]
    ds_read_b64_tr_b16 a[220:221], v22 offset:6400
    s_add_u32 m0, s72, 109088
    v_mfma_f32_16x16x32_bf16 v[168:171], a[168:171], a[184:187], v[168:171]
    ds_read_b64_tr_b16 a[222:223], v22 offset:6656
    v_add_u32 v22, 41904, v20
    v_mfma_f32_16x16x32_bf16 v[172:175], a[172:175], a[184:187], v[172:175]
    buffer_load_dwordx4 v114, s[4:7], s65 offen offset:0 lds
    v_mfma_f32_16x16x32_bf16 v[188:191], a[172:175], a[188:191], v[188:191]
    ds_read_b128 a[224:227], v21 offset:32
    s_add_u32 m0, s72, 110688
    v_mfma_f32_16x16x32_bf16 v[184:187], a[168:171], a[188:191], v[184:187]
    ds_read_b128 a[228:231], v21 offset:288
    v_mfma_f32_16x16x32_bf16 v[180:183], a[164:167], a[188:191], v[180:183]
    buffer_load_dwordx4 v114, s[4:7], s65 offen offset:2560 lds
    v_mfma_f32_16x16x32_bf16 v[176:179], a[160:163], a[188:191], v[176:179]
    ds_read_b128 a[232:235], v21 offset:8352
    s_add_u32 m0, s72, 117408
    v_mfma_f32_16x16x32_bf16 v[192:195], a[160:163], a[192:195], v[192:195]
    ds_read_b128 a[236:239], v21 offset:8608
Lpad27:
    s_cbranch_execz Lhret
    v_mfma_f32_16x16x32_bf16 v[196:199], a[164:167], a[192:195], v[196:199]
    buffer_load_dwordx4 v115, s[4:7], s65 offen offset:0 lds
    v_mfma_f32_16x16x32_bf16 v[200:203], a[168:171], a[192:195], v[200:203]
    ds_read_b128 a[240:243], v21 offset:16672
    s_add_u32 m0, s72, 119008
    v_mfma_f32_16x16x32_bf16 v[204:207], a[172:175], a[192:195], v[204:207]
    ds_read_b128 a[244:247], v21 offset:16928
    v_add_u32 v21, 41904, v19
    v_mfma_f32_16x16x32_bf16 v[220:223], a[172:175], a[196:199], v[220:223]
    buffer_load_dwordx4 v115, s[4:7], s65 offen offset:2560 lds
    v_mfma_f32_16x16x32_bf16 v[216:219], a[168:171], a[196:199], v[216:219]
    v_mfma_f32_16x16x32_bf16 v[212:215], a[164:167], a[196:199], v[212:215]
    v_mfma_f32_16x16x32_bf16 v[208:211], a[160:163], a[196:199], v[208:211]
    s_waitcnt vmcnt(10)
    s_waitcnt lgkmcnt(0)
    s_barrier
    v_mfma_f32_16x16x32_bf16 v[128:131], a[208:211], a[224:227], v[128:131]
    ds_read_b64_tr_b16 a[160:161], v22 offset:0
    v_mfma_f32_16x16x32_bf16 v[132:135], a[212:215], a[224:227], v[132:135]
    ds_read_b64_tr_b16 a[162:163], v22 offset:256
    v_mfma_f32_16x16x32_bf16 v[136:139], a[216:219], a[224:227], v[136:139]
    s_add_u32 m0, s73, 0
    s_mul_i32 s66, s64, 221184
    v_mfma_f32_16x16x32_bf16 v[140:143], a[220:223], a[224:227], v[140:143]
    ds_read_b64_tr_b16 a[164:165], v22 offset:32
    v_mfma_f32_16x16x32_bf16 v[156:159], a[220:223], a[228:231], v[156:159]
    ds_read_b64_tr_b16 a[166:167], v22 offset:288
    v_mfma_f32_16x16x32_bf16 v[152:155], a[216:219], a[228:231], v[152:155]
    buffer_load_dwordx4 v18, s[8:11], s66 offen lds
    v_mfma_f32_16x16x32_bf16 v[148:151], a[212:215], a[228:231], v[148:151]
    ds_read_b64_tr_b16 a[168:169], v22 offset:2112
    v_mfma_f32_16x16x32_bf16 v[144:147], a[208:211], a[228:231], v[144:147]
Lpad28:
    s_cbranch_execz Lhret
    ds_read_b64_tr_b16 a[170:171], v22 offset:2368
    v_mfma_f32_16x16x32_bf16 v[160:163], a[208:211], a[232:235], v[160:163]
    ds_write_b128 v9, v[64:67] offset:2080
    v_mfma_f32_16x16x32_bf16 v[164:167], a[212:215], a[232:235], v[164:167]
    ds_read_b64_tr_b16 a[172:173], v22 offset:2144
    s_add_u32 m0, s73, 1056
    v_mfma_f32_16x16x32_bf16 v[168:171], a[216:219], a[232:235], v[168:171]
    ds_read_b64_tr_b16 a[174:175], v22 offset:2400
    v_mfma_f32_16x16x32_bf16 v[172:175], a[220:223], a[232:235], v[172:175]
    buffer_load_dwordx4 v127, s[8:11], s66 offen lds
    v_mfma_f32_16x16x32_bf16 v[188:191], a[220:223], a[236:239], v[188:191]
    ds_read_b128 a[176:179], v21 offset:0
    s_add_u32 m0, s73, 2112
    v_mfma_f32_16x16x32_bf16 v[184:187], a[216:219], a[236:239], v[184:187]
    ds_read_b128 a[180:183], v21 offset:256
    v_mfma_f32_16x16x32_bf16 v[180:183], a[212:215], a[236:239], v[180:183]
    buffer_load_dwordx4 v18, s[12:15], s66 offen lds
    v_mfma_f32_16x16x32_bf16 v[176:179], a[208:211], a[236:239], v[176:179]
    ds_read_b128 a[184:187], v21 offset:8320
    s_add_u32 m0, s73, 3168
    v_mfma_f32_16x16x32_bf16 v[192:195], a[208:211], a[240:243], v[192:195]
    ds_read_b128 a[188:191], v21 offset:8576
    v_mfma_f32_16x16x32_bf16 v[196:199], a[212:215], a[240:243], v[196:199]
    buffer_load_dwordx4 v127, s[12:15], s66 offen lds
    v_mfma_f32_16x16x32_bf16 v[200:203], a[216:219], a[240:243], v[200:203]
    ds_read_b128 a[192:195], v21 offset:16640
    v_mfma_f32_16x16x32_bf16 v[204:207], a[220:223], a[240:243], v[204:207]
    ds_read_b128 a[196:199], v21 offset:16896
    v_mfma_f32_16x16x32_bf16 v[220:223], a[220:223], a[244:247], v[220:223]
    s_add_u32 m0, s72, 16960
    s_lshl_b32 s65, s64, 7
    v_mfma_f32_16x16x32_bf16 v[216:219], a[216:219], a[244:247], v[216:219]
    buffer_load_dwordx4 v17, s[4:7], s65 offen offset:0 lds
    v_mfma_f32_16x16x32_bf16 v[212:215], a[212:215], a[244:247], v[212:215]
    v_mfma_f32_16x16x32_bf16 v[208:211], a[208:211], a[244:247], v[208:211]
    s_waitcnt lgkmcnt(0)
    v_mfma_f32_16x16x32_bf16 v[128:131], a[160:163], a[176:179], v[128:131]
    ds_read_b64_tr_b16 a[208:209], v22 offset:4256
    v_mfma_f32_16x16x32_bf16 v[132:135], a[164:167], a[176:179], v[132:135]
    ds_read_b64_tr_b16 a[210:211], v22 offset:4512
    v_mfma_f32_16x16x32_bf16 v[136:139], a[168:171], a[176:179], v[136:139]
    s_add_u32 s64, s64, 1
    s_cmp_eq_u32 s64, 10
    s_cselect_b32 s64, 0, s64
    s_add_u32 m0, s72, 18560
    v_mfma_f32_16x16x32_bf16 v[140:143], a[172:175], a[176:179], v[140:143]
    ds_read_b64_tr_b16 a[212:213], v22 offset:4288
    v_mfma_f32_16x16x32_bf16 v[156:159], a[172:175], a[180:183], v[156:159]
    ds_read_b64_tr_b16 a[214:215], v22 offset:4544
    v_mfma_f32_16x16x32_bf16 v[152:155], a[168:171], a[180:183], v[152:155]
Lpad29:
    s_cbranch_execz Lhret
    buffer_load_dwordx4 v17, s[4:7], s65 offen offset:2560 lds
    v_mfma_f32_16x16x32_bf16 v[148:151], a[164:167], a[180:183], v[148:151]
    ds_read_b64_tr_b16 a[216:217], v22 offset:6368
    v_mfma_f32_16x16x32_bf16 v[144:147], a[160:163], a[180:183], v[144:147]
    ds_read_b64_tr_b16 a[218:219], v22 offset:6624
    v_mfma_f32_16x16x32_bf16 v[160:163], a[160:163], a[184:187], v[160:163]
    ds_write_b128 v9, v[68:71] offset:3104
    v_mfma_f32_16x16x32_bf16 v[164:167], a[164:167], a[184:187], v[164:167]
    ds_read_b64_tr_b16 a[220:221], v22 offset:6400
    s_add_u32 m0, s72, 25280
    v_mfma_f32_16x16x32_bf16 v[168:171], a[168:171], a[184:187], v[168:171]
    ds_read_b64_tr_b16 a[222:223], v22 offset:6656
    v_add_u32 v22, 83808, v20
    v_mfma_f32_16x16x32_bf16 v[172:175], a[172:175], a[184:187], v[172:175]
    buffer_load_dwordx4 v114, s[4:7], s65 offen offset:0 lds
    v_mfma_f32_16x16x32_bf16 v[188:191], a[172:175], a[188:191], v[188:191]
    ds_read_b128 a[224:227], v21 offset:32
    v_mfma_f32_16x16x32_bf16 v[184:187], a[168:171], a[188:191], v[184:187]
    ds_read_b128 a[228:231], v21 offset:288
    v_mfma_f32_16x16x32_bf16 v[180:183], a[164:167], a[188:191], v[180:183]
    buffer_load_dwordx2 v[36:37], v35, s[20:23], 0 offen sc1
    v_mfma_f32_16x16x32_bf16 v[176:179], a[160:163], a[188:191], v[176:179]
    ds_read_b128 a[232:235], v21 offset:8352
    s_add_u32 m0, s72, 26880
    v_mfma_f32_16x16x32_bf16 v[192:195], a[160:163], a[192:195], v[192:195]
    ds_read_b128 a[236:239], v21 offset:8608
    v_mfma_f32_16x16x32_bf16 v[196:199], a[164:167], a[192:195], v[196:199]
    buffer_load_dwordx4 v114, s[4:7], s65 offen offset:2560 lds
    v_mfma_f32_16x16x32_bf16 v[200:203], a[168:171], a[192:195], v[200:203]
    ds_read_b128 a[240:243], v21 offset:16672
    s_add_u32 m0, s72, 33600
    v_mfma_f32_16x16x32_bf16 v[204:207], a[172:175], a[192:195], v[204:207]
    ds_read_b128 a[244:247], v21 offset:16928
    v_add_u32 v21, 83808, v19
    v_mfma_f32_16x16x32_bf16 v[220:223], a[172:175], a[196:199], v[220:223]
    buffer_load_dwordx4 v115, s[4:7], s65 offen offset:0 lds
    v_mfma_f32_16x16x32_bf16 v[216:219], a[168:171], a[196:199], v[216:219]
    s_add_u32 m0, s72, 35200
    v_mfma_f32_16x16x32_bf16 v[212:215], a[164:167], a[196:199], v[212:215]
    buffer_load_dwordx4 v115, s[4:7], s65 offen offset:2560 lds
    v_mfma_f32_16x16x32_bf16 v[208:211], a[160:163], a[196:199], v[208:211]
    s_waitcnt vmcnt(11)
    s_waitcnt lgkmcnt(0)
    s_barrier
    v_mfma_f32_16x16x32_bf16 v[128:131], a[208:211], a[224:227], v[128:131]
    ds_read_b64_tr_b16 a[160:161], v22 offset:0
    v_mfma_f32_16x16x32_bf16 v[132:135], a[212:215], a[224:227], v[132:135]
    ds_read_b64_tr_b16 a[162:163], v22 offset:256
    v_mfma_f32_16x16x32_bf16 v[136:139], a[216:219], a[224:227], v[136:139]
Lpad30:
    s_cbranch_execz Lhret
    ds_write_b128 v13, v[40:43] offset:16736
    v_mfma_f32_16x16x32_bf16 v[140:143], a[220:223], a[224:227], v[140:143]
    ds_read_b64_tr_b16 a[164:165], v22 offset:32
    v_mfma_f32_16x16x32_bf16 v[156:159], a[220:223], a[228:231], v[156:159]
    ds_read_b64_tr_b16 a[166:167], v22 offset:288
    v_mfma_f32_16x16x32_bf16 v[152:155], a[216:219], a[228:231], v[152:155]
    ds_write_b128 v13, v[44:47] offset:17760
    v_mfma_f32_16x16x32_bf16 v[148:151], a[212:215], a[228:231], v[148:151]
    ds_read_b64_tr_b16 a[168:169], v22 offset:2112
    v_mfma_f32_16x16x32_bf16 v[144:147], a[208:211], a[228:231], v[144:147]
    ds_read_b64_tr_b16 a[170:171], v22 offset:2368
    v_mfma_f32_16x16x32_bf16 v[160:163], a[208:211], a[232:235], v[160:163]
    ds_write_b64 v104, v[248:249]
    v_mfma_f32_16x16x32_bf16 v[164:167], a[212:215], a[232:235], v[164:167]
    ds_read_b64_tr_b16 a[172:173], v22 offset:2144
    v_mfma_f32_16x16x32_bf16 v[168:171], a[216:219], a[232:235], v[168:171]
    ds_read_b64_tr_b16 a[174:175], v22 offset:2400
    v_mfma_f32_16x16x32_bf16 v[172:175], a[220:223], a[232:235], v[172:175]
    ds_write_b128 v13, v[48:51] offset:18784
    v_mfma_f32_16x16x32_bf16 v[188:191], a[220:223], a[236:239], v[188:191]
    ds_read_b128 a[176:179], v21 offset:0
    s_waitcnt vmcnt(3)
    v_mfma_f32_16x16x32_bf16 v[184:187], a[216:219], a[236:239], v[184:187]
    ds_read_b128 a[180:183], v21 offset:256
    v_cmp_ne_u64 vcc, s[56:57], v[36:37]
    v_mfma_f32_16x16x32_bf16 v[180:183], a[212:215], a[236:239], v[180:183]
    s_nop 1
    s_cmp_eq_u32 vcc_hi, 0
    s_cbranch_scc0 Lks8
Lkb9:
    v_mfma_f32_16x16x32_bf16 v[176:179], a[208:211], a[236:239], v[176:179]
    ds_read_b128 a[184:187], v21 offset:8320
    v_mfma_f32_16x16x32_bf16 v[192:195], a[208:211], a[240:243], v[192:195]
    ds_read_b128 a[188:191], v21 offset:8576
    v_mfma_f32_16x16x32_bf16 v[196:199], a[212:215], a[240:243], v[196:199]
    s_cmp_eq_u32 vcc_lo, 0
    s_cselect_b32 s79, s80, 2130706432
    v_mfma_f32_16x16x32_bf16 v[200:203], a[216:219], a[240:243], v[200:203]
    ds_read_b128 a[192:195], v21 offset:16640
    v_mfma_f32_16x16x32_bf16 v[204:207], a[220:223], a[240:243], v[204:207]
    ds_read_b128 a[196:199], v21 offset:16896
    v_mfma_f32_16x16x32_bf16 v[220:223], a[220:223], a[244:247], v[220:223]
    buffer_load_dwordx4 v[88:91], v24, s[20:23], s77 offen offset:0 sc1
    v_mfma_f32_16x16x32_bf16 v[216:219], a[216:219], a[244:247], v[216:219]
    buffer_load_dwordx4 v[92:95], v24, s[20:23], s77 offen offset:1024 sc1
    v_mfma_f32_16x16x32_bf16 v[212:215], a[212:215], a[244:247], v[212:215]
    v_mfma_f32_16x16x32_bf16 v[208:211], a[208:211], a[244:247], v[208:211]
    s_waitcnt lgkmcnt(0)
    v_mfma_f32_16x16x32_bf16 v[128:131], a[160:163], a[176:179], v[128:131]
    ds_read_b64_tr_b16 a[208:209], v22 offset:4256
    v_mfma_f32_16x16x32_bf16 v[132:135], a[164:167], a[176:179], v[132:135]
    ds_read_b64_tr_b16 a[210:211], v22 offset:4512
Lpad31:
    s_cbranch_execz Lhret
    v_mfma_f32_16x16x32_bf16 v[136:139], a[168:171], a[176:179], v[136:139]
    buffer_load_dwordx4 v[96:99], v24, s[20:23], s77 offen offset:2048 sc1
    v_mfma_f32_16x16x32_bf16 v[140:143], a[172:175], a[176:179], v[140:143]
    ds_read_b64_tr_b16 a[212:213], v22 offset:4288
    v_mfma_f32_16x16x32_bf16 v[156:159], a[172:175], a[180:183], v[156:159]
    ds_read_b64_tr_b16 a[214:215], v22 offset:4544
    v_mfma_f32_16x16x32_bf16 v[152:155], a[168:171], a[180:183], v[152:155]
    ds_write_b128 v13, v[52:55] offset:19808
    v_mfma_f32_16x16x32_bf16 v[148:151], a[164:167], a[180:183], v[148:151]
    ds_read_b64_tr_b16 a[216:217], v22 offset:6368
    v_mfma_f32_16x16x32_bf16 v[144:147], a[160:163], a[180:183], v[144:147]
    ds_read_b64_tr_b16 a[218:219], v22 offset:6624
    v_mfma_f32_16x16x32_bf16 v[160:163], a[160:163], a[184:187], v[160:163]
    buffer_load_dwordx4 v[100:103], v24, s[20:23], s77 offen offset:3072 sc1
    v_mfma_f32_16x16x32_bf16 v[164:167], a[164:167], a[184:187], v[164:167]
    ds_read_b64_tr_b16 a[220:221], v22 offset:6400
    v_mfma_f32_16x16x32_bf16 v[168:171], a[168:171], a[184:187], v[168:171]
    ds_read_b64_tr_b16 a[222:223], v22 offset:6656
    v_add_u32 v22, 0, v20
    v_mfma_f32_16x16x32_bf16 v[172:175], a[172:175], a[184:187], v[172:175]
    ds_write_b128 v13, v[72:75] offset:32
    v_mfma_f32_16x16x32_bf16 v[188:191], a[172:175], a[188:191], v[188:191]
    ds_read_b128 a[224:227], v21 offset:32
    v_mfma_f32_16x16x32_bf16 v[184:187], a[168:171], a[188:191], v[184:187]
    ds_read_b128 a[228:231], v21 offset:288
    v_mfma_f32_16x16x32_bf16 v[180:183], a[164:167], a[188:191], v[180:183]
    s_add_u32 s70, s79, 0
    buffer_load_dwordx4 a[0:3], v24, s[20:23], s70 offen offset:0 sc1
    v_mfma_f32_16x16x32_bf16 v[176:179], a[160:163], a[188:191], v[176:179]
    ds_read_b128 a[232:235], v21 offset:8352
    v_mfma_f32_16x16x32_bf16 v[192:195], a[160:163], a[192:195], v[192:195]
    ds_read_b128 a[236:239], v21 offset:8608
    v_mfma_f32_16x16x32_bf16 v[196:199], a[164:167], a[192:195], v[196:199]
    buffer_load_dwordx4 a[4:7], v24, s[20:23], s70 offen offset:1024 sc1
    v_mfma_f32_16x16x32_bf16 v[200:203], a[168:171], a[192:195], v[200:203]
    ds_read_b128 a[240:243], v21 offset:16672
    v_mfma_f32_16x16x32_bf16 v[204:207], a[172:175], a[192:195], v[204:207]
    ds_read_b128 a[244:247], v21 offset:16928
    v_add_u32 v21, 0, v19
    v_mfma_f32_16x16x32_bf16 v[220:223], a[172:175], a[196:199], v[220:223]
    buffer_load_dwordx4 a[8:11], v24, s[20:23], s70 offen offset:2048 sc1
    v_mfma_f32_16x16x32_bf16 v[216:219], a[168:171], a[196:199], v[216:219]
    v_mfma_f32_16x16x32_bf16 v[212:215], a[164:167], a[196:199], v[212:215]
    v_mfma_f32_16x16x32_bf16 v[208:211], a[160:163], a[196:199], v[208:211]
    s_waitcnt vmcnt(7)
    s_waitcnt lgkmcnt(0)
    s_barrier
    v_mfma_f32_16x16x32_bf16 v[128:131], a[208:211], a[224:227], v[128:131]
    ds_read_b64_tr_b16 a[160:161], v22 offset:0
    v_mfma_f32_16x16x32_bf16 v[132:135], a[212:215], a[224:227], v[132:135]
    ds_read_b64_tr_b16 a[162:163], v22 offset:256
Lpad32:
    s_cbranch_execz Lhret
    v_mfma_f32_16x16x32_bf16 v[136:139], a[216:219], a[224:227], v[136:139]
    buffer_load_dwordx2 v[36:37], v35, s[20:23], 0 offen sc1
    v_mfma_f32_16x16x32_bf16 v[140:143], a[220:223], a[224:227], v[140:143]
    ds_read_b64_tr_b16 a[164:165], v22 offset:32
    v_mfma_f32_16x16x32_bf16 v[156:159], a[220:223], a[228:231], v[156:159]
    ds_read_b64_tr_b16 a[166:167], v22 offset:288
    v_mfma_f32_16x16x32_bf16 v[152:155], a[216:219], a[228:231], v[152:155]
    s_add_u32 s70, s79, 0
    buffer_load_dwordx4 a[12:15], v24, s[20:23], s70 offen offset:3072 sc1
    v_mfma_f32_16x16x32_bf16 v[148:151], a[212:215], a[228:231], v[148:151]
    ds_read_b64_tr_b16 a[168:169], v22 offset:2112
    v_mfma_f32_16x16x32_bf16 v[144:147], a[208:211], a[228:231], v[144:147]
    ds_read_b64_tr_b16 a[170:171], v22 offset:2368
    v_mfma_f32_16x16x32_bf16 v[160:163], a[208:211], a[232:235], v[160:163]
    ds_write_b128 v13, v[76:79] offset:1056
    v_mfma_f32_16x16x32_bf16 v[164:167], a[212:215], a[232:235], v[164:167]
    ds_read_b64_tr_b16 a[172:173], v22 offset:2144
    v_mfma_f32_16x16x32_bf16 v[168:171], a[216:219], a[232:235], v[168:171]
    ds_read_b64_tr_b16 a[174:175], v22 offset:2400
    v_mfma_f32_16x16x32_bf16 v[172:175], a[220:223], a[232:235], v[172:175]
    s_add_u32 s70, s79, 4096
    buffer_load_dwordx4 a[16:19], v24, s[20:23], s70 offen offset:0 sc1
    v_mfma_f32_16x16x32_bf16 v[188:191], a[220:223], a[236:239], v[188:191]
    ds_read_b128 a[176:179], v21 offset:0
    v_mfma_f32_16x16x32_bf16 v[184:187], a[216:219], a[236:239], v[184:187]
    ds_read_b128 a[180:183], v21 offset:256
    v_mfma_f32_16x16x32_bf16 v[180:183], a[212:215], a[236:239], v[180:183]
    ds_write_b128 v13, v[80:83] offset:2080
    v_mfma_f32_16x16x32_bf16 v[176:179], a[208:211], a[236:239], v[176:179]
    ds_read_b128 a[184:187], v21 offset:8320
    v_mfma_f32_16x16x32_bf16 v[192:195], a[208:211], a[240:243], v[192:195]
    ds_read_b128 a[188:191], v21 offset:8576
    v_mfma_f32_16x16x32_bf16 v[196:199], a[212:215], a[240:243], v[196:199]
    buffer_load_dwordx4 a[20:23], v24, s[20:23], s70 offen offset:1024 sc1
    v_mfma_f32_16x16x32_bf16 v[200:203], a[216:219], a[240:243], v[200:203]
    ds_read_b128 a[192:195], v21 offset:16640
    v_mfma_f32_16x16x32_bf16 v[204:207], a[220:223], a[240:243], v[204:207]
    ds_read_b128 a[196:199], v21 offset:16896
    v_mfma_f32_16x16x32_bf16 v[220:223], a[220:223], a[244:247], v[220:223]
    ds_write_b128 v13, v[84:87] offset:3104
    v_mfma_f32_16x16x32_bf16 v[216:219], a[216:219], a[244:247], v[216:219]
    v_mfma_f32_16x16x32_bf16 v[212:215], a[212:215], a[244:247], v[212:215]
    v_mfma_f32_16x16x32_bf16 v[208:211], a[208:211], a[244:247], v[208:211]
    s_waitcnt lgkmcnt(1)
    v_mfma_f32_16x16x32_bf16 v[128:131], a[160:163], a[176:179], v[128:131]
    ds_read_b64_tr_b16 a[208:209], v22 offset:4256
    v_mfma_f32_16x16x32_bf16 v[132:135], a[164:167], a[176:179], v[132:135]
    ds_read_b64_tr_b16 a[210:211], v22 offset:4512
    v_mfma_f32_16x16x32_bf16 v[136:139], a[168:171], a[176:179], v[136:139]
Lpad33:
    s_cbranch_execz Lhret
    s_add_u32 s70, s79, 4096
    buffer_load_dwordx4 a[24:27], v24, s[20:23], s70 offen offset:2048 sc1
    v_mfma_f32_16x16x32_bf16 v[140:143], a[172:175], a[176:179], v[140:143]
    ds_read_b64_tr_b16 a[212:213], v22 offset:4288
    v_mfma_f32_16x16x32_bf16 v[156:159], a[172:175], a[180:183], v[156:159]
    ds_read_b64_tr_b16 a[214:215], v22 offset:4544
    v_mfma_f32_16x16x32_bf16 v[152:155], a[168:171], a[180:183], v[152:155]
    s_mov_b32 exec_hi, 0
    ds_write_b128 v30, v[248:251]
    s_mov_b32 exec_hi, -1
    v_mfma_f32_16x16x32_bf16 v[148:151], a[164:167], a[180:183], v[148:151]
    ds_read_b64_tr_b16 a[216:217], v22 offset:6368
    v_mfma_f32_16x16x32_bf16 v[144:147], a[160:163], a[180:183], v[144:147]
    ds_read_b64_tr_b16 a[218:219], v22 offset:6624
    v_mfma_f32_16x16x32_bf16 v[160:163], a[160:163], a[184:187], v[160:163]
    buffer_load_dwordx4 a[28:31], v24, s[20:23], s70 offen offset:3072 sc1
    v_mfma_f32_16x16x32_bf16 v[164:167], a[164:167], a[184:187], v[164:167]
    ds_read_b64_tr_b16 a[220:221], v22 offset:6400
    v_mfma_f32_16x16x32_bf16 v[168:171], a[168:171], a[184:187], v[168:171]
    ds_read_b64_tr_b16 a[222:223], v22 offset:6656
    v_mfma_f32_16x16x32_bf16 v[172:175], a[172:175], a[184:187], v[172:175]
    s_waitcnt vmcnt(12)
    ds_write_b128 v30, v[88:91] offset:512
    v_mfma_f32_16x16x32_bf16 v[188:191], a[172:175], a[188:191], v[188:191]
    ds_read_b128 a[224:227], v21 offset:32
    v_mfma_f32_16x16x32_bf16 v[184:187], a[168:171], a[188:191], v[184:187]
    ds_read_b128 a[228:231], v21 offset:288
    v_mfma_f32_16x16x32_bf16 v[180:183], a[164:167], a[188:191], v[180:183]
    s_add_u32 s70, s79, 8192
    buffer_load_dwordx4 a[32:35], v24, s[20:23], s70 offen offset:0 sc1
    v_mfma_f32_16x16x32_bf16 v[176:179], a[160:163], a[188:191], v[176:179]
    ds_read_b128 a[232:235], v21 offset:8352
    v_mfma_f32_16x16x32_bf16 v[192:195], a[160:163], a[192:195], v[192:195]
    ds_read_b128 a[236:239], v21 offset:8608
    v_mfma_f32_16x16x32_bf16 v[196:199], a[164:167], a[192:195], v[196:199]
    s_waitcnt vmcnt(12)
    ds_write_b128 v30, v[92:95] offset:1536
    v_mfma_f32_16x16x32_bf16 v[200:203], a[168:171], a[192:195], v[200:203]
    ds_read_b128 a[240:243], v21 offset:16672
    v_mfma_f32_16x16x32_bf16 v[204:207], a[172:175], a[192:195], v[204:207]
    ds_read_b128 a[244:247], v21 offset:16928
    v_mfma_f32_16x16x32_bf16 v[220:223], a[172:175], a[196:199], v[220:223]
    v_mfma_f32_16x16x32_bf16 v[216:219], a[168:171], a[196:199], v[216:219]
    v_mfma_f32_16x16x32_bf16 v[212:215], a[164:167], a[196:199], v[212:215]
    v_mfma_f32_16x16x32_bf16 v[208:211], a[160:163], a[196:199], v[208:211]
    s_waitcnt lgkmcnt(0)
    s_barrier
    v_mfma_f32_16x16x32_bf16 v[128:131], a[208:211], a[224:227], v[128:131]
    s_waitcnt vmcnt(6)
    v_cmp_ne_u64 vcc, s[56:57], v[36:37]
    v_mfma_f32_16x16x32_bf16 v[132:135], a[212:215], a[224:227], v[132:135]
    s_mov_b32 s71, s79
Lpad34:
    s_cbranch_execz Lhret
    s_nop 0
    v_mfma_f32_16x16x32_bf16 v[136:139], a[216:219], a[224:227], v[136:139]
    s_cmp_eq_u32 vcc_lo, 0
    s_cselect_b32 s79, s80, s79
    v_mfma_f32_16x16x32_bf16 v[140:143], a[220:223], a[224:227], v[140:143]
    s_add_u32 s70, s79, 8192
    buffer_load_dwordx4 a[36:39], v24, s[20:23], s70 offen offset:1024 sc1
    v_mfma_f32_16x16x32_bf16 v[156:159], a[220:223], a[228:231], v[156:159]
    s_waitcnt vmcnt(12)
    ds_write_b128 v30, v[96:99] offset:2560
    v_mfma_f32_16x16x32_bf16 v[152:155], a[216:219], a[228:231], v[152:155]
    buffer_load_dwordx4 a[40:43], v24, s[20:23], s70 offen offset:2048 sc1
    v_mfma_f32_16x16x32_bf16 v[148:151], a[212:215], a[228:231], v[148:151]
    s_waitcnt vmcnt(12)
    ds_write_b128 v30, v[100:103] offset:3584
    v_mfma_f32_16x16x32_bf16 v[144:147], a[208:211], a[228:231], v[144:147]
    buffer_load_dwordx4 a[44:47], v24, s[20:23], s70 offen offset:3072 sc1
    v_mfma_f32_16x16x32_bf16 v[160:163], a[208:211], a[232:235], v[160:163]
    s_add_u32 s70, s79, 12288
    buffer_load_dwordx4 a[48:51], v24, s[20:23], s70 offen offset:0 sc1
    v_mfma_f32_16x16x32_bf16 v[164:167], a[212:215], a[232:235], v[164:167]
    v_mfma_f32_16x16x32_bf16 v[168:171], a[216:219], a[232:235], v[168:171]
    v_mfma_f32_16x16x32_bf16 v[172:175], a[220:223], a[232:235], v[172:175]
    v_mfma_f32_16x16x32_bf16 v[188:191], a[220:223], a[236:239], v[188:191]
    v_mfma_f32_16x16x32_bf16 v[184:187], a[216:219], a[236:239], v[184:187]
    v_mfma_f32_16x16x32_bf16 v[180:183], a[212:215], a[236:239], v[180:183]
    v_mfma_f32_16x16x32_bf16 v[176:179], a[208:211], a[236:239], v[176:179]
    v_mfma_f32_16x16x32_bf16 v[192:195], a[208:211], a[240:243], v[192:195]
    v_mfma_f32_16x16x32_bf16 v[196:199], a[212:215], a[240:243], v[196:199]
    v_mfma_f32_16x16x32_bf16 v[200:203], a[216:219], a[240:243], v[200:203]
    v_mfma_f32_16x16x32_bf16 v[204:207], a[220:223], a[240:243], v[204:207]
    v_mfma_f32_16x16x32_bf16 v[220:223], a[220:223], a[244:247], v[220:223]
    v_mfma_f32_16x16x32_bf16 v[216:219], a[216:219], a[244:247], v[216:219]
    v_mfma_f32_16x16x32_bf16 v[212:215], a[212:215], a[244:247], v[212:215]
    v_mfma_f32_16x16x32_bf16 v[208:211], a[208:211], a[244:247], v[208:211]
    s_mov_b32 s94, 0xbfb8aa3b
    s_mov_b32 s95, 0xbfb8aa3b
    s_mov_b32 s98, 1.0
    s_mov_b32 s99, 1.0
    s_nop 3
    s_add_u32 s70, s79, 12288
    buffer_load_dwordx4 a[52:55], v24, s[20:23], s70 offen offset:1024 sc1
    v_pk_mul_f32 v[40:41], v[128:129], s[94:95]
    v_pk_mul_f32 v[42:43], v[130:131], s[94:95]
    v_pk_mul_f32 v[44:45], v[132:133], s[94:95]
    v_pk_mul_f32 v[46:47], v[134:135], s[94:95]
    v_exp_f32 v40, v40
    v_exp_f32 v41, v41
    v_exp_f32 v42, v42
    v_exp_f32 v43, v43
    v_exp_f32 v44, v44
    v_exp_f32 v45, v45
    v_exp_f32 v46, v46
    v_exp_f32 v47, v47
    v_pk_mul_f32 v[128:129], v[128:129], v[136:137]
    v_pk_mul_f32 v[130:131], v[130:131], v[138:139]
Lpad35:
    s_cbranch_execz Lhret
    v_pk_mul_f32 v[132:133], v[132:133], v[140:141]
    v_pk_mul_f32 v[134:135], v[134:135], v[142:143]
    v_pk_add_f32 v[40:41], v[40:41], s[98:99]
    v_pk_add_f32 v[42:43], v[42:43], s[98:99]
    v_pk_add_f32 v[44:45], v[44:45], s[98:99]
    buffer_load_dwordx4 a[56:59], v24, s[20:23], s70 offen offset:2048 sc1
    v_pk_add_f32 v[46:47], v[46:47], s[98:99]
    v_rcp_f32 v40, v40
    v_rcp_f32 v41, v41
    v_rcp_f32 v42, v42
    v_rcp_f32 v43, v43
    v_rcp_f32 v44, v44
    v_rcp_f32 v45, v45
    v_rcp_f32 v46, v46
    v_rcp_f32 v47, v47
    s_mov_b32 s93, 0
    v_pk_mul_f32 v[128:129], v[128:129], v[40:41]
    v_pk_mul_f32 v[130:131], v[130:131], v[42:43]
    v_pk_mul_f32 v[132:133], v[132:133], v[44:45]
    v_pk_mul_f32 v[134:135], v[134:135], v[46:47]
    v_cvt_pk_bf16_f32 v48, v128, v129
    v_cvt_pk_bf16_f32 v49, v130, v131
    v_cvt_pk_bf16_f32 v50, v132, v133
    v_cvt_pk_bf16_f32 v51, v134, v135
    buffer_store_dwordx4 v[48:51], v23, s[20:23], s93 offen sc1
    s_add_u32 s70, s79, 12288
    buffer_load_dwordx4 a[60:63], v24, s[20:23], s70 offen offset:3072 sc1
    v_pk_mul_f32 v[52:53], v[144:145], s[94:95]
    v_pk_mul_f32 v[54:55], v[146:147], s[94:95]
    v_pk_mul_f32 v[56:57], v[148:149], s[94:95]
    v_pk_mul_f32 v[58:59], v[150:151], s[94:95]
    v_exp_f32 v52, v52
    v_exp_f32 v53, v53
    v_exp_f32 v54, v54
    v_exp_f32 v55, v55
    v_exp_f32 v56, v56
    v_exp_f32 v57, v57
    v_exp_f32 v58, v58
    v_exp_f32 v59, v59
    v_pk_mul_f32 v[144:145], v[144:145], v[152:153]
    v_pk_mul_f32 v[146:147], v[146:147], v[154:155]
    v_pk_mul_f32 v[148:149], v[148:149], v[156:157]
    v_pk_mul_f32 v[150:151], v[150:151], v[158:159]
    v_pk_add_f32 v[52:53], v[52:53], s[98:99]
    v_pk_add_f32 v[54:55], v[54:55], s[98:99]
    v_pk_add_f32 v[56:57], v[56:57], s[98:99]
    s_add_u32 s70, s79, 16384
    buffer_load_dwordx4 a[64:67], v24, s[20:23], s70 offen offset:0 sc1
    v_pk_add_f32 v[58:59], v[58:59], s[98:99]
    v_rcp_f32 v52, v52
    v_rcp_f32 v53, v53
    v_rcp_f32 v54, v54
    v_rcp_f32 v55, v55
    v_rcp_f32 v56, v56
    v_rcp_f32 v57, v57
    v_rcp_f32 v58, v58
    v_rcp_f32 v59, v59
    s_mov_b32 s93, 55296
    v_pk_mul_f32 v[144:145], v[144:145], v[52:53]
    v_pk_mul_f32 v[146:147], v[146:147], v[54:55]
Lpad36:
    s_cbranch_execz Lhret
    v_pk_mul_f32 v[148:149], v[148:149], v[56:57]
    v_pk_mul_f32 v[150:151], v[150:151], v[58:59]
    v_cvt_pk_bf16_f32 v60, v144, v145
    v_cvt_pk_bf16_f32 v61, v146, v147
    v_cvt_pk_bf16_f32 v62, v148, v149
    v_cvt_pk_bf16_f32 v63, v150, v151
    buffer_store_dwordx4 v[60:63], v23, s[20:23], s93 offen sc1
    s_add_u32 s70, s79, 16384
    buffer_load_dwordx4 a[68:71], v24, s[20:23], s70 offen offset:1024 sc1
    v_pk_mul_f32 v[40:41], v[160:161], s[94:95]
    v_pk_mul_f32 v[42:43], v[162:163], s[94:95]
    v_pk_mul_f32 v[44:45], v[164:165], s[94:95]
    v_pk_mul_f32 v[46:47], v[166:167], s[94:95]
    v_exp_f32 v40, v40
    v_exp_f32 v41, v41
    v_exp_f32 v42, v42
    v_exp_f32 v43, v43
    v_exp_f32 v44, v44
    v_exp_f32 v45, v45
    v_exp_f32 v46, v46
    v_exp_f32 v47, v47
    v_pk_mul_f32 v[160:161], v[160:161], v[168:169]
    v_pk_mul_f32 v[162:163], v[162:163], v[170:171]
    v_pk_mul_f32 v[164:165], v[164:165], v[172:173]
    v_pk_mul_f32 v[166:167], v[166:167], v[174:175]
    v_pk_add_f32 v[40:41], v[40:41], s[98:99]
    v_pk_add_f32 v[42:43], v[42:43], s[98:99]
    v_pk_add_f32 v[44:45], v[44:45], s[98:99]
    buffer_load_dwordx4 a[72:75], v24, s[20:23], s70 offen offset:2048 sc1
    v_pk_add_f32 v[46:47], v[46:47], s[98:99]
    v_rcp_f32 v40, v40
    v_rcp_f32 v41, v41
    v_rcp_f32 v42, v42
    v_rcp_f32 v43, v43
    v_rcp_f32 v44, v44
    v_rcp_f32 v45, v45
    v_rcp_f32 v46, v46
    v_rcp_f32 v47, v47
    s_mov_b32 s93, 221184
    v_pk_mul_f32 v[160:161], v[160:161], v[40:41]
    v_pk_mul_f32 v[162:163], v[162:163], v[42:43]
    v_pk_mul_f32 v[164:165], v[164:165], v[44:45]
    v_pk_mul_f32 v[166:167], v[166:167], v[46:47]
    v_cvt_pk_bf16_f32 v48, v160, v161
    v_cvt_pk_bf16_f32 v49, v162, v163
    v_cvt_pk_bf16_f32 v50, v164, v165
    v_cvt_pk_bf16_f32 v51, v166, v167
    buffer_store_dwordx4 v[48:51], v23, s[20:23], s93 offen sc1
    s_add_u32 s70, s79, 16384
    buffer_load_dwordx4 a[76:79], v24, s[20:23], s70 offen offset:3072 sc1
    v_pk_mul_f32 v[52:53], v[176:177], s[94:95]
    v_pk_mul_f32 v[54:55], v[178:179], s[94:95]
    v_pk_mul_f32 v[56:57], v[180:181], s[94:95]
    v_pk_mul_f32 v[58:59], v[182:183], s[94:95]
    v_exp_f32 v52, v52
    v_exp_f32 v53, v53
    v_exp_f32 v54, v54
Lpad37:
    s_cbranch_execz Lhret
    v_exp_f32 v55, v55
    v_exp_f32 v56, v56
    v_exp_f32 v57, v57
    v_exp_f32 v58, v58
    v_exp_f32 v59, v59
    v_pk_mul_f32 v[176:177], v[176:177], v[184:185]
    v_pk_mul_f32 v[178:179], v[178:179], v[186:187]
    v_pk_mul_f32 v[180:181], v[180:181], v[188:189]
    v_pk_mul_f32 v[182:183], v[182:183], v[190:191]
    v_pk_add_f32 v[52:53], v[52:53], s[98:99]
    v_pk_add_f32 v[54:55], v[54:55], s[98:99]
    v_pk_add_f32 v[56:57], v[56:57], s[98:99]
    s_add_u32 s70, s79, 20480
    buffer_load_dwordx4 a[80:83], v24, s[20:23], s70 offen offset:0 sc1
    v_pk_add_f32 v[58:59], v[58:59], s[98:99]
    v_rcp_f32 v52, v52
    v_rcp_f32 v53, v53
    v_rcp_f32 v54, v54
    v_rcp_f32 v55, v55
    v_rcp_f32 v56, v56
    v_rcp_f32 v57, v57
    v_rcp_f32 v58, v58
    v_rcp_f32 v59, v59
    s_mov_b32 s93, 276480
    v_pk_mul_f32 v[176:177], v[176:177], v[52:53]
    v_pk_mul_f32 v[178:179], v[178:179], v[54:55]
    v_pk_mul_f32 v[180:181], v[180:181], v[56:57]
    v_pk_mul_f32 v[182:183], v[182:183], v[58:59]
    v_cvt_pk_bf16_f32 v60, v176, v177
    v_cvt_pk_bf16_f32 v61, v178, v179
    v_cvt_pk_bf16_f32 v62, v180, v181
    v_cvt_pk_bf16_f32 v63, v182, v183
    buffer_store_dwordx4 v[60:63], v23, s[20:23], s93 offen sc1
    s_add_u32 s70, s79, 20480
    buffer_load_dwordx4 a[84:87], v24, s[20:23], s70 offen offset:1024 sc1
    v_pk_mul_f32 v[40:41], v[192:193], s[94:95]
    v_pk_mul_f32 v[42:43], v[194:195], s[94:95]
    v_pk_mul_f32 v[44:45], v[196:197], s[94:95]
    v_pk_mul_f32 v[46:47], v[198:199], s[94:95]
    v_exp_f32 v40, v40
    v_exp_f32 v41, v41
    v_exp_f32 v42, v42
    v_exp_f32 v43, v43
    v_exp_f32 v44, v44
    v_exp_f32 v45, v45
    v_exp_f32 v46, v46
    v_exp_f32 v47, v47
    v_pk_mul_f32 v[192:193], v[192:193], v[200:201]
    v_pk_mul_f32 v[194:195], v[194:195], v[202:203]
    v_pk_mul_f32 v[196:197], v[196:197], v[204:205]
    v_pk_mul_f32 v[198:199], v[198:199], v[206:207]
    v_pk_add_f32 v[40:41], v[40:41], s[98:99]
    v_pk_add_f32 v[42:43], v[42:43], s[98:99]
    v_pk_add_f32 v[44:45], v[44:45], s[98:99]
    buffer_load_dwordx4 a[88:91], v24, s[20:23], s70 offen offset:2048 sc1
    v_pk_add_f32 v[46:47], v[46:47], s[98:99]
    v_rcp_f32 v40, v40
    v_rcp_f32 v41, v41
    v_rcp_f32 v42, v42
    v_rcp_f32 v43, v43
Lpad38:
    s_cbranch_execz Lhret
    v_rcp_f32 v44, v44
    v_rcp_f32 v45, v45
    v_rcp_f32 v46, v46
    v_rcp_f32 v47, v47
    s_mov_b32 s93, 442368
    v_pk_mul_f32 v[192:193], v[192:193], v[40:41]
    v_pk_mul_f32 v[194:195], v[194:195], v[42:43]
    v_pk_mul_f32 v[196:197], v[196:197], v[44:45]
    v_pk_mul_f32 v[198:199], v[198:199], v[46:47]
    v_cvt_pk_bf16_f32 v48, v192, v193
    v_cvt_pk_bf16_f32 v49, v194, v195
    v_cvt_pk_bf16_f32 v50, v196, v197
    v_cvt_pk_bf16_f32 v51, v198, v199
    buffer_store_dwordx4 v[48:51], v23, s[20:23], s93 offen sc1
    s_add_u32 s70, s79, 20480
    buffer_load_dwordx4 a[92:95], v24, s[20:23], s70 offen offset:3072 sc1
    v_pk_mul_f32 v[52:53], v[208:209], s[94:95]
    v_pk_mul_f32 v[54:55], v[210:211], s[94:95]
    v_pk_mul_f32 v[56:57], v[212:213], s[94:95]
    v_pk_mul_f32 v[58:59], v[214:215], s[94:95]
    v_exp_f32 v52, v52
    v_exp_f32 v53, v53
    v_exp_f32 v54, v54
    v_exp_f32 v55, v55
    v_exp_f32 v56, v56
    v_exp_f32 v57, v57
    v_exp_f32 v58, v58
    v_exp_f32 v59, v59
    v_pk_mul_f32 v[208:209], v[208:209], v[216:217]
    v_pk_mul_f32 v[210:211], v[210:211], v[218:219]
    v_pk_mul_f32 v[212:213], v[212:213], v[220:221]
    v_pk_mul_f32 v[214:215], v[214:215], v[222:223]
    v_pk_add_f32 v[52:53], v[52:53], s[98:99]
    v_pk_add_f32 v[54:55], v[54:55], s[98:99]
    v_pk_add_f32 v[56:57], v[56:57], s[98:99]
    s_add_u32 s70, s79, 24576
Lpad39:
    s_cbranch_execz Lhret
    buffer_load_dwordx4 a[96:99], v24, s[20:23], s70 offen offset:0 sc1
    v_pk_add_f32 v[58:59], v[58:59], s[98:99]
    v_rcp_f32 v52, v52
    v_rcp_f32 v53, v53
    v_rcp_f32 v54, v54
    v_rcp_f32 v55, v55
    v_rcp_f32 v56, v56
    v_rcp_f32 v57, v57
    v_rcp_f32 v58, v58
    v_rcp_f32 v59, v59
    s_mov_b32 s93, 497664
    v_pk_mul_f32 v[208:209], v[208:209], v[52:53]
    v_pk_mul_f32 v[210:211], v[210:211], v[54:55]
    v_pk_mul_f32 v[212:213], v[212:213], v[56:57]
    v_pk_mul_f32 v[214:215], v[214:215], v[58:59]
    v_cvt_pk_bf16_f32 v60, v208, v209
    v_cvt_pk_bf16_f32 v61, v210, v211
    v_cvt_pk_bf16_f32 v62, v212, v213
    v_cvt_pk_bf16_f32 v63, v214, v215
    buffer_store_dwordx4 v[60:63], v23, s[20:23], s93 offen sc1
    ds_read_b64_tr_b16 v[72:73], v27 offset:8
    ds_read_b64_tr_b16 v[74:75], v27 offset:0
    ds_read_b128 v[104:107], v28 offset:448
    ds_read_b64_tr_b16 v[76:77], v27 offset:520
    ds_read_b64_tr_b16 v[78:79], v27 offset:512
    ds_read_b128 v[108:111], v28 offset:960
    ds_read_b64_tr_b16 v[80:81], v27 offset:1032
    ds_read_b64_tr_b16 v[82:83], v27 offset:1024
    ds_read_b128 v[112:115], v28 offset:1472
    ds_read_b64_tr_b16 v[84:85], v27 offset:1544
    ds_read_b64_tr_b16 v[86:87], v27 offset:1536
    ds_read_b128 v[116:119], v28 offset:1984
    ds_read_b64_tr_b16 v[88:89], v27 offset:2056
    ds_read_b64_tr_b16 v[90:91], v27 offset:2048
    ds_read_b128 v[120:123], v28 offset:2496
    ds_read_b64_tr_b16 v[92:93], v27 offset:2568
    ds_read_b64_tr_b16 v[94:95], v27 offset:2560
    ds_read_b128 v[124:127], v28 offset:3008
    ds_read_b64_tr_b16 v[96:97], v27 offset:3080
    ds_read_b64_tr_b16 v[98:99], v27 offset:3072
    ds_read_b128 v[128:131], v28 offset:3520
    ds_read_b64_tr_b16 v[100:101], v27 offset:3592
    ds_read_b64_tr_b16 v[102:103], v27 offset:3584
    ds_read_b128 v[132:135], v28 offset:4032
    s_waitcnt lgkmcnt(0)
    v_mfma_f32_16x16x32_bf16 v[40:43], v[252:255], v[104:107], 0
    ds_read_b64_tr_b16 v[136:137], v27 offset:72
    v_mfma_f32_16x16x32_bf16 v[44:47], v[252:255], v[108:111], 0
    ds_read_b64_tr_b16 v[138:139], v27 offset:64
    v_mfma_f32_16x16x32_bf16 v[48:51], v[252:255], v[112:115], 0
    s_add_u32 s70, s79, 24576
    buffer_load_dwordx4 a[100:103], v24, s[20:23], s70 offen offset:1024 sc1
Lpad40:
    s_cbranch_execz Lhret
    v_mfma_f32_16x16x32_bf16 v[52:55], v[252:255], v[116:119], 0
    ds_read_b128 v[168:171], v28 offset:384
    v_mfma_f32_16x16x32_bf16 v[56:59], v[252:255], v[120:123], 0
    ds_read_b64_tr_b16 v[140:141], v27 offset:584
    v_mfma_f32_16x16x32_bf16 v[60:63], v[252:255], v[124:127], 0
    s_mov_b32 s69, s3
    s_mov_b32 s72, 0
    v_mfma_f32_16x16x32_bf16 v[64:67], v[252:255], v[128:131], 0
    ds_read_b64_tr_b16 v[142:143], v27 offset:576
    v_mfma_f32_16x16x32_bf16 v[68:71], v[252:255], v[132:135], 0
    ds_read_b128 v[172:175], v28 offset:896
    v_mfma_f32_16x16x32_bf16 v[40:43], v[72:75], v[104:107], v[40:43]
    s_mov_b32 s73, 0
    s_mov_b32 s74, 7680
    s_mov_b32 s75, 15360
    v_mfma_f32_16x16x32_bf16 v[44:47], v[72:75], v[108:111], v[44:47]
    ds_read_b64_tr_b16 v[144:145], v27 offset:1096
    v_mfma_f32_16x16x32_bf16 v[48:51], v[72:75], v[112:115], v[48:51]
    ds_read_b64_tr_b16 v[146:147], v27 offset:1088
    v_mfma_f32_16x16x32_bf16 v[52:55], v[72:75], v[116:119], v[52:55]
    buffer_load_dwordx4 a[104:107], v24, s[20:23], s70 offen offset:2048 sc1
    v_mfma_f32_16x16x32_bf16 v[56:59], v[72:75], v[120:123], v[56:59]
    ds_read_b128 v[176:179], v28 offset:1408
    s_add_u32 s93, s3, 3
    v_mfma_f32_16x16x32_bf16 v[60:63], v[72:75], v[124:127], v[60:63]
    ds_read_b64_tr_b16 v[148:149], v27 offset:1608
    v_mfma_f32_16x16x32_bf16 v[64:67], v[72:75], v[128:131], v[64:67]
    buffer_load_dwordx4 a[108:111], v24, s[20:23], s70 offen offset:3072 sc1
    v_mfma_f32_16x16x32_bf16 v[68:71], v[72:75], v[132:135], v[68:71]
    ds_read_b64_tr_b16 v[150:151], v27 offset:1600
    s_and_b32 s93, s93, 3
    v_mfma_f32_16x16x32_bf16 v[44:47], v[76:79], v[104:107], v[44:47]
    ds_read_b128 v[180:183], v28 offset:1920
    v_mfma_f32_16x16x32_bf16 v[48:51], v[76:79], v[108:111], v[48:51]
    s_add_u32 s70, s79, 28672
    buffer_load_dwordx4 a[112:115], v24, s[20:23], s70 offen offset:0 sc1
    v_mfma_f32_16x16x32_bf16 v[52:55], v[76:79], v[112:115], v[52:55]
    ds_read_b64_tr_b16 v[152:153], v27 offset:2120
    s_lshl_b32 s93, s93, 4
    v_mfma_f32_16x16x32_bf16 v[56:59], v[76:79], v[116:119], v[56:59]
    ds_read_b64_tr_b16 v[154:155], v27 offset:2112
    v_mfma_f32_16x16x32_bf16 v[60:63], v[76:79], v[120:123], v[60:63]
    buffer_load_dwordx4 a[116:119], v24, s[20:23], s70 offen offset:1024 sc1
    v_mfma_f32_16x16x32_bf16 v[64:67], v[76:79], v[124:127], v[64:67]
    ds_read_b128 v[184:187], v28 offset:2432
    s_lshl_b32 s92, s83, 6
    v_mfma_f32_16x16x32_bf16 v[68:71], v[76:79], v[128:131], v[68:71]
    ds_read_b64_tr_b16 v[156:157], v27 offset:2632
    v_mfma_f32_16x16x32_bf16 v[48:51], v[80:83], v[104:107], v[48:51]
    buffer_load_dwordx4 a[120:123], v24, s[20:23], s70 offen offset:2048 sc1
    v_mfma_f32_16x16x32_bf16 v[52:55], v[80:83], v[108:111], v[52:55]
Lpad41:
    s_cbranch_execz Lhret
    ds_read_b64_tr_b16 v[158:159], v27 offset:2624
    s_add_u32 s93, s93, s92
    v_mfma_f32_16x16x32_bf16 v[56:59], v[80:83], v[112:115], v[56:59]
    ds_read_b128 v[188:191], v28 offset:2944
    v_mfma_f32_16x16x32_bf16 v[60:63], v[80:83], v[116:119], v[60:63]
    buffer_load_dwordx4 a[124:127], v24, s[20:23], s70 offen offset:3072 sc1
    v_mfma_f32_16x16x32_bf16 v[64:67], v[80:83], v[120:123], v[64:67]
    ds_read_b64_tr_b16 v[160:161], v27 offset:3144
    v_mul_u32_u24 v4, 26, v1
    v_mfma_f32_16x16x32_bf16 v[68:71], v[80:83], v[124:127], v[68:71]
    ds_read_b64_tr_b16 v[162:163], v27 offset:3136
    v_mfma_f32_16x16x32_bf16 v[52:55], v[84:87], v[104:107], v[52:55]
    s_add_u32 s70, s79, 32768
    buffer_load_dwordx4 a[128:131], v24, s[20:23], s70 offen offset:0 sc1
    v_mfma_f32_16x16x32_bf16 v[56:59], v[84:87], v[108:111], v[56:59]
    ds_read_b128 v[192:195], v28 offset:3456
    v_lshrrev_b32 v4, 8, v4
    v_mfma_f32_16x16x32_bf16 v[60:63], v[84:87], v[112:115], v[60:63]
    ds_read_b64_tr_b16 v[164:165], v27 offset:3656
    v_mov_b32 v10, s56
    v_mfma_f32_16x16x32_bf16 v[64:67], v[84:87], v[116:119], v[64:67]
    v_mov_b32 v11, s57
    v_lshl_add_u32 v12, v1, 3, s87
    v_mfma_f32_16x16x32_bf16 v[68:71], v[84:87], v[120:123], v[68:71]
    ds_read_b64_tr_b16 v[166:167], v27 offset:3648
    v_mfma_f32_16x16x32_bf16 v[56:59], v[88:91], v[104:107], v[56:59]
    ds_read_b128 v[196:199], v28 offset:3968
    v_mfma_f32_16x16x32_bf16 v[60:63], v[88:91], v[108:111], v[60:63]
    s_waitcnt vmcnt(8)
    s_barrier
    v_mfma_f32_16x16x32_bf16 v[64:67], v[88:91], v[112:115], v[64:67]
    s_mov_b64 exec, 0xffff
    buffer_store_dwordx2 v[10:11], v12, s[20:23], 0 offen sc1
    s_mov_b64 exec, -1
    v_mfma_f32_16x16x32_bf16 v[68:71], v[88:91], v[116:119], v[68:71]
    s_cmp_lg_u32 s71, s80
    s_cbranch_scc1 Lws17
Lwb19:
    v_mfma_f32_16x16x32_bf16 v[60:63], v[92:95], v[104:107], v[60:63]
    v_mfma_f32_16x16x32_bf16 v[64:67], v[92:95], v[108:111], v[64:67]
    v_mfma_f32_16x16x32_bf16 v[68:71], v[92:95], v[112:115], v[68:71]
    v_mfma_f32_16x16x32_bf16 v[64:67], v[96:99], v[104:107], v[64:67]
    v_mfma_f32_16x16x32_bf16 v[68:71], v[96:99], v[108:111], v[68:71]
    v_mfma_f32_16x16x32_bf16 v[68:71], v[100:103], v[104:107], v[68:71]
    s_waitcnt lgkmcnt(0)
    v_mfma_f32_16x16x32_bf16 v[40:43], v[136:139], v[168:171], v[40:43]
    ds_read_b64_tr_b16 v[72:73], v27 offset:136
    v_mfma_f32_16x16x32_bf16 v[44:47], v[136:139], v[172:175], v[44:47]
    ds_read_b64_tr_b16 v[74:75], v27 offset:128
    v_mfma_f32_16x16x32_bf16 v[48:51], v[136:139], v[176:179], v[48:51]
    s_add_u32 s70, s79, 32768
    buffer_load_dwordx4 a[132:135], v24, s[20:23], s70 offen offset:1024 sc1
    v_mfma_f32_16x16x32_bf16 v[52:55], v[136:139], v[180:183], v[52:55]
    ds_read_b128 v[104:107], v28 offset:320
Lpad42:
    s_cbranch_execz Lhret
    v_mul_u32_u24 v5, 10, v4
    v_mfma_f32_16x16x32_bf16 v[56:59], v[136:139], v[184:187], v[56:59]
    ds_read_b64_tr_b16 v[76:77], v27 offset:648
    v_mfma_f32_16x16x32_bf16 v[60:63], v[136:139], v[188:191], v[60:63]
    buffer_load_dwordx4 a[136:139], v24, s[20:23], s70 offen offset:2048 sc1
    v_mfma_f32_16x16x32_bf16 v[64:67], v[136:139], v[192:195], v[64:67]
    ds_read_b64_tr_b16 v[78:79], v27 offset:640
    v_sub_u32 v5, v1, v5
    v_mfma_f32_16x16x32_bf16 v[68:71], v[136:139], v[196:199], v[68:71]
    ds_read_b128 v[108:111], v28 offset:832
    v_mfma_f32_16x16x32_bf16 v[44:47], v[140:143], v[168:171], v[44:47]
    buffer_load_dwordx4 a[140:143], v24, s[20:23], s70 offen offset:3072 sc1
    v_mfma_f32_16x16x32_bf16 v[48:51], v[140:143], v[172:175], v[48:51]
    ds_read_b64_tr_b16 v[80:81], v27 offset:1160
    v_lshlrev_b32 v8, 4, v5
    v_mfma_f32_16x16x32_bf16 v[52:55], v[140:143], v[176:179], v[52:55]
    ds_read_b64_tr_b16 v[82:83], v27 offset:1152
    v_mfma_f32_16x16x32_bf16 v[56:59], v[140:143], v[180:183], v[56:59]
    s_add_u32 s70, s79, 36864
    buffer_load_dwordx4 a[144:147], v24, s[20:23], s70 offen offset:0 sc1
    v_mfma_f32_16x16x32_bf16 v[60:63], v[140:143], v[184:187], v[60:63]
    ds_read_b128 v[112:115], v28 offset:1344
    v_add_u32 v6, s93, v4
    v_mfma_f32_16x16x32_bf16 v[64:67], v[140:143], v[188:191], v[64:67]
    ds_read_b64_tr_b16 v[84:85], v27 offset:1672
    v_mfma_f32_16x16x32_bf16 v[68:71], v[140:143], v[192:195], v[68:71]
    buffer_load_dwordx4 a[148:151], v24, s[20:23], s70 offen offset:1024 sc1
    v_mfma_f32_16x16x32_bf16 v[48:51], v[144:147], v[168:171], v[48:51]
    ds_read_b64_tr_b16 v[86:87], v27 offset:1664
    s_movk_i32 s92, 1280
    v_mfma_f32_16x16x32_bf16 v[52:55], v[144:147], v[172:175], v[52:55]
    ds_read_b128 v[116:119], v28 offset:1856
    v_mfma_f32_16x16x32_bf16 v[56:59], v[144:147], v[176:179], v[56:59]
    buffer_load_dwordx4 a[152:155], v24, s[20:23], s70 offen offset:2048 sc1
    v_mfma_f32_16x16x32_bf16 v[60:63], v[144:147], v[180:183], v[60:63]
    ds_read_b64_tr_b16 v[88:89], v27 offset:2184
    v_mad_u32_u24 v6, v6, s92, v8
    v_mfma_f32_16x16x32_bf16 v[64:67], v[144:147], v[184:187], v[64:67]
    ds_read_b64_tr_b16 v[90:91], v27 offset:2176
    v_mfma_f32_16x16x32_bf16 v[68:71], v[144:147], v[188:191], v[68:71]
    buffer_load_dwordx4 a[156:159], v24, s[20:23], s70 offen offset:3072 sc1
    v_mfma_f32_16x16x32_bf16 v[52:55], v[148:151], v[168:171], v[52:55]
    ds_read_b128 v[120:123], v28 offset:2368
    s_mul_i32 s92, s82, 160
    v_mfma_f32_16x16x32_bf16 v[56:59], v[148:151], v[172:175], v[56:59]
    ds_read_b64_tr_b16 v[92:93], v27 offset:2696
    v_mfma_f32_16x16x32_bf16 v[60:63], v[148:151], v[176:179], v[60:63]
    s_add_u32 s70, s79, 40960
    buffer_load_dwordx4 a[160:163], v24, s[20:23], s70 offen offset:0 sc1
    v_mfma_f32_16x16x32_bf16 v[64:67], v[148:151], v[180:183], v[64:67]
Lpad43:
    s_cbranch_execz Lhret
    ds_read_b64_tr_b16 v[94:95], v27 offset:2688
    v_add_u32 v6, s92, v6
    v_mfma_f32_16x16x32_bf16 v[68:71], v[148:151], v[184:187], v[68:71]
    ds_read_b128 v[124:127], v28 offset:2880
    v_mfma_f32_16x16x32_bf16 v[56:59], v[152:155], v[168:171], v[56:59]
    ds_read_b64_tr_b16 v[96:97], v27 offset:3208
    v_mfma_f32_16x16x32_bf16 v[60:63], v[152:155], v[172:175], v[60:63]
    ds_read_b64_tr_b16 v[98:99], v27 offset:3200
    v_mfma_f32_16x16x32_bf16 v[64:67], v[152:155], v[176:179], v[64:67]
    ds_read_b128 v[128:131], v28 offset:3392
    v_mfma_f32_16x16x32_bf16 v[68:71], v[152:155], v[180:183], v[68:71]
    ds_read_b64_tr_b16 v[100:101], v27 offset:3720
    v_mfma_f32_16x16x32_bf16 v[60:63], v[156:159], v[168:171], v[60:63]
    ds_read_b64_tr_b16 v[102:103], v27 offset:3712
    v_mfma_f32_16x16x32_bf16 v[64:67], v[156:159], v[172:175], v[64:67]
    ds_read_b128 v[132:135], v28 offset:3904
    v_mfma_f32_16x16x32_bf16 v[68:71], v[156:159], v[176:179], v[68:71]
    v_mfma_f32_16x16x32_bf16 v[64:67], v[160:163], v[168:171], v[64:67]
    v_mfma_f32_16x16x32_bf16 v[68:71], v[160:163], v[172:175], v[68:71]
    v_mfma_f32_16x16x32_bf16 v[68:71], v[164:167], v[168:171], v[68:71]
    s_waitcnt lgkmcnt(0)
    v_mfma_f32_16x16x32_bf16 v[40:43], v[72:75], v[104:107], v[40:43]
    ds_read_b64_tr_b16 v[136:137], v27 offset:200
    v_mfma_f32_16x16x32_bf16 v[44:47], v[72:75], v[108:111], v[44:47]
    ds_read_b64_tr_b16 v[138:139], v27 offset:192
    v_mfma_f32_16x16x32_bf16 v[48:51], v[72:75], v[112:115], v[48:51]
    s_add_u32 s70, s79, 40960
    buffer_load_dwordx4 a[164:167], v24, s[20:23], s70 offen offset:1024 sc1
    v_mfma_f32_16x16x32_bf16 v[52:55], v[72:75], v[116:119], v[52:55]
    ds_read_b128 v[168:171], v28 offset:256
    v_mfma_f32_16x16x32_bf16 v[56:59], v[72:75], v[120:123], v[56:59]
    ds_read_b64_tr_b16 v[140:141], v27 offset:712
    v_mfma_f32_16x16x32_bf16 v[60:63], v[72:75], v[124:127], v[60:63]
    v_cmp_gt_u32 vcc, 60, v1
    v_mov_b32 v7, 2130706432
    v_mul_u32_u24 v20, 176, v4
    v_cndmask_b32 v17, v7, v6, vcc
    v_mfma_f32_16x16x32_bf16 v[64:67], v[72:75], v[128:131], v[64:67]
    ds_read_b64_tr_b16 v[142:143], v27 offset:704
    v_mfma_f32_16x16x32_bf16 v[68:71], v[72:75], v[132:135], v[68:71]
    ds_read_b128 v[172:175], v28 offset:768
    v_mfma_f32_16x16x32_bf16 v[44:47], v[76:79], v[104:107], v[44:47]
    buffer_load_dwordx4 a[168:171], v24, s[20:23], s70 offen offset:2048 sc1
    v_mfma_f32_16x16x32_bf16 v[48:51], v[76:79], v[108:111], v[48:51]
    ds_read_b64_tr_b16 v[144:145], v27 offset:1224
    v_mfma_f32_16x16x32_bf16 v[52:55], v[76:79], v[112:115], v[52:55]
    ds_read_b64_tr_b16 v[146:147], v27 offset:1216
    v_mfma_f32_16x16x32_bf16 v[56:59], v[76:79], v[116:119], v[56:59]
    v_cmp_gt_u32 vcc, 40, v1
    s_mul_i32 s92, s3, 3344
Lpad44:
    s_cbranch_execz Lhret
    s_add_u32 s92, s92, 97280
    v_cndmask_b32 v15, v7, v6, vcc
    v_mfma_f32_16x16x32_bf16 v[60:63], v[76:79], v[120:123], v[60:63]
    ds_read_b128 v[176:179], v28 offset:1280
    v_mfma_f32_16x16x32_bf16 v[64:67], v[76:79], v[124:127], v[64:67]
    ds_read_b64_tr_b16 v[148:149], v27 offset:1736
    v_mfma_f32_16x16x32_bf16 v[68:71], v[76:79], v[128:131], v[68:71]
    buffer_load_dwordx4 a[172:175], v24, s[20:23], s70 offen offset:3072 sc1
    v_mfma_f32_16x16x32_bf16 v[48:51], v[80:83], v[104:107], v[48:51]
    ds_read_b64_tr_b16 v[150:151], v27 offset:1728
    v_add3_u32 v20, v20, v8, s92
    v_mfma_f32_16x16x32_bf16 v[52:55], v[80:83], v[108:111], v[52:55]
    ds_read_b128 v[180:183], v28 offset:1792
    v_mfma_f32_16x16x32_bf16 v[56:59], v[80:83], v[112:115], v[56:59]
    s_add_u32 s70, s79, 45056
    buffer_load_dwordx4 a[176:179], v24, s[20:23], s70 offen offset:0 sc1
    v_mfma_f32_16x16x32_bf16 v[60:63], v[80:83], v[116:119], v[60:63]
    ds_read_b64_tr_b16 v[152:153], v27 offset:2248
    v_and_b32 v4, 15, v1
    v_mfma_f32_16x16x32_bf16 v[64:67], v[80:83], v[120:123], v[64:67]
    ds_read_b64_tr_b16 v[154:155], v27 offset:2240
    v_mfma_f32_16x16x32_bf16 v[68:71], v[80:83], v[124:127], v[68:71]
    buffer_load_dwordx4 a[180:183], v24, s[20:23], s70 offen offset:1024 sc1
    v_mfma_f32_16x16x32_bf16 v[52:55], v[84:87], v[104:107], v[52:55]
    ds_read_b128 v[184:187], v28 offset:2304
    v_lshrrev_b32 v5, 4, v1
    v_mfma_f32_16x16x32_bf16 v[56:59], v[84:87], v[108:111], v[56:59]
    ds_read_b64_tr_b16 v[156:157], v27 offset:2760
    v_mfma_f32_16x16x32_bf16 v[60:63], v[84:87], v[112:115], v[60:63]
    buffer_load_dwordx4 a[184:187], v24, s[20:23], s70 offen offset:2048 sc1
    v_mfma_f32_16x16x32_bf16 v[64:67], v[84:87], v[116:119], v[64:67]
    ds_read_b64_tr_b16 v[158:159], v27 offset:2752
    v_mul_u32_u24 v21, 176, v4
    v_mfma_f32_16x16x32_bf16 v[68:71], v[84:87], v[120:123], v[68:71]
    ds_read_b128 v[188:191], v28 offset:2816
    v_mfma_f32_16x16x32_bf16 v[56:59], v[88:91], v[104:107], v[56:59]
    buffer_load_dwordx4 a[188:191], v24, s[20:23], s70 offen offset:3072 sc1
    v_mfma_f32_16x16x32_bf16 v[60:63], v[88:91], v[108:111], v[60:63]
    ds_read_b64_tr_b16 v[160:161], v27 offset:3272
    v_lshl_add_u32 v21, v5, 3, v21
    v_mfma_f32_16x16x32_bf16 v[64:67], v[88:91], v[112:115], v[64:67]
    ds_read_b64_tr_b16 v[162:163], v27 offset:3264
    v_mfma_f32_16x16x32_bf16 v[68:71], v[88:91], v[116:119], v[68:71]
    s_add_u32 s70, s79, 49152
    buffer_load_dwordx4 a[192:195], v24, s[20:23], s70 offen offset:0 sc1
    v_mfma_f32_16x16x32_bf16 v[60:63], v[92:95], v[104:107], v[60:63]
    ds_read_b128 v[192:195], v28 offset:3328
    v_add_u32 v21, s92, v21
    v_mfma_f32_16x16x32_bf16 v[64:67], v[92:95], v[108:111], v[64:67]
    ds_read_b64_tr_b16 v[164:165], v27 offset:3784
Lpad45:
    s_cbranch_execz Lhret
    v_mfma_f32_16x16x32_bf16 v[68:71], v[92:95], v[112:115], v[68:71]
    ds_read_b64_tr_b16 v[166:167], v27 offset:3776
    v_mfma_f32_16x16x32_bf16 v[64:67], v[96:99], v[104:107], v[64:67]
    ds_read_b128 v[196:199], v28 offset:3840
    v_mfma_f32_16x16x32_bf16 v[68:71], v[96:99], v[108:111], v[68:71]
    v_mfma_f32_16x16x32_bf16 v[68:71], v[100:103], v[104:107], v[68:71]
    s_waitcnt lgkmcnt(0)
    v_mfma_f32_16x16x32_bf16 v[40:43], v[136:139], v[168:171], v[40:43]
    ds_read_b64_tr_b16 v[72:73], v27 offset:264
    v_mfma_f32_16x16x32_bf16 v[44:47], v[136:139], v[172:175], v[44:47]
    ds_read_b64_tr_b16 v[74:75], v27 offset:256
    v_mfma_f32_16x16x32_bf16 v[48:51], v[136:139], v[176:179], v[48:51]
    s_add_u32 s70, s79, 49152
    buffer_load_dwordx4 a[196:199], v24, s[20:23], s70 offen offset:1024 sc1
    v_mfma_f32_16x16x32_bf16 v[52:55], v[136:139], v[180:183], v[52:55]
    ds_read_b128 v[104:107], v28 offset:192
    v_add_u32 v6, s93, v4
    v_mfma_f32_16x16x32_bf16 v[56:59], v[136:139], v[184:187], v[56:59]
    ds_read_b64_tr_b16 v[76:77], v27 offset:776
    v_lshlrev_b32 v6, 4, v6
    v_mfma_f32_16x16x32_bf16 v[60:63], v[136:139], v[188:191], v[60:63]
    buffer_load_dwordx4 a[200:203], v24, s[20:23], s70 offen offset:2048 sc1
    v_mfma_f32_16x16x32_bf16 v[64:67], v[136:139], v[192:195], v[64:67]
    ds_read_b64_tr_b16 v[78:79], v27 offset:768
    v_add_u32 v18, 12320768, v6
    v_mfma_f32_16x16x32_bf16 v[68:71], v[136:139], v[196:199], v[68:71]
    ds_read_b128 v[108:111], v28 offset:704
    v_mfma_f32_16x16x32_bf16 v[44:47], v[140:143], v[168:171], v[44:47]
    buffer_load_dwordx4 a[204:207], v24, s[20:23], s70 offen offset:3072 sc1
    v_mfma_f32_16x16x32_bf16 v[48:51], v[140:143], v[172:175], v[48:51]
    ds_read_b64_tr_b16 v[80:81], v27 offset:1288
    s_add_u32 s92, s3, 1
    v_mfma_f32_16x16x32_bf16 v[52:55], v[140:143], v[176:179], v[52:55]
    ds_read_b64_tr_b16 v[82:83], v27 offset:1280
    v_mfma_f32_16x16x32_bf16 v[56:59], v[140:143], v[180:183], v[56:59]
    s_add_u32 s70, s79, 53248
    buffer_load_dwordx4 a[208:211], v24, s[20:23], s70 offen offset:0 sc1
    v_mfma_f32_16x16x32_bf16 v[60:63], v[140:143], v[184:187], v[60:63]
    ds_read_b128 v[112:115], v28 offset:1216
    s_and_b32 s92, s92, 3
    v_mfma_f32_16x16x32_bf16 v[64:67], v[140:143], v[188:191], v[64:67]
    ds_read_b64_tr_b16 v[84:85], v27 offset:1800
    v_mfma_f32_16x16x32_bf16 v[68:71], v[140:143], v[192:195], v[68:71]
    buffer_load_dwordx4 a[212:215], v24, s[20:23], s70 offen offset:1024 sc1
    v_mfma_f32_16x16x32_bf16 v[48:51], v[144:147], v[168:171], v[48:51]
    ds_read_b64_tr_b16 v[86:87], v27 offset:1792
    s_mul_i32 s92, s92, 5120
    v_mfma_f32_16x16x32_bf16 v[52:55], v[144:147], v[172:175], v[52:55]
    ds_read_b128 v[116:119], v28 offset:1728
    v_mfma_f32_16x16x32_bf16 v[56:59], v[144:147], v[176:179], v[56:59]
Lpad46:
    s_cbranch_execz Lhret
    buffer_load_dwordx4 a[216:219], v24, s[20:23], s70 offen offset:2048 sc1
    v_mfma_f32_16x16x32_bf16 v[60:63], v[144:147], v[180:183], v[60:63]
    ds_read_b64_tr_b16 v[88:89], v27 offset:2312
    v_add_u32 v19, s92, v24
    v_mfma_f32_16x16x32_bf16 v[64:67], v[144:147], v[184:187], v[64:67]
    ds_read_b64_tr_b16 v[90:91], v27 offset:2304
    v_mfma_f32_16x16x32_bf16 v[68:71], v[144:147], v[188:191], v[68:71]
    buffer_load_dwordx4 a[220:223], v24, s[20:23], s70 offen offset:3072 sc1
    v_mfma_f32_16x16x32_bf16 v[52:55], v[148:151], v[168:171], v[52:55]
    ds_read_b128 v[120:123], v28 offset:2240
    s_mul_i32 s94, s3, 2880
    v_mfma_f32_16x16x32_bf16 v[56:59], v[148:151], v[172:175], v[56:59]
    ds_read_b64_tr_b16 v[92:93], v27 offset:2824
    v_mfma_f32_16x16x32_bf16 v[60:63], v[148:151], v[176:179], v[60:63]
    ds_read_b64_tr_b16 v[94:95], v27 offset:2816
    v_mfma_f32_16x16x32_bf16 v[64:67], v[148:151], v[180:183], v[64:67]
    ds_read_b128 v[124:127], v28 offset:2752
    v_mfma_f32_16x16x32_bf16 v[68:71], v[148:151], v[184:187], v[68:71]
    ds_read_b64_tr_b16 v[96:97], v27 offset:3336
    v_mfma_f32_16x16x32_bf16 v[56:59], v[152:155], v[168:171], v[56:59]
    ds_read_b64_tr_b16 v[98:99], v27 offset:3328
    v_mfma_f32_16x16x32_bf16 v[60:63], v[152:155], v[172:175], v[60:63]
    ds_read_b128 v[128:131], v28 offset:3264
    v_mfma_f32_16x16x32_bf16 v[64:67], v[152:155], v[176:179], v[64:67]
    ds_read_b64_tr_b16 v[100:101], v27 offset:3848
    v_mfma_f32_16x16x32_bf16 v[68:71], v[152:155], v[180:183], v[68:71]
    ds_read_b64_tr_b16 v[102:103], v27 offset:3840
    v_mfma_f32_16x16x32_bf16 v[60:63], v[156:159], v[168:171], v[60:63]
    ds_read_b128 v[132:135], v28 offset:3776
    v_mfma_f32_16x16x32_bf16 v[64:67], v[156:159], v[172:175], v[64:67]
    v_mfma_f32_16x16x32_bf16 v[68:71], v[156:159], v[176:179], v[68:71]
    v_mfma_f32_16x16x32_bf16 v[64:67], v[160:163], v[168:171], v[64:67]
    v_mfma_f32_16x16x32_bf16 v[68:71], v[160:163], v[172:175], v[68:71]
    v_mfma_f32_16x16x32_bf16 v[68:71], v[164:167], v[168:171], v[68:71]
    s_waitcnt lgkmcnt(0)
    v_mfma_f32_16x16x32_bf16 v[40:43], v[72:75], v[104:107], v[40:43]
    ds_read_b64_tr_b16 v[136:137], v27 offset:328
    v_mfma_f32_16x16x32_bf16 v[44:47], v[72:75], v[108:111], v[44:47]
    ds_read_b64_tr_b16 v[138:139], v27 offset:320
    v_mfma_f32_16x16x32_bf16 v[48:51], v[72:75], v[112:115], v[48:51]
    s_add_u32 s70, s79, 57344
    buffer_load_dwordx4 a[224:227], v24, s[20:23], s70 offen offset:0 sc1
    v_mfma_f32_16x16x32_bf16 v[52:55], v[72:75], v[116:119], v[52:55]
    ds_read_b128 v[168:171], v28 offset:128
    s_add_u32 s94, s94, 84992
    v_mfma_f32_16x16x32_bf16 v[56:59], v[72:75], v[120:123], v[56:59]
    ds_read_b64_tr_b16 v[140:141], v27 offset:840
    v_lshrrev_b32 v4, 3, v1
    v_mfma_f32_16x16x32_bf16 v[60:63], v[72:75], v[124:127], v[60:63]
Lpad47:
    s_cbranch_execz Lhret
    buffer_load_dwordx4 a[228:231], v24, s[20:23], s70 offen offset:1024 sc1
    v_mfma_f32_16x16x32_bf16 v[64:67], v[72:75], v[128:131], v[64:67]
    ds_read_b64_tr_b16 v[142:143], v27 offset:832
    v_and_b32 v5, 7, v1
    v_mfma_f32_16x16x32_bf16 v[68:71], v[72:75], v[132:135], v[68:71]
    ds_read_b128 v[172:175], v28 offset:640
    v_mfma_f32_16x16x32_bf16 v[44:47], v[76:79], v[104:107], v[44:47]
    buffer_load_dwordx4 a[232:235], v24, s[20:23], s70 offen offset:2048 sc1
    v_mfma_f32_16x16x32_bf16 v[48:51], v[76:79], v[108:111], v[48:51]
    ds_read_b64_tr_b16 v[144:145], v27 offset:1352
    v_lshlrev_b32 v6, 4, v5
    v_mfma_f32_16x16x32_bf16 v[52:55], v[76:79], v[112:115], v[52:55]
    ds_read_b64_tr_b16 v[146:147], v27 offset:1344
    v_mfma_f32_16x16x32_bf16 v[56:59], v[76:79], v[116:119], v[56:59]
    buffer_load_dwordx4 a[236:239], v24, s[20:23], s70 offen offset:3072 sc1
    v_mfma_f32_16x16x32_bf16 v[60:63], v[76:79], v[120:123], v[60:63]
    ds_read_b128 v[176:179], v28 offset:1152
    v_mfma_f32_16x16x32_bf16 v[64:67], v[76:79], v[124:127], v[64:67]
    ds_read_b64_tr_b16 v[148:149], v27 offset:1864
    v_mfma_f32_16x16x32_bf16 v[68:71], v[76:79], v[128:131], v[68:71]
    v_cmp_gt_u32 vcc, 32, v1
    v_lshl_add_u32 v9, v4, 12, v6
    v_mov_b32 v8, 2130706432
    v_add_u32 v7, 65536, v9
    v_cndmask_b32 v23, v8, v7, vcc
    v_mfma_f32_16x16x32_bf16 v[48:51], v[80:83], v[104:107], v[48:51]
    ds_read_b64_tr_b16 v[150:151], v27 offset:1856
    v_mfma_f32_16x16x32_bf16 v[52:55], v[80:83], v[108:111], v[52:55]
    ds_read_b128 v[180:183], v28 offset:1664
    v_mfma_f32_16x16x32_bf16 v[56:59], v[80:83], v[112:115], v[56:59]
    s_add_u32 s70, s79, 61440
    buffer_load_dwordx4 a[240:243], v24, s[20:23], s70 offen offset:0 sc1
    v_mfma_f32_16x16x32_bf16 v[60:63], v[80:83], v[116:119], v[60:63]
    ds_read_b64_tr_b16 v[152:153], v27 offset:2376
    v_mul_u32_u24 v4, 144, v4
    v_mfma_f32_16x16x32_bf16 v[64:67], v[80:83], v[120:123], v[64:67]
    ds_read_b64_tr_b16 v[154:155], v27 offset:2368
    v_mfma_f32_16x16x32_bf16 v[68:71], v[80:83], v[124:127], v[68:71]
    buffer_load_dwordx4 a[244:247], v24, s[20:23], s70 offen offset:1024 sc1
    v_mfma_f32_16x16x32_bf16 v[52:55], v[84:87], v[104:107], v[52:55]
    ds_read_b128 v[184:187], v28 offset:2176
    v_add3_u32 v13, v4, v6, s94
    v_mfma_f32_16x16x32_bf16 v[56:59], v[84:87], v[108:111], v[56:59]
    ds_read_b64_tr_b16 v[156:157], v27 offset:2888
    v_mfma_f32_16x16x32_bf16 v[60:63], v[84:87], v[112:115], v[60:63]
    buffer_load_dwordx4 a[248:251], v24, s[20:23], s70 offen offset:2048 sc1
    v_mfma_f32_16x16x32_bf16 v[64:67], v[84:87], v[116:119], v[64:67]
    ds_read_b64_tr_b16 v[158:159], v27 offset:2880
    v_lshrrev_b32 v4, 2, v1
    v_mfma_f32_16x16x32_bf16 v[68:71], v[84:87], v[120:123], v[68:71]
Lpad48:
    s_cbranch_execz Lhret
    ds_read_b128 v[188:191], v28 offset:2688
    v_mfma_f32_16x16x32_bf16 v[56:59], v[88:91], v[104:107], v[56:59]
    ds_read_b64_tr_b16 v[160:161], v27 offset:3400
    v_mfma_f32_16x16x32_bf16 v[60:63], v[88:91], v[108:111], v[60:63]
    ds_read_b64_tr_b16 v[162:163], v27 offset:3392
    v_mfma_f32_16x16x32_bf16 v[64:67], v[88:91], v[112:115], v[64:67]
    ds_read_b128 v[192:195], v28 offset:3200
    v_mfma_f32_16x16x32_bf16 v[68:71], v[88:91], v[116:119], v[68:71]
    ds_read_b64_tr_b16 v[164:165], v27 offset:3912
    v_mfma_f32_16x16x32_bf16 v[60:63], v[92:95], v[104:107], v[60:63]
    ds_read_b64_tr_b16 v[166:167], v27 offset:3904
    v_mfma_f32_16x16x32_bf16 v[64:67], v[92:95], v[108:111], v[64:67]
    ds_read_b128 v[196:199], v28 offset:3712
    v_mfma_f32_16x16x32_bf16 v[68:71], v[92:95], v[112:115], v[68:71]
    v_mfma_f32_16x16x32_bf16 v[64:67], v[96:99], v[104:107], v[64:67]
    v_mfma_f32_16x16x32_bf16 v[68:71], v[96:99], v[108:111], v[68:71]
    v_mfma_f32_16x16x32_bf16 v[68:71], v[100:103], v[104:107], v[68:71]
    s_waitcnt lgkmcnt(0)
    v_mfma_f32_16x16x32_bf16 v[40:43], v[136:139], v[168:171], v[40:43]
    ds_read_b64_tr_b16 v[72:73], v27 offset:392
    v_mfma_f32_16x16x32_bf16 v[44:47], v[136:139], v[172:175], v[44:47]
    ds_read_b64_tr_b16 v[74:75], v27 offset:384
    v_mfma_f32_16x16x32_bf16 v[48:51], v[136:139], v[176:179], v[48:51]
    buffer_load_dwordx2 v[36:37], v32, s[20:23], 0 offen sc1
    v_mfma_f32_16x16x32_bf16 v[52:55], v[136:139], v[180:183], v[52:55]
    ds_read_b128 v[104:107], v28 offset:64
    v_mfma_f32_16x16x32_bf16 v[56:59], v[136:139], v[184:187], v[56:59]
    ds_read_b64_tr_b16 v[76:77], v27 offset:904
    v_mfma_f32_16x16x32_bf16 v[60:63], v[136:139], v[188:191], v[60:63]
    s_add_u32 s70, s79, 61440
    buffer_load_dwordx4 a[252:255], v24, s[20:23], s70 offen offset:3072 sc1
    v_mfma_f32_16x16x32_bf16 v[64:67], v[136:139], v[192:195], v[64:67]
    ds_read_b64_tr_b16 v[78:79], v27 offset:896
    v_mul_u32_u24 v4, 144, v4
    v_mfma_f32_16x16x32_bf16 v[68:71], v[136:139], v[196:199], v[68:71]
    ds_read_b128 v[108:111], v28 offset:576
    v_and_b32 v5, 3, v1
    v_mfma_f32_16x16x32_bf16 v[44:47], v[140:143], v[168:171], v[44:47]
    s_add_u32 s70, s79, 65536
    buffer_load_dwordx4 v[232:235], v24, s[20:23], s70 offen offset:0 sc1
    v_mfma_f32_16x16x32_bf16 v[48:51], v[140:143], v[172:175], v[48:51]
    ds_read_b64_tr_b16 v[80:81], v27 offset:1416
    v_lshl_add_u32 v4, v5, 3, v4
    v_mfma_f32_16x16x32_bf16 v[52:55], v[140:143], v[176:179], v[52:55]
    ds_read_b64_tr_b16 v[82:83], v27 offset:1408
    v_mfma_f32_16x16x32_bf16 v[56:59], v[140:143], v[180:183], v[56:59]
    s_add_u32 s70, s81, 65536
    buffer_load_dwordx4 v[236:239], v24, s[20:23], s70 offen offset:1024 sc1
    v_mfma_f32_16x16x32_bf16 v[60:63], v[140:143], v[184:187], v[60:63]
Lpad49:
    s_cbranch_execz Lhret
    ds_read_b128 v[112:115], v28 offset:1088
    s_add_u32 s94, s3, 3
    v_mfma_f32_16x16x32_bf16 v[64:67], v[140:143], v[188:191], v[64:67]
    ds_read_b64_tr_b16 v[84:85], v27 offset:1928
    v_mfma_f32_16x16x32_bf16 v[68:71], v[140:143], v[192:195], v[68:71]
    buffer_load_dwordx4 v[240:243], v24, s[20:23], s70 offen offset:2048 sc1
    v_mfma_f32_16x16x32_bf16 v[48:51], v[144:147], v[168:171], v[48:51]
    ds_read_b64_tr_b16 v[86:87], v27 offset:1920
    s_and_b32 s94, s94, 3
    v_mfma_f32_16x16x32_bf16 v[52:55], v[144:147], v[172:175], v[52:55]
    ds_read_b128 v[116:119], v28 offset:1600
    v_mfma_f32_16x16x32_bf16 v[56:59], v[144:147], v[176:179], v[56:59]
    buffer_load_dwordx4 v[244:247], v24, s[20:23], s70 offen offset:3072 sc1
    v_mfma_f32_16x16x32_bf16 v[60:63], v[144:147], v[180:183], v[60:63]
    ds_read_b64_tr_b16 v[88:89], v27 offset:2440
    s_lshl_b32 s94, s94, 5
    v_mfma_f32_16x16x32_bf16 v[64:67], v[144:147], v[184:187], v[64:67]
    ds_read_b64_tr_b16 v[90:91], v27 offset:2432
    v_mfma_f32_16x16x32_bf16 v[68:71], v[144:147], v[188:191], v[68:71]
    s_add_u32 s70, s81, 69632
    buffer_load_dwordx4 v[248:251], v24, s[20:23], s70 offen offset:0 sc1
    v_mfma_f32_16x16x32_bf16 v[52:55], v[148:151], v[168:171], v[52:55]
    ds_read_b128 v[120:123], v28 offset:2112
    s_add_u32 s94, s94, 84992
    v_mfma_f32_16x16x32_bf16 v[56:59], v[148:151], v[172:175], v[56:59]
    ds_read_b64_tr_b16 v[92:93], v27 offset:2952
    v_mfma_f32_16x16x32_bf16 v[60:63], v[148:151], v[176:179], v[60:63]
    buffer_load_dwordx4 v[252:255], v24, s[20:23], s70 offen offset:1024 sc1
    v_mfma_f32_16x16x32_bf16 v[64:67], v[148:151], v[180:183], v[64:67]
    ds_read_b64_tr_b16 v[94:95], v27 offset:2944
    v_add_u32 v22, s94, v4
    v_mfma_f32_16x16x32_bf16 v[68:71], v[148:151], v[184:187], v[68:71]
Lpad50:
    s_cbranch_execz Lhret
    ds_read_b128 v[124:127], v28 offset:2624
    v_mfma_f32_16x16x32_bf16 v[56:59], v[152:155], v[168:171], v[56:59]
    buffer_load_dwordx4 v[220:223], v17, s[4:7], 0 offen
    v_mfma_f32_16x16x32_bf16 v[60:63], v[152:155], v[172:175], v[60:63]
    ds_read_b64_tr_b16 v[96:97], v27 offset:3464
    v_mfma_f32_16x16x32_bf16 v[64:67], v[152:155], v[176:179], v[64:67]
    ds_read_b64_tr_b16 v[98:99], v27 offset:3456
    v_mfma_f32_16x16x32_bf16 v[68:71], v[152:155], v[180:183], v[68:71]
    buffer_load_dwordx4 v[224:227], v17, s[4:7], s74 offen
    v_mfma_f32_16x16x32_bf16 v[60:63], v[156:159], v[168:171], v[60:63]
    ds_read_b128 v[128:131], v28 offset:3136
    v_mfma_f32_16x16x32_bf16 v[64:67], v[156:159], v[172:175], v[64:67]
    ds_read_b64_tr_b16 v[100:101], v27 offset:3976
    v_mfma_f32_16x16x32_bf16 v[68:71], v[156:159], v[176:179], v[68:71]
    buffer_load_dwordx4 v[228:231], v15, s[4:7], s75 offen
    v_mfma_f32_16x16x32_bf16 v[64:67], v[160:163], v[168:171], v[64:67]
    ds_read_b64_tr_b16 v[102:103], v27 offset:3968
    v_mfma_f32_16x16x32_bf16 v[68:71], v[160:163], v[172:175], v[68:71]
    ds_read_b128 v[132:135], v28 offset:3648
    v_mfma_f32_16x16x32_bf16 v[68:71], v[164:167], v[168:171], v[68:71]
    s_waitcnt lgkmcnt(0)
    v_mfma_f32_16x16x32_bf16 v[40:43], v[72:75], v[104:107], v[40:43]
    ds_read_b64_tr_b16 v[136:137], v27 offset:456
    v_mfma_f32_16x16x32_bf16 v[44:47], v[72:75], v[108:111], v[44:47]
    ds_read_b64_tr_b16 v[138:139], v27 offset:448
    v_mfma_f32_16x16x32_bf16 v[48:51], v[72:75], v[112:115], v[48:51]
    s_waitcnt vmcnt(10)
    v_cmp_ne_u64 vcc, s[56:57], v[36:37]
    s_nop 1
    v_mfma_f32_16x16x32_bf16 v[52:55], v[72:75], v[116:119], v[52:55]
    ds_read_b128 v[168:171], v28 offset:0
    v_mfma_f32_16x16x32_bf16 v[56:59], v[72:75], v[120:123], v[56:59]
    ds_read_b64_tr_b16 v[140:141], v27 offset:968
    v_mfma_f32_16x16x32_bf16 v[60:63], v[72:75], v[124:127], v[60:63]
    s_cmp_eq_u64 vcc, 0
    s_cselect_b32 s72, 0, 64
    v_mfma_f32_16x16x32_bf16 v[64:67], v[72:75], v[128:131], v[64:67]
    ds_read_b64_tr_b16 v[142:143], v27 offset:960
    v_mfma_f32_16x16x32_bf16 v[68:71], v[72:75], v[132:135], v[68:71]
    ds_read_b128 v[172:175], v28 offset:512
    v_mfma_f32_16x16x32_bf16 v[44:47], v[76:79], v[104:107], v[44:47]
    s_mul_i32 s92, s69, 55296
    s_add_u32 s92, s92, s84
    v_mfma_f32_16x16x32_bf16 v[48:51], v[76:79], v[108:111], v[48:51]
    ds_read_b64_tr_b16 v[144:145], v27 offset:1480
    v_mfma_f32_16x16x32_bf16 v[52:55], v[76:79], v[112:115], v[52:55]
    ds_read_b64_tr_b16 v[146:147], v27 offset:1472
    v_mfma_f32_16x16x32_bf16 v[56:59], v[76:79], v[116:119], v[56:59]
    s_cmp_ge_u32 s72, 64
    s_cselect_b32 s64, 2130706432, s92
    v_mfma_f32_16x16x32_bf16 v[60:63], v[76:79], v[120:123], v[60:63]
    ds_read_b128 v[176:179], v28 offset:1024
Lpad51:
    s_cbranch_execz Lhret
    v_mfma_f32_16x16x32_bf16 v[64:67], v[76:79], v[124:127], v[64:67]
    ds_read_b64_tr_b16 v[148:149], v27 offset:1992
    v_mfma_f32_16x16x32_bf16 v[68:71], v[76:79], v[128:131], v[68:71]
    s_add_u32 s65, s64, 4096
    s_add_u32 s66, s64, 8192
    v_mfma_f32_16x16x32_bf16 v[48:51], v[80:83], v[104:107], v[48:51]
    ds_read_b64_tr_b16 v[150:151], v27 offset:1984
    v_mfma_f32_16x16x32_bf16 v[52:55], v[80:83], v[108:111], v[52:55]
    ds_read_b128 v[180:183], v28 offset:1536
    v_mfma_f32_16x16x32_bf16 v[56:59], v[80:83], v[112:115], v[56:59]
    s_add_u32 s67, s64, 12288
    s_cmp_ge_u32 s3, 2
    s_cselect_b32 s68, 2130706432, s67
    v_mfma_f32_16x16x32_bf16 v[60:63], v[80:83], v[116:119], v[60:63]
    ds_read_b64_tr_b16 v[152:153], v27 offset:2504
    v_mfma_f32_16x16x32_bf16 v[64:67], v[80:83], v[120:123], v[64:67]
    ds_read_b64_tr_b16 v[154:155], v27 offset:2496
    v_mfma_f32_16x16x32_bf16 v[68:71], v[80:83], v[124:127], v[68:71]
    s_add_u32 s69, s69, 1
    s_and_b32 s69, s69, 3
    v_mfma_f32_16x16x32_bf16 v[52:55], v[84:87], v[104:107], v[52:55]
    ds_read_b128 v[184:187], v28 offset:2048
    v_mfma_f32_16x16x32_bf16 v[56:59], v[84:87], v[108:111], v[56:59]
    ds_read_b64_tr_b16 v[156:157], v27 offset:3016
    v_mfma_f32_16x16x32_bf16 v[60:63], v[84:87], v[112:115], v[60:63]
    buffer_load_dwordx4 v[200:203], v24, s[20:23], s64 offen offset:0 sc1
    v_mfma_f32_16x16x32_bf16 v[64:67], v[84:87], v[116:119], v[64:67]
    ds_read_b64_tr_b16 v[158:159], v27 offset:3008
    v_mfma_f32_16x16x32_bf16 v[68:71], v[84:87], v[120:123], v[68:71]
    ds_read_b128 v[188:191], v28 offset:2560
    v_mfma_f32_16x16x32_bf16 v[56:59], v[88:91], v[104:107], v[56:59]
    buffer_load_dwordx4 v[204:207], v24, s[20:23], s64 offen offset:1024 sc1
    v_mfma_f32_16x16x32_bf16 v[60:63], v[88:91], v[108:111], v[60:63]
    ds_read_b64_tr_b16 v[160:161], v27 offset:3528
    v_mfma_f32_16x16x32_bf16 v[64:67], v[88:91], v[112:115], v[64:67]
    ds_read_b64_tr_b16 v[162:163], v27 offset:3520
    v_mfma_f32_16x16x32_bf16 v[68:71], v[88:91], v[116:119], v[68:71]
    buffer_load_dwordx4 v[208:211], v24, s[20:23], s64 offen offset:2048 sc1
    v_mfma_f32_16x16x32_bf16 v[60:63], v[92:95], v[104:107], v[60:63]
    ds_read_b128 v[192:195], v28 offset:3072
    v_mfma_f32_16x16x32_bf16 v[64:67], v[92:95], v[108:111], v[64:67]
    ds_read_b64_tr_b16 v[164:165], v27 offset:4040
    v_mfma_f32_16x16x32_bf16 v[68:71], v[92:95], v[112:115], v[68:71]
    buffer_load_dwordx4 v[212:215], v24, s[20:23], s64 offen offset:3072 sc1
    v_mfma_f32_16x16x32_bf16 v[64:67], v[96:99], v[104:107], v[64:67]
    ds_read_b64_tr_b16 v[166:167], v27 offset:4032
    v_mfma_f32_16x16x32_bf16 v[68:71], v[96:99], v[108:111], v[68:71]
    ds_read_b128 v[196:199], v28 offset:3584
    v_mfma_f32_16x16x32_bf16 v[68:71], v[100:103], v[104:107], v[68:71]
Lpad52:
    s_cbranch_execz Lhret
    buffer_load_dwordx4 v[216:219], v24, s[20:23], s65 offen offset:0 sc1
    s_waitcnt lgkmcnt(0)
    v_mfma_f32_16x16x32_bf16 v[40:43], v[136:139], v[168:171], v[40:43]
    buffer_load_dwordx4 v[72:75], v24, s[20:23], s65 offen offset:1024 sc1
    v_mfma_f32_16x16x32_bf16 v[44:47], v[136:139], v[172:175], v[44:47]
    buffer_load_dwordx4 v[76:79], v24, s[20:23], s65 offen offset:2048 sc1
    v_mfma_f32_16x16x32_bf16 v[44:47], v[140:143], v[168:171], v[44:47]
    buffer_load_dwordx4 v[80:83], v24, s[20:23], s65 offen offset:3072 sc1
    v_mfma_f32_16x16x32_bf16 v[48:51], v[136:139], v[176:179], v[48:51]
    buffer_load_dwordx4 v[84:87], v24, s[20:23], s66 offen offset:0 sc1
    v_mfma_f32_16x16x32_bf16 v[48:51], v[140:143], v[172:175], v[48:51]
    buffer_load_dwordx2 v[36:37], v32, s[20:23], 0 offen sc1
    v_mfma_f32_16x16x32_bf16 v[48:51], v[144:147], v[168:171], v[48:51]
    buffer_load_dwordx4 v[88:91], v24, s[20:23], s66 offen offset:1024 sc1
    v_mfma_f32_16x16x32_bf16 v[52:55], v[136:139], v[180:183], v[52:55]
    v_cvt_pk_bf16_f32 v40, v40, v41
    v_cvt_pk_bf16_f32 v41, v42, v43
    ds_write_b64 v29, v[40:41] offset:0
    v_mfma_f32_16x16x32_bf16 v[52:55], v[140:143], v[176:179], v[52:55]
    v_cvt_pk_bf16_f32 v44, v44, v45
    v_cvt_pk_bf16_f32 v45, v46, v47
    ds_write_b64 v29, v[44:45] offset:512
    v_mfma_f32_16x16x32_bf16 v[52:55], v[144:147], v[172:175], v[52:55]
    v_cvt_pk_bf16_f32 v48, v48, v49
    v_cvt_pk_bf16_f32 v49, v50, v51
    ds_write_b64 v29, v[48:49] offset:1024
    v_mfma_f32_16x16x32_bf16 v[52:55], v[148:151], v[168:171], v[52:55]
    v_mfma_f32_16x16x32_bf16 v[56:59], v[136:139], v[184:187], v[56:59]
    v_mfma_f32_16x16x32_bf16 v[56:59], v[140:143], v[180:183], v[56:59]
    v_mfma_f32_16x16x32_bf16 v[56:59], v[144:147], v[176:179], v[56:59]
    v_mfma_f32_16x16x32_bf16 v[56:59], v[148:151], v[172:175], v[56:59]
    v_mfma_f32_16x16x32_bf16 v[56:59], v[152:155], v[168:171], v[56:59]
    v_mfma_f32_16x16x32_bf16 v[60:63], v[136:139], v[188:191], v[60:63]
    v_mfma_f32_16x16x32_bf16 v[60:63], v[140:143], v[184:187], v[60:63]
    v_mfma_f32_16x16x32_bf16 v[60:63], v[144:147], v[180:183], v[60:63]
    v_mfma_f32_16x16x32_bf16 v[60:63], v[148:151], v[176:179], v[60:63]
    v_cvt_pk_bf16_f32 v52, v52, v53
    v_cvt_pk_bf16_f32 v53, v54, v55
    ds_write_b64 v29, v[52:53] offset:1536
    v_mfma_f32_16x16x32_bf16 v[60:63], v[152:155], v[172:175], v[60:63]
    v_mfma_f32_16x16x32_bf16 v[60:63], v[156:159], v[168:171], v[60:63]
    v_cvt_pk_bf16_f32 v56, v56, v57
    v_cvt_pk_bf16_f32 v57, v58, v59
    ds_write_b64 v29, v[56:57] offset:2048
    v_mfma_f32_16x16x32_bf16 v[64:67], v[136:139], v[192:195], v[64:67]
    v_mfma_f32_16x16x32_bf16 v[64:67], v[140:143], v[188:191], v[64:67]
    v_mfma_f32_16x16x32_bf16 v[64:67], v[144:147], v[184:187], v[64:67]
    v_mfma_f32_16x16x32_bf16 v[64:67], v[148:151], v[180:183], v[64:67]
Lpad53:
    s_cbranch_execz Lhret
    v_mfma_f32_16x16x32_bf16 v[64:67], v[152:155], v[176:179], v[64:67]
    v_mfma_f32_16x16x32_bf16 v[64:67], v[156:159], v[172:175], v[64:67]
    v_cvt_pk_bf16_f32 v60, v60, v61
    v_cvt_pk_bf16_f32 v61, v62, v63
    ds_write_b64 v29, v[60:61] offset:2560
    v_mfma_f32_16x16x32_bf16 v[64:67], v[160:163], v[168:171], v[64:67]
    v_mfma_f32_16x16x32_bf16 v[68:71], v[136:139], v[196:199], v[68:71]
    v_mfma_f32_16x16x32_bf16 v[68:71], v[140:143], v[192:195], v[68:71]
    v_mfma_f32_16x16x32_bf16 v[68:71], v[144:147], v[188:191], v[68:71]
    v_mfma_f32_16x16x32_bf16 v[68:71], v[148:151], v[184:187], v[68:71]
    v_mfma_f32_16x16x32_bf16 v[68:71], v[152:155], v[180:183], v[68:71]
    v_mfma_f32_16x16x32_bf16 v[68:71], v[156:159], v[176:179], v[68:71]
    v_mfma_f32_16x16x32_bf16 v[68:71], v[160:163], v[172:175], v[68:71]
    v_mfma_f32_16x16x32_bf16 v[68:71], v[164:167], v[168:171], v[68:71]
    s_nop 7
    v_cvt_pk_bf16_f32 v64, v64, v65
    v_cvt_pk_bf16_f32 v65, v66, v67
    ds_write_b64 v29, v[64:65] offset:3072
    v_cvt_pk_bf16_f32 v68, v68, v69
    v_cvt_pk_bf16_f32 v69, v70, v71
    ds_write_b64 v29, v[68:69] offset:3584
    s_cmp_lt_u32 s72, 64
    s_cbranch_scc0 Lh2nd
Lh2ndb:
    ds_read_b128 v[168:171], v30 offset:512
    ds_read_b128 v[172:175], v30 offset:1536
    ds_read_b128 v[176:179], v30 offset:2560
    ds_read_b128 v[180:183], v30 offset:3584
    s_add_u32 s92, s77, 2621440
    s_waitcnt lgkmcnt(3)
    buffer_store_dwordx4 v[168:171], v24, s[20:23], s92 offen offset:0 sc1
    s_waitcnt lgkmcnt(2)
    buffer_store_dwordx4 v[172:175], v24, s[20:23], s92 offen offset:1024 sc1
    s_waitcnt lgkmcnt(1)
    buffer_store_dwordx4 v[176:179], v24, s[20:23], s92 offen offset:2048 sc1
    s_waitcnt lgkmcnt(0)
    buffer_store_dwordx4 v[180:183], v24, s[20:23], s92 offen offset:3072 sc1
    s_waitcnt lgkmcnt(0)
    s_cmp_lt_u32 s72, 64
    s_cbranch_scc1 Lg2start
    buffer_load_dwordx2 v[36:37], v32, s[20:23], 0 offen sc1
    s_waitcnt vmcnt(0)
    v_mov_b32 v10, s56
    v_mov_b32 v11, s57
    v_lshl_add_u32 v12, v1, 3, s88
    s_mov_b64 exec, 0xffff
    buffer_store_dwordx2 v[10:11], v12, s[20:23], 0 offen sc1
    s_mov_b64 exec, -1
    s_mov_b32 s96, 0
    s_waitcnt vmcnt(0)
Lpp22:
    v_cmp_ne_u64 vcc, s[56:57], v[36:37]
    s_nop 3
    s_cmp_eq_u64 vcc, 0
    s_cbranch_scc1 Lpd23
    s_sleep 1
    buffer_load_dwordx2 v[36:37], v32, s[20:23], 0 offen sc1
    s_waitcnt vmcnt(0)
    s_add_u32 s96, s96, 1
    s_cmp_lt_u32 s96, 0x8000
    s_cbranch_scc1 Lpp22
Lpd23:
    s_mov_b32 s69, s3
Lpad54:
    s_cbranch_execz Lhret
    s_mov_b32 s72, 0
    s_branch Lg2loads
Lheavy2:
Lpad55:
    s_cbranch_execz Lhret
    s_mov_b32 s34, 2621440
    s_mov_b32 s35, 0x20000
    s_mov_b32 s54, 1280
    s_mov_b32 s55, 0x20000
    s_mov_b32 s18, 2211840
    s_mov_b32 s19, 0x20000
    s_mov_b32 s46, 1280
    s_mov_b32 s47, 0x20000
    s_mov_b32 s38, 2621440
    s_mov_b32 s39, 0x20000
    s_mov_b32 s22, 15204352
    s_mov_b32 s23, 0x20000
    v_bfe_u32 v4, v1, 2, 2
    v_bfe_u32 v5, v1, 1, 1
    v_lshl_add_u32 v4, v5, 2, v4
    v_mul_u32_u24 v4, 1040, v4
    v_and_b32 v5, 1, v1
    v_lshl_add_u32 v4, v5, 7, v4
    v_bfe_u32 v7, v1, 4, 1
    v_lshrrev_b32 v6, 5, v1
    v_lshl_add_u32 v5, v7, 2, v6
    v_lshl_add_u32 v4, v5, 4, v4
    s_lshr_b32 s92, s3, 1
    s_lshl_b32 s92, s92, 9
    s_add_u32 s92, s92, 16960
    v_add_u32 v19, s92, v4
    v_mul_u32_u24 v4, 8512, v7
    v_bfe_u32 v5, v1, 3, 1
    v_mul_u32_u24 v5, 1056, v5
    v_add_u32 v4, v4, v5
    v_bfe_u32 v5, v1, 2, 1
    v_lshl_add_u32 v5, v6, 2, v5
    v_lshl_add_u32 v4, v5, 7, v4
    v_and_b32 v5, 3, v1
    v_lshl_add_u32 v4, v5, 3, v4
    s_and_b32 s92, s3, 1
    s_lshl_b32 s92, s92, 6
    v_add_u32 v20, s92, v4
    v_mov_b32 v21, v19
    v_mov_b32 v22, v20
    s_and_b32 s92, s58, 31
    s_mul_i32 s93, s92, 205
    s_lshr_b32 s93, s93, 10
    s_sub_u32 s95, s92, 20
    s_cmp_lt_u32 s92, 25
    s_cselect_b32 s93, s93, s95
    s_mov_b32 s96, s93
    s_lshr_b32 s92, s58, 5
    s_lshl_b32 s92, s92, 3
    s_add_u32 s92, s92, s93
    s_sub_u32 s92, s92, 4
    s_cmp_ge_u32 s93, 4
    s_cselect_b32 s77, s92, 99
    s_lshl_b32 s94, s3, 11
    s_add_u32 s94, s94, 150672
    s_lshl_b32 s92, s77, 5
    s_lshl_b32 s93, s3, 3
    s_add_u32 s92, s92, s93
    v_lshrrev_b32 v4, 3, v1
    v_add_u32 v125, s92, v4
    v_and_b32 v5, 7, v1
    v_lshlrev_b32 v5, 4, v5
    s_movk_i32 s95, 1280
    v_mad_u32_u24 v112, v125, s95, v5
Lpad56:
    s_cbranch_execz Lhret
    v_add_u32 v124, s94, v5
    s_lshl_b32 s92, s62, 2
    s_add_u32 s92, s92, s3
    s_mul_i32 s93, s92, 6554
    s_lshr_b32 s93, s93, 16
    s_mul_i32 s94, s93, 10
    s_sub_u32 s94, s92, s94
    s_lshl_b32 s79, s94, 2
    s_mul_i32 s91, s93, 5
    s_add_u32 s91, s91, 12416
    s_cmp_lt_u32 s93, 54
    s_cselect_b32 s91, s91, 2080768
    s_lshl_b32 s95, s94, 6
    s_add_u32 s95, s95, s93
    s_lshl_b32 s95, s95, 7
    s_add_u32 s71, s95, 15073280
    s_mul_i32 s67, s93, 40960
    v_lshrrev_b32 v4, 3, v1
    v_mul_u32_u24 v4, 5120, v4
    v_and_b32 v5, 7, v1
    v_lshl_add_u32 v4, v5, 4, v4
    s_lshl_b32 s92, s94, 7
    v_add_u32 v25, s92, v4
    v_bfe_u32 v5, v1, 2, 2
    v_mul_u32_u24 v5, 1056, v5
    v_lshrrev_b32 v6, 4, v1
    v_lshl_add_u32 v5, v6, 7, v5
    v_and_b32 v6, 3, v1
    v_lshl_add_u32 v5, v6, 3, v5
    s_min_u32 s92, s73, 8512
    s_add_u32 s92, s92, 125712
    v_add_u32 v26, s73, v5
    v_lshlrev_b32 v24, 4, v1
    v_add_u32 v39, s73, v24
    s_getpc_b64 s[68:69]
Lq24:
    s_lshl_b32 s92, s3, 2
    s_sub_u32 s92, Lq24-Ltabh-0, s92
    s_sub_u32 s92, s68, s92
    s_subb_u32 s93, s69, 0
    s_add_u32 s68, s68, Lr24-Lq24
    s_addc_u32 s69, s69, 0
    s_mov_b64 exec, 0
    s_setpc_b64 s[92:93]
Lr24:
    s_add_u32 m0, s73, 50224
    s_mul_i32 s66, s64, 221184
    buffer_load_dwordx4 v18, s[8:11], s66 offen lds
    s_add_u32 m0, s73, 51280
    s_nop 0
    buffer_load_dwordx4 v127, s[8:11], s66 offen lds
    s_add_u32 m0, s73, 52336
    s_nop 0
    buffer_load_dwordx4 v18, s[12:15], s66 offen lds
    s_add_u32 m0, s73, 53392
    s_nop 0
    buffer_load_dwordx4 v127, s[12:15], s66 offen lds
    s_add_u32 m0, s72, 67184
    s_lshl_b32 s65, s64, 7
    buffer_load_dwordx4 v17, s[4:7], s65 offen offset:0 lds
    s_add_u32 s64, s64, 1
    s_cmp_eq_u32 s64, 10
    s_cselect_b32 s64, 0, s64
    s_add_u32 m0, s72, 68784
    s_nop 0
    buffer_load_dwordx4 v17, s[4:7], s65 offen offset:2560 lds
    s_add_u32 m0, s72, 75504
    s_nop 0
Lpad57:
    s_cbranch_execz Lhret
    buffer_load_dwordx4 v114, s[4:7], s65 offen offset:0 lds
    s_add_u32 m0, s72, 77104
    s_nop 0
    buffer_load_dwordx4 v114, s[4:7], s65 offen offset:2560 lds
    s_add_u32 m0, s72, 83824
    s_nop 0
    buffer_load_dwordx4 v115, s[4:7], s65 offen offset:0 lds
    s_add_u32 m0, s72, 85424
    s_nop 0
    buffer_load_dwordx4 v115, s[4:7], s65 offen offset:2560 lds
    s_add_u32 m0, s72, 92144
    s_nop 0
    buffer_load_dwordx4 v126, s[4:7], s65 offen offset:0 lds
    s_add_u32 m0, s72, 93744
    s_nop 0
    buffer_load_dwordx4 v126, s[4:7], s65 offen offset:2560 lds
    s_waitcnt vmcnt(12) lgkmcnt(0)
    s_barrier
    ds_read_b64_tr_b16 a[160:161], v22 offset:0
    ds_read_b64_tr_b16 a[162:163], v22 offset:256
    ds_read_b64_tr_b16 a[164:165], v22 offset:32
    ds_read_b64_tr_b16 a[166:167], v22 offset:288
    ds_read_b64_tr_b16 a[168:169], v22 offset:2112
    ds_read_b64_tr_b16 a[170:171], v22 offset:2368
    ds_read_b64_tr_b16 a[172:173], v22 offset:2144
    ds_read_b64_tr_b16 a[174:175], v22 offset:2400
    ds_read_b128 a[176:179], v21 offset:0
    ds_read_b128 a[180:183], v21 offset:256
    ds_read_b128 a[184:187], v21 offset:8320
    ds_read_b128 a[188:191], v21 offset:8576
    ds_read_b128 a[192:195], v21 offset:16640
    ds_read_b128 a[196:199], v21 offset:16896
    ds_read_b128 a[200:203], v21 offset:24960
    ds_read_b128 a[204:207], v21 offset:25216
    s_waitcnt lgkmcnt(0)
    v_mfma_f32_16x16x32_bf16 v[128:131], a[160:163], a[176:179], 0
    ds_read_b64_tr_b16 a[208:209], v22 offset:4256
    v_mfma_f32_16x16x32_bf16 v[132:135], a[164:167], a[176:179], 0
    ds_read_b64_tr_b16 a[210:211], v22 offset:4512
    s_add_u32 m0, s73, 100448
    s_mul_i32 s66, s64, 221184
    v_mfma_f32_16x16x32_bf16 v[136:139], a[168:171], a[176:179], 0
    buffer_load_dwordx4 v18, s[8:11], s66 offen lds
    v_mfma_f32_16x16x32_bf16 v[140:143], a[172:175], a[176:179], 0
    ds_read_b64_tr_b16 a[212:213], v22 offset:4288
    v_mfma_f32_16x16x32_bf16 v[156:159], a[172:175], a[180:183], 0
    ds_read_b64_tr_b16 a[214:215], v22 offset:4544
    v_mfma_f32_16x16x32_bf16 v[152:155], a[168:171], a[180:183], 0
    buffer_load_dwordx4 v[80:83], v25, s[16:19], s67 offen offset:0
    v_mfma_f32_16x16x32_bf16 v[148:151], a[164:167], a[180:183], 0
    ds_read_b64_tr_b16 a[216:217], v22 offset:6368
    v_mfma_f32_16x16x32_bf16 v[144:147], a[160:163], a[180:183], 0
Lpad58:
    s_cbranch_execz Lhret
    ds_read_b64_tr_b16 a[218:219], v22 offset:6624
    v_mfma_f32_16x16x32_bf16 v[160:163], a[160:163], a[184:187], 0
    buffer_load_dwordx4 v[84:87], v25, s[16:19], s67 offen offset:1280
    s_add_u32 m0, s73, 101504
    v_mfma_f32_16x16x32_bf16 v[164:167], a[164:167], a[184:187], 0
    ds_read_b64_tr_b16 a[220:221], v22 offset:6400
    v_mfma_f32_16x16x32_bf16 v[168:171], a[168:171], a[184:187], 0
    ds_read_b64_tr_b16 a[222:223], v22 offset:6656
    v_add_u32 v22, 50224, v20
    v_mfma_f32_16x16x32_bf16 v[172:175], a[172:175], a[184:187], 0
    buffer_load_dwordx4 v127, s[8:11], s66 offen lds
    v_mfma_f32_16x16x32_bf16 v[188:191], a[172:175], a[188:191], 0
    ds_read_b128 a[224:227], v21 offset:32
    v_mfma_f32_16x16x32_bf16 v[184:187], a[168:171], a[188:191], 0
    ds_read_b128 a[228:231], v21 offset:288
    v_mfma_f32_16x16x32_bf16 v[180:183], a[164:167], a[188:191], 0
    buffer_load_dwordx4 v[88:91], v25, s[16:19], s67 offen offset:2560
    v_mfma_f32_16x16x32_bf16 v[176:179], a[160:163], a[188:191], 0
    ds_read_b128 a[232:235], v21 offset:8352
    buffer_load_dwordx4 v[92:95], v25, s[16:19], s67 offen offset:3840
    v_mfma_f32_16x16x32_bf16 v[192:195], a[160:163], a[192:195], 0
    ds_read_b128 a[236:239], v21 offset:8608
    s_add_u32 m0, s73, 102560
    v_mfma_f32_16x16x32_bf16 v[196:199], a[164:167], a[192:195], 0
    buffer_load_dwordx4 v18, s[12:15], s66 offen lds
    v_mfma_f32_16x16x32_bf16 v[200:203], a[168:171], a[192:195], 0
    ds_read_b128 a[240:243], v21 offset:16672
    buffer_load_dwordx2 v[2:3], v16, s[48:51], 0 offen sc1
    v_mfma_f32_16x16x32_bf16 v[204:207], a[172:175], a[192:195], 0
    ds_read_b128 a[244:247], v21 offset:16928
    s_lshr_b32 s92, s61, 4
    s_add_u32 m0, s73, 103616
    v_mfma_f32_16x16x32_bf16 v[220:223], a[172:175], a[196:199], 0
    buffer_load_dwordx4 v127, s[12:15], s66 offen lds
    s_lshr_b32 s93, s3, 1
    s_lshl_b32 s93, s93, 1
    v_mfma_f32_16x16x32_bf16 v[216:219], a[168:171], a[196:199], 0
    ds_read_b128 a[248:251], v21 offset:24992
    s_add_u32 m0, s72, 117408
    s_lshl_b32 s65, s64, 7
    v_mfma_f32_16x16x32_bf16 v[212:215], a[164:167], a[196:199], 0
    ds_read_b128 a[252:255], v21 offset:25248
    v_add_u32 v21, 50224, v19
    v_mfma_f32_16x16x32_bf16 v[208:211], a[160:163], a[196:199], 0
    buffer_load_dwordx4 v17, s[4:7], s65 offen offset:0 lds
    s_add_u32 s92, s92, s93
    s_mul_i32 s92, s92, 54
    v_mfma_f32_16x16x32_bf16 v[224:227], a[160:163], a[200:203], 0
    s_add_u32 s64, s64, 1
    s_cmp_eq_u32 s64, 10
    s_cselect_b32 s64, 0, s64
    s_add_u32 m0, s72, 119008
Lpad59:
    s_cbranch_execz Lhret
    v_mfma_f32_16x16x32_bf16 v[228:231], a[164:167], a[200:203], 0
    buffer_load_dwordx4 v17, s[4:7], s65 offen offset:2560 lds
    s_lshl_b32 s93, s59, 1
    s_add_u32 s92, s92, s93
    s_add_u32 m0, s72, 125728
    v_mfma_f32_16x16x32_bf16 v[232:235], a[168:171], a[200:203], 0
    buffer_load_dwordx4 v114, s[4:7], s65 offen offset:0 lds
    s_and_b32 s93, s3, 1
    s_add_u32 s92, s92, s93
    s_add_u32 m0, s72, 127328
    v_mfma_f32_16x16x32_bf16 v[236:239], a[172:175], a[200:203], 0
    buffer_load_dwordx4 v114, s[4:7], s65 offen offset:2560 lds
    s_lshl_b32 s92, s92, 10
    s_add_u32 s92, s92, 5242880
    s_add_u32 m0, s72, 134048
    v_mfma_f32_16x16x32_bf16 v[252:255], a[172:175], a[204:207], 0
    buffer_load_dwordx4 v115, s[4:7], s65 offen offset:0 lds
    v_lshlrev_b32 v4, 4, v1
    v_add_u32 v23, s92, v4
    s_add_u32 m0, s72, 135648
    v_mfma_f32_16x16x32_bf16 v[248:251], a[168:171], a[204:207], 0
    buffer_load_dwordx4 v115, s[4:7], s65 offen offset:2560 lds
    s_mul_i32 s92, s63, 5
    s_add_u32 s92, s92, s60
    s_add_u32 m0, s72, 142368
    v_mfma_f32_16x16x32_bf16 v[244:247], a[164:167], a[204:207], 0
    buffer_load_dwordx4 v126, s[4:7], s65 offen offset:0 lds
    s_lshl_b32 s92, s92, 5
    s_add_u32 s92, s92, s59
    s_add_u32 m0, s72, 143968
    s_nop 0
    buffer_load_dwordx4 v126, s[4:7], s65 offen offset:2560 lds
    v_mfma_f32_16x16x32_bf16 v[240:243], a[160:163], a[204:207], 0
    s_lshl_b32 s92, s92, 7
    s_add_u32 s92, s92, 12451840
    s_cmp_eq_u32 s3, 0
    s_cselect_b32 s87, s92, 2130706432
    s_lshr_b32 s83, s58, 3
    s_and_b32 s82, s58, 7
    s_mul_i32 s85, s3, 14
    s_cmp_eq_u32 s3, 3
    s_subb_u32 s85, s85, 0
    s_waitcnt vmcnt(17)
    s_waitcnt lgkmcnt(0)
    s_barrier
    v_mfma_f32_16x16x32_bf16 v[128:131], a[208:211], a[224:227], v[128:131]
    ds_read_b64_tr_b16 a[160:161], v22 offset:0
    v_mfma_f32_16x16x32_bf16 v[132:135], a[212:215], a[224:227], v[132:135]
    ds_read_b64_tr_b16 a[162:163], v22 offset:256
    v_mfma_f32_16x16x32_bf16 v[136:139], a[216:219], a[224:227], v[136:139]
    s_add_u32 m0, s73, 0
    s_mul_i32 s66, s64, 221184
    v_mfma_f32_16x16x32_bf16 v[140:143], a[220:223], a[224:227], v[140:143]
    ds_read_b64_tr_b16 a[164:165], v22 offset:32
    v_mfma_f32_16x16x32_bf16 v[156:159], a[220:223], a[228:231], v[156:159]
    ds_read_b64_tr_b16 a[166:167], v22 offset:288
    v_mfma_f32_16x16x32_bf16 v[152:155], a[216:219], a[228:231], v[152:155]
    buffer_load_dwordx4 v18, s[8:11], s66 offen lds
    v_mfma_f32_16x16x32_bf16 v[148:151], a[212:215], a[228:231], v[148:151]
Lpad60:
    s_cbranch_execz Lhret
    ds_read_b64_tr_b16 a[168:169], v22 offset:2112
    s_mul_i32 s86, s3, 5120
    v_mfma_f32_16x16x32_bf16 v[144:147], a[208:211], a[228:231], v[144:147]
    ds_read_b64_tr_b16 a[170:171], v22 offset:2368
    s_mul_i32 s92, s82, 54
    v_mfma_f32_16x16x32_bf16 v[160:163], a[208:211], a[232:235], v[160:163]
    s_add_u32 s92, s92, s85
    s_mul_i32 s92, s92, 5120
    s_add_u32 m0, s73, 1056
    v_mfma_f32_16x16x32_bf16 v[164:167], a[212:215], a[232:235], v[164:167]
    ds_read_b64_tr_b16 a[172:173], v22 offset:2144
    v_mfma_f32_16x16x32_bf16 v[168:171], a[216:219], a[232:235], v[168:171]
    ds_read_b64_tr_b16 a[174:175], v22 offset:2400
    v_mfma_f32_16x16x32_bf16 v[172:175], a[220:223], a[232:235], v[172:175]
    buffer_load_dwordx4 v127, s[8:11], s66 offen lds
    v_mfma_f32_16x16x32_bf16 v[188:191], a[220:223], a[236:239], v[188:191]
    ds_read_b128 a[176:179], v21 offset:0
    s_add_u32 s80, s92, 12713984
    v_mfma_f32_16x16x32_bf16 v[184:187], a[216:219], a[236:239], v[184:187]
    ds_read_b128 a[180:183], v21 offset:256
    v_mfma_f32_16x16x32_bf16 v[180:183], a[212:215], a[236:239], v[180:183]
    s_cmp_ge_u32 s3, 2
    s_cselect_b32 s81, 2130706432, s80
    s_mul_i32 s92, s83, 216
    v_mfma_f32_16x16x32_bf16 v[176:179], a[208:211], a[236:239], v[176:179]
    ds_read_b128 a[184:187], v21 offset:8320
    s_add_u32 s92, s92, s85
    v_mfma_f32_16x16x32_bf16 v[192:195], a[208:211], a[240:243], v[192:195]
    ds_read_b128 a[188:191], v21 offset:8576
    s_add_u32 m0, s73, 2112
    v_mfma_f32_16x16x32_bf16 v[196:199], a[212:215], a[240:243], v[196:199]
    buffer_load_dwordx4 v18, s[12:15], s66 offen lds
    v_mfma_f32_16x16x32_bf16 v[200:203], a[216:219], a[240:243], v[200:203]
    ds_read_b128 a[192:195], v21 offset:16640
    s_lshl_b32 s92, s92, 10
    v_mfma_f32_16x16x32_bf16 v[204:207], a[220:223], a[240:243], v[204:207]
    ds_read_b128 a[196:199], v21 offset:16896
    s_add_u32 s84, s92, 5242880
    v_mfma_f32_16x16x32_bf16 v[220:223], a[220:223], a[244:247], v[220:223]
    s_and_b32 s92, s83, 15
    s_mul_i32 s93, s92, 43
    s_add_u32 m0, s73, 3168
    v_mfma_f32_16x16x32_bf16 v[216:219], a[216:219], a[244:247], v[216:219]
    ds_read_b128 a[200:203], v21 offset:24960
    v_mfma_f32_16x16x32_bf16 v[212:215], a[212:215], a[244:247], v[212:215]
    ds_read_b128 a[204:207], v21 offset:25216
    v_mfma_f32_16x16x32_bf16 v[208:211], a[208:211], a[244:247], v[208:211]
    buffer_load_dwordx4 v127, s[12:15], s66 offen lds
    v_mfma_f32_16x16x32_bf16 v[224:227], a[208:211], a[248:251], v[224:227]
    s_lshr_b32 s93, s93, 7
    s_min_u32 s93, s93, 4
    s_lshr_b32 s92, s92, 2
    v_mfma_f32_16x16x32_bf16 v[228:231], a[212:215], a[248:251], v[228:231]
Lpad61:
    s_cbranch_execz Lhret
    s_lshr_b32 s94, s83, 4
    s_add_u32 m0, s72, 16960
    s_lshl_b32 s65, s64, 7
    v_mfma_f32_16x16x32_bf16 v[232:235], a[216:219], a[248:251], v[232:235]
    buffer_load_dwordx4 v17, s[4:7], s65 offen offset:0 lds
    v_mfma_f32_16x16x32_bf16 v[236:239], a[220:223], a[248:251], v[236:239]
    s_mul_i32 s94, s94, 5
    s_add_u32 s92, s92, s94
    s_add_u32 s93, s93, s94
    v_mfma_f32_16x16x32_bf16 v[252:255], a[220:223], a[252:255], v[252:255]
    v_and_b32 v8, 31, v1
    v_mfma_f32_16x16x32_bf16 v[248:251], a[216:219], a[252:255], v[248:251]
    s_add_u32 s64, s64, 1
    s_cmp_eq_u32 s64, 10
    s_cselect_b32 s64, 0, s64
    s_add_u32 m0, s72, 18560
    v_mfma_f32_16x16x32_bf16 v[244:247], a[212:215], a[252:255], v[244:247]
    buffer_load_dwordx4 v17, s[4:7], s65 offen offset:2560 lds
    v_min_u32 v7, 26, v8
    v_mfma_f32_16x16x32_bf16 v[240:243], a[208:211], a[252:255], v[240:243]
    v_cmp_gt_u32 vcc, 20, v7
    v_mov_b32 v4, s92
    v_mov_b32 v5, s93
    v_cndmask_b32 v6, v4, v5, vcc
    v_lshl_add_u32 v7, v6, 5, v7
    v_lshlrev_b32 v7, 7, v7
    s_waitcnt lgkmcnt(0)
    v_mfma_f32_16x16x32_bf16 v[128:131], a[160:163], a[176:179], v[128:131]
    ds_read_b64_tr_b16 a[208:209], v22 offset:4256
    s_add_u32 m0, s72, 25280
    v_mfma_f32_16x16x32_bf16 v[132:135], a[164:167], a[176:179], v[132:135]
    ds_read_b64_tr_b16 a[210:211], v22 offset:4512
    v_mfma_f32_16x16x32_bf16 v[136:139], a[168:171], a[176:179], v[136:139]
    buffer_load_dwordx4 v114, s[4:7], s65 offen offset:0 lds
    v_mfma_f32_16x16x32_bf16 v[140:143], a[172:175], a[176:179], v[140:143]
    ds_read_b64_tr_b16 a[212:213], v22 offset:4288
Lpad62:
    s_cbranch_execz Lhret
    v_add_u32 v32, 12451840, v7
    v_mfma_f32_16x16x32_bf16 v[156:159], a[172:175], a[180:183], v[156:159]
    ds_read_b64_tr_b16 a[214:215], v22 offset:4544
    s_lshl_b32 s92, s83, 3
    v_mfma_f32_16x16x32_bf16 v[152:155], a[168:171], a[180:183], v[152:155]
    v_and_b32 v9, 7, v1
    v_add_u32 v9, s92, v9
    s_add_u32 m0, s72, 26880
    v_mfma_f32_16x16x32_bf16 v[148:151], a[164:167], a[180:183], v[148:151]
    ds_read_b64_tr_b16 a[216:217], v22 offset:6368
    v_mfma_f32_16x16x32_bf16 v[144:147], a[160:163], a[180:183], v[144:147]
    ds_read_b64_tr_b16 a[218:219], v22 offset:6624
    v_mfma_f32_16x16x32_bf16 v[160:163], a[160:163], a[184:187], v[160:163]
    buffer_load_dwordx4 v114, s[4:7], s65 offen offset:2560 lds
    v_mfma_f32_16x16x32_bf16 v[164:167], a[164:167], a[184:187], v[164:167]
    ds_read_b64_tr_b16 a[220:221], v22 offset:6400
    v_lshlrev_b32 v9, 7, v9
    v_mfma_f32_16x16x32_bf16 v[168:171], a[168:171], a[184:187], v[168:171]
    ds_read_b64_tr_b16 a[222:223], v22 offset:6656
    v_add_u32 v22, 100448, v20
    v_mfma_f32_16x16x32_bf16 v[172:175], a[172:175], a[184:187], v[172:175]
    v_add_u32 v9, 12517376, v9
    s_mul_i32 s92, s82, 80
    s_mul_i32 s93, s3, 20
    v_mfma_f32_16x16x32_bf16 v[188:191], a[172:175], a[188:191], v[188:191]
    ds_read_b128 a[224:227], v21 offset:32
    s_add_u32 m0, s72, 33600
    v_mfma_f32_16x16x32_bf16 v[184:187], a[168:171], a[188:191], v[184:187]
    ds_read_b128 a[228:231], v21 offset:288
    v_mfma_f32_16x16x32_bf16 v[180:183], a[164:167], a[188:191], v[180:183]
    buffer_load_dwordx4 v115, s[4:7], s65 offen offset:0 lds
    v_mfma_f32_16x16x32_bf16 v[176:179], a[160:163], a[188:191], v[176:179]
    ds_read_b128 a[232:235], v21 offset:8352
    s_add_u32 s92, s92, s93
    v_mfma_f32_16x16x32_bf16 v[192:195], a[160:163], a[192:195], v[192:195]
    ds_read_b128 a[236:239], v21 offset:8608
    v_min_u32 v5, 19, v8
    v_mfma_f32_16x16x32_bf16 v[196:199], a[164:167], a[192:195], v[196:199]
    v_add_u32 v5, s92, v5
    v_lshlrev_b32 v5, 7, v5
    s_add_u32 m0, s72, 35200
    v_mfma_f32_16x16x32_bf16 v[200:203], a[168:171], a[192:195], v[200:203]
    ds_read_b128 a[240:243], v21 offset:16672
    v_mfma_f32_16x16x32_bf16 v[204:207], a[172:175], a[192:195], v[204:207]
    ds_read_b128 a[244:247], v21 offset:16928
    v_mfma_f32_16x16x32_bf16 v[220:223], a[172:175], a[196:199], v[220:223]
    buffer_load_dwordx4 v115, s[4:7], s65 offen offset:2560 lds
    v_mfma_f32_16x16x32_bf16 v[216:219], a[168:171], a[196:199], v[216:219]
    ds_read_b128 a[248:251], v21 offset:24992
    v_mfma_f32_16x16x32_bf16 v[212:215], a[164:167], a[196:199], v[212:215]
    ds_read_b128 a[252:255], v21 offset:25248
    v_add_u32 v21, 100448, v19
Lpad63:
    s_cbranch_execz Lhret
    v_mfma_f32_16x16x32_bf16 v[208:211], a[160:163], a[196:199], v[208:211]
    v_cmp_lt_u32 vcc, 31, v1
    v_add_u32 v5, 14942208, v5
    s_lshl_b32 s92, s92, 12
    v_cndmask_b32 v38, v5, v9, vcc
    v_mfma_f32_16x16x32_bf16 v[224:227], a[160:163], a[200:203], v[224:227]
    s_lshl_b32 s93, s83, 7
    s_add_u32 s92, s92, s93
    s_add_u32 s90, s92, 2621440
    v_mfma_f32_16x16x32_bf16 v[228:231], a[164:167], a[200:203], v[228:231]
    s_add_u32 m0, s72, 41920
    v_mfma_f32_16x16x32_bf16 v[232:235], a[168:171], a[200:203], v[232:235]
    buffer_load_dwordx4 v126, s[4:7], s65 offen offset:0 lds
    v_mfma_f32_16x16x32_bf16 v[236:239], a[172:175], a[200:203], v[236:239]
    v_lshlrev_b32 v24, 4, v1
    v_and_b32 v4, 15, v1
    v_mfma_f32_16x16x32_bf16 v[252:255], a[172:175], a[204:207], v[252:255]
    v_lshrrev_b32 v6, 4, v1
    v_add_u32 v33, s86, v24
    s_add_u32 m0, s72, 43520
    v_mfma_f32_16x16x32_bf16 v[248:251], a[168:171], a[204:207], v[248:251]
    buffer_load_dwordx4 v126, s[4:7], s65 offen offset:2560 lds
    v_mfma_f32_16x16x32_bf16 v[244:247], a[164:167], a[204:207], v[244:247]
    s_mul_i32 s92, s82, 5
    v_and_b32 v5, 1, v6
    v_lshlrev_b32 v5, 2, v5
    v_mfma_f32_16x16x32_bf16 v[240:243], a[160:163], a[204:207], v[240:243]
    v_add_u32 v5, s92, v5
    s_waitcnt vmcnt(12)
    s_waitcnt lgkmcnt(0)
    s_barrier
    v_mfma_f32_16x16x32_bf16 v[128:131], a[208:211], a[224:227], v[128:131]
    ds_read_b64_tr_b16 a[160:161], v22 offset:0
    v_mfma_f32_16x16x32_bf16 v[132:135], a[212:215], a[224:227], v[132:135]
    ds_read_b64_tr_b16 a[162:163], v22 offset:256
    v_mfma_f32_16x16x32_bf16 v[136:139], a[216:219], a[224:227], v[136:139]
    s_add_u32 m0, s72, 67184
    s_lshl_b32 s65, s64, 7
    v_mfma_f32_16x16x32_bf16 v[140:143], a[220:223], a[224:227], v[140:143]
    ds_read_b64_tr_b16 a[164:165], v22 offset:32
    v_mfma_f32_16x16x32_bf16 v[156:159], a[220:223], a[228:231], v[156:159]
    ds_read_b64_tr_b16 a[166:167], v22 offset:288
    v_mfma_f32_16x16x32_bf16 v[152:155], a[216:219], a[228:231], v[152:155]
    buffer_load_dwordx4 v17, s[4:7], s65 offen offset:0 lds
    v_mfma_f32_16x16x32_bf16 v[148:151], a[212:215], a[228:231], v[148:151]
    ds_read_b64_tr_b16 a[168:169], v22 offset:2112
    s_waitcnt vmcnt(24)
    v_mfma_f32_16x16x32_bf16 v[144:147], a[208:211], a[228:231], v[144:147]
    ds_read_b64_tr_b16 a[170:171], v22 offset:2368
    v_mfma_f32_16x16x32_bf16 v[160:163], a[208:211], a[232:235], v[160:163]
    ds_write_b128 v39, v[80:83] offset:50224
    v_mfma_f32_16x16x32_bf16 v[164:167], a[212:215], a[232:235], v[164:167]
    ds_read_b64_tr_b16 a[172:173], v22 offset:2144
    v_mfma_f32_16x16x32_bf16 v[168:171], a[216:219], a[232:235], v[168:171]
    ds_read_b64_tr_b16 a[174:175], v22 offset:2400
    v_mfma_f32_16x16x32_bf16 v[172:175], a[220:223], a[232:235], v[172:175]
    ds_write_b128 v39, v[84:87] offset:51280
Lpad64:
    s_cbranch_execz Lhret
    v_mfma_f32_16x16x32_bf16 v[188:191], a[220:223], a[236:239], v[188:191]
    ds_read_b128 a[176:179], v21 offset:0
    v_mfma_f32_16x16x32_bf16 v[184:187], a[216:219], a[236:239], v[184:187]
    ds_read_b128 a[180:183], v21 offset:256
    v_mfma_f32_16x16x32_bf16 v[180:183], a[212:215], a[236:239], v[180:183]
    ds_write_b128 v39, v[88:91] offset:52336
    v_mfma_f32_16x16x32_bf16 v[176:179], a[208:211], a[236:239], v[176:179]
    ds_read_b128 a[184:187], v21 offset:8320
    s_add_u32 m0, s72, 68784
    s_mul_i32 s66, s64, 221184
    v_mfma_f32_16x16x32_bf16 v[192:195], a[208:211], a[240:243], v[192:195]
    ds_read_b128 a[188:191], v21 offset:8576
    v_mfma_f32_16x16x32_bf16 v[196:199], a[212:215], a[240:243], v[196:199]
    buffer_load_dwordx4 v17, s[4:7], s65 offen offset:2560 lds
    v_mfma_f32_16x16x32_bf16 v[200:203], a[216:219], a[240:243], v[200:203]
    ds_read_b128 a[192:195], v21 offset:16640
    v_mfma_f32_16x16x32_bf16 v[204:207], a[220:223], a[240:243], v[204:207]
    ds_read_b128 a[196:199], v21 offset:16896
    v_mfma_f32_16x16x32_bf16 v[220:223], a[220:223], a[244:247], v[220:223]
    ds_write_b128 v39, v[92:95] offset:53392
    v_mfma_f32_16x16x32_bf16 v[216:219], a[216:219], a[244:247], v[216:219]
    ds_read_b128 a[200:203], v21 offset:24960
    ds_read_b64_tr_b16 a[144:145], v26 offset:50224
    v_mfma_f32_16x16x32_bf16 v[212:215], a[212:215], a[244:247], v[212:215]
    ds_read_b128 a[204:207], v21 offset:25216
    ds_read_b64_tr_b16 a[146:147], v26 offset:50736
    v_mfma_f32_16x16x32_bf16 v[208:211], a[208:211], a[244:247], v[208:211]
    ds_read_b64_tr_b16 a[148:149], v26 offset:50256
    s_add_u32 m0, s72, 75504
    v_mfma_f32_16x16x32_bf16 v[224:227], a[208:211], a[248:251], v[224:227]
    buffer_load_dwordx4 v114, s[4:7], s65 offen offset:0 lds
    v_mfma_f32_16x16x32_bf16 v[228:231], a[212:215], a[248:251], v[228:231]
    ds_read_b64_tr_b16 a[150:151], v26 offset:50768
    ds_read_b64_tr_b16 a[152:153], v26 offset:50288
    v_mfma_f32_16x16x32_bf16 v[232:235], a[216:219], a[248:251], v[232:235]
    ds_read_b64_tr_b16 a[154:155], v26 offset:50800
    ds_read_b64_tr_b16 a[156:157], v26 offset:50320
    s_add_u32 m0, s72, 77104
    v_mfma_f32_16x16x32_bf16 v[236:239], a[220:223], a[248:251], v[236:239]
    buffer_load_dwordx4 v114, s[4:7], s65 offen offset:2560 lds
    ds_read_b64_tr_b16 a[158:159], v26 offset:50832
    v_mfma_f32_16x16x32_bf16 v[252:255], a[220:223], a[252:255], v[252:255]
    v_lshrrev_b32 v5, 2, v5
    v_min_u32 v7, 13, v4
    v_add_u32 v7, s85, v7
    s_add_u32 m0, s72, 83824
    v_mfma_f32_16x16x32_bf16 v[248:251], a[216:219], a[252:255], v[248:251]
    buffer_load_dwordx4 v115, s[4:7], s65 offen offset:0 lds
    v_min_u32 v7, 53, v7
    v_lshl_add_u32 v5, v5, 6, v7
Lpad65:
    s_cbranch_execz Lhret
    v_lshlrev_b32 v5, 7, v5
    v_mfma_f32_16x16x32_bf16 v[244:247], a[212:215], a[252:255], v[244:247]
    v_add_u32 v35, 15073280, v5
    s_add_u32 s64, s64, 1
    s_cmp_eq_u32 s64, 10
    s_cselect_b32 s64, 0, s64
    s_add_u32 m0, s72, 85424
    v_mfma_f32_16x16x32_bf16 v[240:243], a[208:211], a[252:255], v[240:243]
    buffer_load_dwordx4 v115, s[4:7], s65 offen offset:2560 lds
    s_lshl_b32 s92, s77, 2
    s_add_u32 s92, s92, s3
    s_lshl_b32 s92, s92, 7
    s_add_u32 s88, s92, 12517376
    s_waitcnt lgkmcnt(7)
    v_mfma_f32_16x16x32_bf16 v[128:131], a[160:163], a[176:179], v[128:131]
    ds_read_b64_tr_b16 a[208:209], v22 offset:4256
    s_add_u32 m0, s72, 92144
    v_mfma_f32_16x16x32_bf16 v[132:135], a[164:167], a[176:179], v[132:135]
    ds_read_b64_tr_b16 a[210:211], v22 offset:4512
    v_mfma_f32_16x16x32_bf16 v[136:139], a[168:171], a[176:179], v[136:139]
    buffer_load_dwordx4 v126, s[4:7], s65 offen offset:0 lds
    v_mfma_f32_16x16x32_bf16 v[140:143], a[172:175], a[176:179], v[140:143]
    ds_read_b64_tr_b16 a[212:213], v22 offset:4288
    s_waitcnt lgkmcnt(3)
    v_mfma_f32_16x16x32_bf16 v[156:159], a[172:175], a[180:183], v[156:159]
    ds_read_b64_tr_b16 a[214:215], v22 offset:4544
    s_add_u32 m0, s72, 93744
    v_mfma_f32_16x16x32_bf16 v[152:155], a[168:171], a[180:183], v[152:155]
    buffer_load_dwordx4 v126, s[4:7], s65 offen offset:2560 lds
    v_mfma_f32_16x16x32_bf16 v[148:151], a[164:167], a[180:183], v[148:151]
    ds_read_b64_tr_b16 a[216:217], v22 offset:6368
    v_mfma_f32_16x16x32_bf16 v[144:147], a[160:163], a[180:183], v[144:147]
    ds_read_b64_tr_b16 a[218:219], v22 offset:6624
    v_mfma_f32_16x16x32_bf16 v[160:163], a[160:163], a[184:187], v[160:163]
    s_add_u32 s70, s79, 0
    s_mul_i32 s76, s70, 52
    s_lshr_b32 s76, s76, 8
    v_mfma_f32_16x16x32_bf16 v[164:167], a[164:167], a[184:187], v[164:167]
    ds_read_b64_tr_b16 a[220:221], v22 offset:6400
    v_mfma_f32_16x16x32_bf16 v[168:171], a[168:171], a[184:187], v[168:171]
    ds_read_b64_tr_b16 a[222:223], v22 offset:6656
    v_add_u32 v22, 0, v20
    v_mfma_f32_16x16x32_bf16 v[172:175], a[172:175], a[184:187], v[172:175]
    s_waitcnt lgkmcnt(8)
    s_add_u32 m0, s73, 50224
    v_mfma_f32_16x16x32_bf16 v[188:191], a[172:175], a[188:191], v[188:191]
    ds_read_b128 a[224:227], v21 offset:32
    v_mfma_f32_16x16x32_bf16 v[184:187], a[168:171], a[188:191], v[184:187]
    ds_read_b128 a[228:231], v21 offset:288
    v_mfma_f32_16x16x32_bf16 v[180:183], a[164:167], a[188:191], v[180:183]
    buffer_load_dwordx4 v18, s[8:11], s66 offen lds
    v_mfma_f32_16x16x32_bf16 v[176:179], a[160:163], a[188:191], v[176:179]
    ds_read_b128 a[232:235], v21 offset:8352
    v_mfma_f32_16x16x32_bf16 v[192:195], a[160:163], a[192:195], v[192:195]
    ds_read_b128 a[236:239], v21 offset:8608
Lpad66:
    s_cbranch_execz Lhret
    v_mfma_f32_16x16x32_bf16 v[196:199], a[164:167], a[192:195], v[196:199]
    s_mul_i32 s76, s76, 265
    s_add_u32 s70, s70, s91
    s_add_u32 s70, s70, s76
    v_mfma_f32_16x16x32_bf16 v[200:203], a[168:171], a[192:195], v[200:203]
    ds_read_b128 a[240:243], v21 offset:16672
    s_add_u32 m0, s73, 51280
    v_mfma_f32_16x16x32_bf16 v[204:207], a[172:175], a[192:195], v[204:207]
    ds_read_b128 a[244:247], v21 offset:16928
    v_mfma_f32_16x16x32_bf16 v[220:223], a[172:175], a[196:199], v[220:223]
    buffer_load_dwordx4 v127, s[8:11], s66 offen lds
    v_mfma_f32_16x16x32_bf16 v[216:219], a[168:171], a[196:199], v[216:219]
    ds_read_b128 a[248:251], v21 offset:24992
    v_mfma_f32_16x16x32_bf16 v[212:215], a[164:167], a[196:199], v[212:215]
    ds_read_b128 a[252:255], v21 offset:25248
    v_add_u32 v21, 0, v19
    v_mfma_f32_16x16x32_bf16 v[208:211], a[160:163], a[196:199], v[208:211]
    s_lshl_b32 s70, s70, 10
    buffer_store_dwordx4 a[144:147], v24, s[20:23], s70 offen sc1
    v_mfma_f32_16x16x32_bf16 v[224:227], a[160:163], a[200:203], v[224:227]
    s_add_u32 m0, s73, 52336
    v_mfma_f32_16x16x32_bf16 v[228:231], a[164:167], a[200:203], v[228:231]
    buffer_load_dwordx4 v18, s[12:15], s66 offen lds
    v_mfma_f32_16x16x32_bf16 v[232:235], a[168:171], a[200:203], v[232:235]
    s_add_u32 s70, s79, 1
    s_mul_i32 s76, s70, 52
    s_lshr_b32 s76, s76, 8
    v_mfma_f32_16x16x32_bf16 v[236:239], a[172:175], a[200:203], v[236:239]
    s_add_u32 m0, s73, 53392
    v_mfma_f32_16x16x32_bf16 v[252:255], a[172:175], a[204:207], v[252:255]
    buffer_load_dwordx4 v127, s[12:15], s66 offen lds
    v_mfma_f32_16x16x32_bf16 v[248:251], a[168:171], a[204:207], v[248:251]
    s_mul_i32 s76, s76, 265
    s_add_u32 s70, s70, s91
    s_add_u32 s70, s70, s76
    v_mfma_f32_16x16x32_bf16 v[244:247], a[164:167], a[204:207], v[244:247]
    s_lshl_b32 s70, s70, 10
    buffer_store_dwordx4 a[148:151], v24, s[20:23], s70 offen sc1
    v_mfma_f32_16x16x32_bf16 v[240:243], a[160:163], a[204:207], v[240:243]
    s_waitcnt vmcnt(14)
    s_waitcnt lgkmcnt(0)
    s_barrier
    v_mfma_f32_16x16x32_bf16 v[128:131], a[208:211], a[224:227], v[128:131]
    ds_read_b64_tr_b16 a[160:161], v22 offset:0
    v_mfma_f32_16x16x32_bf16 v[132:135], a[212:215], a[224:227], v[132:135]
    ds_read_b64_tr_b16 a[162:163], v22 offset:256
    v_mfma_f32_16x16x32_bf16 v[136:139], a[216:219], a[224:227], v[136:139]
    s_add_u32 m0, s73, 100448
    s_mul_i32 s66, s64, 221184
    v_mfma_f32_16x16x32_bf16 v[140:143], a[220:223], a[224:227], v[140:143]
    ds_read_b64_tr_b16 a[164:165], v22 offset:32
    v_mfma_f32_16x16x32_bf16 v[156:159], a[220:223], a[228:231], v[156:159]
    ds_read_b64_tr_b16 a[166:167], v22 offset:288
    v_mfma_f32_16x16x32_bf16 v[152:155], a[216:219], a[228:231], v[152:155]
Lpad67:
    s_cbranch_execz Lhret
    buffer_load_dwordx4 v18, s[8:11], s66 offen lds
    v_mfma_f32_16x16x32_bf16 v[148:151], a[212:215], a[228:231], v[148:151]
    ds_read_b64_tr_b16 a[168:169], v22 offset:2112
    v_mfma_f32_16x16x32_bf16 v[144:147], a[208:211], a[228:231], v[144:147]
    ds_read_b64_tr_b16 a[170:171], v22 offset:2368
    v_mfma_f32_16x16x32_bf16 v[160:163], a[208:211], a[232:235], v[160:163]
    s_add_u32 s70, s79, 2
    s_mul_i32 s76, s70, 52
    s_lshr_b32 s76, s76, 8
    v_mfma_f32_16x16x32_bf16 v[164:167], a[212:215], a[232:235], v[164:167]
    ds_read_b64_tr_b16 a[172:173], v22 offset:2144
    s_add_u32 m0, s73, 101504
    v_mfma_f32_16x16x32_bf16 v[168:171], a[216:219], a[232:235], v[168:171]
    ds_read_b64_tr_b16 a[174:175], v22 offset:2400
    v_mfma_f32_16x16x32_bf16 v[172:175], a[220:223], a[232:235], v[172:175]
    buffer_load_dwordx4 v127, s[8:11], s66 offen lds
    v_mfma_f32_16x16x32_bf16 v[188:191], a[220:223], a[236:239], v[188:191]
    ds_read_b128 a[176:179], v21 offset:0
    v_mfma_f32_16x16x32_bf16 v[184:187], a[216:219], a[236:239], v[184:187]
    ds_read_b128 a[180:183], v21 offset:256
    v_mfma_f32_16x16x32_bf16 v[180:183], a[212:215], a[236:239], v[180:183]
    s_mul_i32 s76, s76, 265
    s_add_u32 s70, s70, s91
    s_add_u32 s70, s70, s76
    v_mfma_f32_16x16x32_bf16 v[176:179], a[208:211], a[236:239], v[176:179]
    ds_read_b128 a[184:187], v21 offset:8320
    s_add_u32 m0, s73, 102560
    v_mfma_f32_16x16x32_bf16 v[192:195], a[208:211], a[240:243], v[192:195]
    ds_read_b128 a[188:191], v21 offset:8576
    v_mfma_f32_16x16x32_bf16 v[196:199], a[212:215], a[240:243], v[196:199]
    buffer_load_dwordx4 v18, s[12:15], s66 offen lds
    v_mfma_f32_16x16x32_bf16 v[200:203], a[216:219], a[240:243], v[200:203]
    ds_read_b128 a[192:195], v21 offset:16640
    v_mfma_f32_16x16x32_bf16 v[204:207], a[220:223], a[240:243], v[204:207]
    ds_read_b128 a[196:199], v21 offset:16896
    v_mfma_f32_16x16x32_bf16 v[220:223], a[220:223], a[244:247], v[220:223]
    s_lshl_b32 s70, s70, 10
    buffer_store_dwordx4 a[152:155], v24, s[20:23], s70 offen sc1
    v_mfma_f32_16x16x32_bf16 v[216:219], a[216:219], a[244:247], v[216:219]
    ds_read_b128 a[200:203], v21 offset:24960
    s_add_u32 m0, s73, 103616
    v_mfma_f32_16x16x32_bf16 v[212:215], a[212:215], a[244:247], v[212:215]
    ds_read_b128 a[204:207], v21 offset:25216
    v_mfma_f32_16x16x32_bf16 v[208:211], a[208:211], a[244:247], v[208:211]
    buffer_load_dwordx4 v127, s[12:15], s66 offen lds
    v_mfma_f32_16x16x32_bf16 v[224:227], a[208:211], a[248:251], v[224:227]
    v_readfirstlane_b32 s56, v2
    s_add_u32 m0, s72, 117408
    s_lshl_b32 s65, s64, 7
    v_mfma_f32_16x16x32_bf16 v[228:231], a[212:215], a[248:251], v[228:231]
    buffer_load_dwordx4 v17, s[4:7], s65 offen offset:0 lds
    v_mfma_f32_16x16x32_bf16 v[232:235], a[216:219], a[248:251], v[232:235]
Lpad68:
    s_cbranch_execz Lhret
    v_readfirstlane_b32 s57, v3
    v_mfma_f32_16x16x32_bf16 v[236:239], a[220:223], a[248:251], v[236:239]
    s_add_u32 s64, s64, 1
    s_cmp_eq_u32 s64, 10
    s_cselect_b32 s64, 0, s64
    s_add_u32 m0, s72, 119008
    v_mfma_f32_16x16x32_bf16 v[252:255], a[220:223], a[252:255], v[252:255]
    buffer_load_dwordx4 v17, s[4:7], s65 offen offset:2560 lds
    s_nop 1
    v_mfma_f32_16x16x32_bf16 v[248:251], a[216:219], a[252:255], v[248:251]
    s_cmp_eq_u32 s56, 0
    s_cbranch_scc1 Lns25
Lnb26:
    v_mfma_f32_16x16x32_bf16 v[244:247], a[212:215], a[252:255], v[244:247]
    s_add_u32 s70, s79, 3
    s_mul_i32 s76, s70, 52
    s_lshr_b32 s76, s76, 8
    v_mfma_f32_16x16x32_bf16 v[240:243], a[208:211], a[252:255], v[240:243]
    s_mul_i32 s76, s76, 265
    s_add_u32 s70, s70, s91
    s_add_u32 s70, s70, s76
    s_lshl_b32 s70, s70, 10
    buffer_store_dwordx4 a[156:159], v24, s[20:23], s70 offen sc1
    s_waitcnt lgkmcnt(0)
    v_mfma_f32_16x16x32_bf16 v[128:131], a[160:163], a[176:179], v[128:131]
    ds_read_b64_tr_b16 a[208:209], v22 offset:4256
    s_add_u32 m0, s72, 125728
    v_mfma_f32_16x16x32_bf16 v[132:135], a[164:167], a[176:179], v[132:135]
    ds_read_b64_tr_b16 a[210:211], v22 offset:4512
    v_mfma_f32_16x16x32_bf16 v[136:139], a[168:171], a[176:179], v[136:139]
    buffer_load_dwordx4 v114, s[4:7], s65 offen offset:0 lds
    v_mfma_f32_16x16x32_bf16 v[140:143], a[172:175], a[176:179], v[140:143]
    ds_read_b64_tr_b16 a[212:213], v22 offset:4288
    v_mfma_f32_16x16x32_bf16 v[156:159], a[172:175], a[180:183], v[156:159]
    ds_read_b64_tr_b16 a[214:215], v22 offset:4544
    v_mfma_f32_16x16x32_bf16 v[152:155], a[168:171], a[180:183], v[152:155]
    s_lshl_b32 s76, s75, 7
    buffer_load_dwordx4 v[40:43], v112, s[4:7], s76 offen
    v_mfma_f32_16x16x32_bf16 v[148:151], a[164:167], a[180:183], v[148:151]
    ds_read_b64_tr_b16 a[216:217], v22 offset:6368
    s_add_u32 m0, s72, 127328
    v_mfma_f32_16x16x32_bf16 v[144:147], a[160:163], a[180:183], v[144:147]
    ds_read_b64_tr_b16 a[218:219], v22 offset:6624
    v_mfma_f32_16x16x32_bf16 v[160:163], a[160:163], a[184:187], v[160:163]
    buffer_load_dwordx4 v114, s[4:7], s65 offen offset:2560 lds
    v_mfma_f32_16x16x32_bf16 v[164:167], a[164:167], a[184:187], v[164:167]
    ds_read_b64_tr_b16 a[220:221], v22 offset:6400
    v_mfma_f32_16x16x32_bf16 v[168:171], a[168:171], a[184:187], v[168:171]
    ds_read_b64_tr_b16 a[222:223], v22 offset:6656
    v_add_u32 v22, 50224, v20
    v_mfma_f32_16x16x32_bf16 v[172:175], a[172:175], a[184:187], v[172:175]
    s_add_u32 s75, s75, 1
    s_cmp_eq_u32 s75, 10
    s_cselect_b32 s75, 0, s75
    v_mfma_f32_16x16x32_bf16 v[188:191], a[172:175], a[188:191], v[188:191]
    ds_read_b128 a[224:227], v21 offset:32
    s_add_u32 m0, s72, 134048
    v_mfma_f32_16x16x32_bf16 v[184:187], a[168:171], a[188:191], v[184:187]
Lpad69:
    s_cbranch_execz Lhret
    ds_read_b128 a[228:231], v21 offset:288
    v_mfma_f32_16x16x32_bf16 v[180:183], a[164:167], a[188:191], v[180:183]
    buffer_load_dwordx4 v115, s[4:7], s65 offen offset:0 lds
    v_mfma_f32_16x16x32_bf16 v[176:179], a[160:163], a[188:191], v[176:179]
    ds_read_b128 a[232:235], v21 offset:8352
    s_add_u32 m0, s72, 135648
    v_mfma_f32_16x16x32_bf16 v[192:195], a[160:163], a[192:195], v[192:195]
    ds_read_b128 a[236:239], v21 offset:8608
    v_mfma_f32_16x16x32_bf16 v[196:199], a[164:167], a[192:195], v[196:199]
    buffer_load_dwordx4 v115, s[4:7], s65 offen offset:2560 lds
    v_mfma_f32_16x16x32_bf16 v[200:203], a[168:171], a[192:195], v[200:203]
    ds_read_b128 a[240:243], v21 offset:16672
    s_add_u32 m0, s72, 142368
    v_mfma_f32_16x16x32_bf16 v[204:207], a[172:175], a[192:195], v[204:207]
    ds_read_b128 a[244:247], v21 offset:16928
    v_mfma_f32_16x16x32_bf16 v[220:223], a[172:175], a[196:199], v[220:223]
    buffer_load_dwordx4 v126, s[4:7], s65 offen offset:0 lds
    v_mfma_f32_16x16x32_bf16 v[216:219], a[168:171], a[196:199], v[216:219]
    ds_read_b128 a[248:251], v21 offset:24992
    s_add_u32 m0, s72, 143968
    v_mfma_f32_16x16x32_bf16 v[212:215], a[164:167], a[196:199], v[212:215]
    ds_read_b128 a[252:255], v21 offset:25248
    v_add_u32 v21, 50224, v19
    v_mfma_f32_16x16x32_bf16 v[208:211], a[160:163], a[196:199], v[208:211]
    buffer_load_dwordx4 v126, s[4:7], s65 offen offset:2560 lds
    v_mfma_f32_16x16x32_bf16 v[224:227], a[160:163], a[200:203], v[224:227]
    v_mfma_f32_16x16x32_bf16 v[228:231], a[164:167], a[200:203], v[228:231]
    v_mfma_f32_16x16x32_bf16 v[232:235], a[168:171], a[200:203], v[232:235]
    v_mfma_f32_16x16x32_bf16 v[236:239], a[172:175], a[200:203], v[236:239]
    v_mfma_f32_16x16x32_bf16 v[252:255], a[172:175], a[204:207], v[252:255]
    v_mfma_f32_16x16x32_bf16 v[248:251], a[168:171], a[204:207], v[248:251]
    v_mfma_f32_16x16x32_bf16 v[244:247], a[164:167], a[204:207], v[244:247]
    v_mfma_f32_16x16x32_bf16 v[240:243], a[160:163], a[204:207], v[240:243]
    s_waitcnt vmcnt(16)
    s_waitcnt lgkmcnt(0)
    s_barrier
    v_mfma_f32_16x16x32_bf16 v[128:131], a[208:211], a[224:227], v[128:131]
    ds_read_b64_tr_b16 a[160:161], v22 offset:0
    v_mfma_f32_16x16x32_bf16 v[132:135], a[212:215], a[224:227], v[132:135]
    ds_read_b64_tr_b16 a[162:163], v22 offset:256
    v_mfma_f32_16x16x32_bf16 v[136:139], a[216:219], a[224:227], v[136:139]
    s_add_u32 m0, s73, 0
    s_mul_i32 s66, s64, 221184
    v_mfma_f32_16x16x32_bf16 v[140:143], a[220:223], a[224:227], v[140:143]
    ds_read_b64_tr_b16 a[164:165], v22 offset:32
    v_mfma_f32_16x16x32_bf16 v[156:159], a[220:223], a[228:231], v[156:159]
    ds_read_b64_tr_b16 a[166:167], v22 offset:288
    v_mfma_f32_16x16x32_bf16 v[152:155], a[216:219], a[228:231], v[152:155]
    buffer_load_dwordx4 v18, s[8:11], s66 offen lds
    v_mfma_f32_16x16x32_bf16 v[148:151], a[212:215], a[228:231], v[148:151]
Lpad70:
    s_cbranch_execz Lhret
    ds_read_b64_tr_b16 a[168:169], v22 offset:2112
    v_mov_b32 v10, s56
    v_mfma_f32_16x16x32_bf16 v[144:147], a[208:211], a[228:231], v[144:147]
    ds_read_b64_tr_b16 a[170:171], v22 offset:2368
    s_add_u32 m0, s73, 1056
    v_mfma_f32_16x16x32_bf16 v[160:163], a[208:211], a[232:235], v[160:163]
    buffer_load_dwordx4 v127, s[8:11], s66 offen lds
    v_mfma_f32_16x16x32_bf16 v[164:167], a[212:215], a[232:235], v[164:167]
    ds_read_b64_tr_b16 a[172:173], v22 offset:2144
    v_mov_b32 v11, s57
    v_mfma_f32_16x16x32_bf16 v[168:171], a[216:219], a[232:235], v[168:171]
    ds_read_b64_tr_b16 a[174:175], v22 offset:2400
    s_add_u32 m0, s73, 2112
    v_mfma_f32_16x16x32_bf16 v[172:175], a[220:223], a[232:235], v[172:175]
    buffer_load_dwordx4 v18, s[12:15], s66 offen lds
    v_mfma_f32_16x16x32_bf16 v[188:191], a[220:223], a[236:239], v[188:191]
    ds_read_b128 a[176:179], v21 offset:0
    v_lshl_add_u32 v12, v1, 3, s71
    v_mfma_f32_16x16x32_bf16 v[184:187], a[216:219], a[236:239], v[184:187]
    ds_read_b128 a[180:183], v21 offset:256
    s_add_u32 m0, s73, 3168
    v_mfma_f32_16x16x32_bf16 v[180:183], a[212:215], a[236:239], v[180:183]
    buffer_load_dwordx4 v127, s[12:15], s66 offen lds
    v_mfma_f32_16x16x32_bf16 v[176:179], a[208:211], a[236:239], v[176:179]
    ds_read_b128 a[184:187], v21 offset:8320
    s_waitcnt vmcnt(11)
    v_mfma_f32_16x16x32_bf16 v[192:195], a[208:211], a[240:243], v[192:195]
    ds_read_b128 a[188:191], v21 offset:8576
    v_mfma_f32_16x16x32_bf16 v[196:199], a[212:215], a[240:243], v[196:199]
    s_add_u32 m0, s72, 16960
    s_lshl_b32 s65, s64, 7
    v_mfma_f32_16x16x32_bf16 v[200:203], a[216:219], a[240:243], v[200:203]
    ds_read_b128 a[192:195], v21 offset:16640
    v_mfma_f32_16x16x32_bf16 v[204:207], a[220:223], a[240:243], v[204:207]
    ds_read_b128 a[196:199], v21 offset:16896
    v_mfma_f32_16x16x32_bf16 v[220:223], a[220:223], a[244:247], v[220:223]
    buffer_load_dwordx4 v17, s[4:7], s65 offen offset:0 lds
    v_mfma_f32_16x16x32_bf16 v[216:219], a[216:219], a[244:247], v[216:219]
    ds_read_b128 a[200:203], v21 offset:24960
    v_mfma_f32_16x16x32_bf16 v[212:215], a[212:215], a[244:247], v[212:215]
    ds_read_b128 a[204:207], v21 offset:25216
    v_mfma_f32_16x16x32_bf16 v[208:211], a[208:211], a[244:247], v[208:211]
    s_mov_b64 exec, 0xffff
    buffer_store_dwordx2 v[10:11], v12, s[20:23], 0 offen sc1
    s_mov_b64 exec, -1
    v_mfma_f32_16x16x32_bf16 v[224:227], a[208:211], a[248:251], v[224:227]
    s_add_u32 s64, s64, 1
    s_cmp_eq_u32 s64, 10
    s_cselect_b32 s64, 0, s64
    s_add_u32 m0, s72, 18560
    v_mfma_f32_16x16x32_bf16 v[228:231], a[212:215], a[248:251], v[228:231]
    buffer_load_dwordx4 v17, s[4:7], s65 offen offset:2560 lds
Lpad71:
    s_cbranch_execz Lhret
    v_mfma_f32_16x16x32_bf16 v[232:235], a[216:219], a[248:251], v[232:235]
    s_lshl_b32 s76, s75, 7
    buffer_load_dwordx4 v[44:47], v112, s[4:7], s76 offen
    v_mfma_f32_16x16x32_bf16 v[236:239], a[220:223], a[248:251], v[236:239]
    s_add_u32 s75, s75, 1
    s_cmp_eq_u32 s75, 10
    s_cselect_b32 s75, 0, s75
    v_mfma_f32_16x16x32_bf16 v[252:255], a[220:223], a[252:255], v[252:255]
    v_mfma_f32_16x16x32_bf16 v[248:251], a[216:219], a[252:255], v[248:251]
    v_mfma_f32_16x16x32_bf16 v[244:247], a[212:215], a[252:255], v[244:247]
    v_mfma_f32_16x16x32_bf16 v[240:243], a[208:211], a[252:255], v[240:243]
    s_waitcnt lgkmcnt(0)
    v_mfma_f32_16x16x32_bf16 v[128:131], a[160:163], a[176:179], v[128:131]
    ds_read_b64_tr_b16 a[208:209], v22 offset:4256
    s_add_u32 m0, s72, 25280
    v_mfma_f32_16x16x32_bf16 v[132:135], a[164:167], a[176:179], v[132:135]
    ds_read_b64_tr_b16 a[210:211], v22 offset:4512
    v_mfma_f32_16x16x32_bf16 v[136:139], a[168:171], a[176:179], v[136:139]
    buffer_load_dwordx4 v114, s[4:7], s65 offen offset:0 lds
    v_mfma_f32_16x16x32_bf16 v[140:143], a[172:175], a[176:179], v[140:143]
    ds_read_b64_tr_b16 a[212:213], v22 offset:4288
    v_mfma_f32_16x16x32_bf16 v[156:159], a[172:175], a[180:183], v[156:159]
    ds_read_b64_tr_b16 a[214:215], v22 offset:4544
    v_mfma_f32_16x16x32_bf16 v[152:155], a[168:171], a[180:183], v[152:155]
    s_lshl_b32 s76, s75, 7
    buffer_load_dwordx4 v[48:51], v112, s[4:7], s76 offen
    v_mfma_f32_16x16x32_bf16 v[148:151], a[164:167], a[180:183], v[148:151]
    ds_read_b64_tr_b16 a[216:217], v22 offset:6368
    s_add_u32 m0, s72, 26880
    v_mfma_f32_16x16x32_bf16 v[144:147], a[160:163], a[180:183], v[144:147]
    ds_read_b64_tr_b16 a[218:219], v22 offset:6624
    v_mfma_f32_16x16x32_bf16 v[160:163], a[160:163], a[184:187], v[160:163]
    buffer_load_dwordx4 v114, s[4:7], s65 offen offset:2560 lds
    v_mfma_f32_16x16x32_bf16 v[164:167], a[164:167], a[184:187], v[164:167]
    ds_read_b64_tr_b16 a[220:221], v22 offset:6400
    v_mfma_f32_16x16x32_bf16 v[168:171], a[168:171], a[184:187], v[168:171]
    ds_read_b64_tr_b16 a[222:223], v22 offset:6656
    v_add_u32 v22, 100448, v20
    v_mfma_f32_16x16x32_bf16 v[172:175], a[172:175], a[184:187], v[172:175]
    s_add_u32 s75, s75, 1
    s_cmp_eq_u32 s75, 10
    s_cselect_b32 s75, 0, s75
    v_mfma_f32_16x16x32_bf16 v[188:191], a[172:175], a[188:191], v[188:191]
    ds_read_b128 a[224:227], v21 offset:32
    s_add_u32 m0, s72, 33600
    v_mfma_f32_16x16x32_bf16 v[184:187], a[168:171], a[188:191], v[184:187]
    ds_read_b128 a[228:231], v21 offset:288
    v_mfma_f32_16x16x32_bf16 v[180:183], a[164:167], a[188:191], v[180:183]
    buffer_load_dwordx4 v115, s[4:7], s65 offen offset:0 lds
    v_mfma_f32_16x16x32_bf16 v[176:179], a[160:163], a[188:191], v[176:179]
    ds_read_b128 a[232:235], v21 offset:8352
    s_add_u32 m0, s72, 35200
Lpad72:
    s_cbranch_execz Lhret
    v_mfma_f32_16x16x32_bf16 v[192:195], a[160:163], a[192:195], v[192:195]
    ds_read_b128 a[236:239], v21 offset:8608
    v_mfma_f32_16x16x32_bf16 v[196:199], a[164:167], a[192:195], v[196:199]
    buffer_load_dwordx4 v115, s[4:7], s65 offen offset:2560 lds
    v_mfma_f32_16x16x32_bf16 v[200:203], a[168:171], a[192:195], v[200:203]
    ds_read_b128 a[240:243], v21 offset:16672
    s_add_u32 m0, s72, 41920
    v_mfma_f32_16x16x32_bf16 v[204:207], a[172:175], a[192:195], v[204:207]
    ds_read_b128 a[244:247], v21 offset:16928
    v_mfma_f32_16x16x32_bf16 v[220:223], a[172:175], a[196:199], v[220:223]
    buffer_load_dwordx4 v126, s[4:7], s65 offen offset:0 lds
    v_mfma_f32_16x16x32_bf16 v[216:219], a[168:171], a[196:199], v[216:219]
    ds_read_b128 a[248:251], v21 offset:24992
    s_add_u32 m0, s72, 43520
    v_mfma_f32_16x16x32_bf16 v[212:215], a[164:167], a[196:199], v[212:215]
    ds_read_b128 a[252:255], v21 offset:25248
    v_add_u32 v21, 100448, v19
    v_mfma_f32_16x16x32_bf16 v[208:211], a[160:163], a[196:199], v[208:211]
    buffer_load_dwordx4 v126, s[4:7], s65 offen offset:2560 lds
    v_mfma_f32_16x16x32_bf16 v[224:227], a[160:163], a[200:203], v[224:227]
    v_mfma_f32_16x16x32_bf16 v[228:231], a[164:167], a[200:203], v[228:231]
    v_mfma_f32_16x16x32_bf16 v[232:235], a[168:171], a[200:203], v[232:235]
    v_mfma_f32_16x16x32_bf16 v[236:239], a[172:175], a[200:203], v[236:239]
    v_mfma_f32_16x16x32_bf16 v[252:255], a[172:175], a[204:207], v[252:255]
    v_mfma_f32_16x16x32_bf16 v[248:251], a[168:171], a[204:207], v[248:251]
    v_mfma_f32_16x16x32_bf16 v[244:247], a[164:167], a[204:207], v[244:247]
    v_mfma_f32_16x16x32_bf16 v[240:243], a[160:163], a[204:207], v[240:243]
    s_waitcnt vmcnt(14)
    s_waitcnt lgkmcnt(0)
Lpad73:
    s_cbranch_execz Lhret
    s_barrier
    v_mfma_f32_16x16x32_bf16 v[128:131], a[208:211], a[224:227], v[128:131]
    ds_read_b64_tr_b16 a[160:161], v22 offset:0
    v_mfma_f32_16x16x32_bf16 v[132:135], a[212:215], a[224:227], v[132:135]
    ds_read_b64_tr_b16 a[162:163], v22 offset:256
    v_mfma_f32_16x16x32_bf16 v[136:139], a[216:219], a[224:227], v[136:139]
    s_add_u32 m0, s73, 50224
    s_mul_i32 s66, s64, 221184
    v_mfma_f32_16x16x32_bf16 v[140:143], a[220:223], a[224:227], v[140:143]
    ds_read_b64_tr_b16 a[164:165], v22 offset:32
    v_mfma_f32_16x16x32_bf16 v[156:159], a[220:223], a[228:231], v[156:159]
    ds_read_b64_tr_b16 a[166:167], v22 offset:288
    v_mfma_f32_16x16x32_bf16 v[152:155], a[216:219], a[228:231], v[152:155]
    buffer_load_dwordx4 v18, s[8:11], s66 offen lds
    v_mfma_f32_16x16x32_bf16 v[148:151], a[212:215], a[228:231], v[148:151]
    ds_read_b64_tr_b16 a[168:169], v22 offset:2112
    s_add_u32 m0, s73, 51280
    v_mfma_f32_16x16x32_bf16 v[144:147], a[208:211], a[228:231], v[144:147]
    ds_read_b64_tr_b16 a[170:171], v22 offset:2368
    v_mfma_f32_16x16x32_bf16 v[160:163], a[208:211], a[232:235], v[160:163]
    buffer_load_dwordx4 v127, s[8:11], s66 offen lds
    v_mfma_f32_16x16x32_bf16 v[164:167], a[212:215], a[232:235], v[164:167]
    ds_read_b64_tr_b16 a[172:173], v22 offset:2144
    s_add_u32 m0, s73, 52336
    v_mfma_f32_16x16x32_bf16 v[168:171], a[216:219], a[232:235], v[168:171]
    ds_read_b64_tr_b16 a[174:175], v22 offset:2400
    v_mfma_f32_16x16x32_bf16 v[172:175], a[220:223], a[232:235], v[172:175]
    buffer_load_dwordx4 v18, s[12:15], s66 offen lds
    v_mfma_f32_16x16x32_bf16 v[188:191], a[220:223], a[236:239], v[188:191]
    ds_read_b128 a[176:179], v21 offset:0
    s_add_u32 m0, s73, 53392
    v_mfma_f32_16x16x32_bf16 v[184:187], a[216:219], a[236:239], v[184:187]
    ds_read_b128 a[180:183], v21 offset:256
    v_mfma_f32_16x16x32_bf16 v[180:183], a[212:215], a[236:239], v[180:183]
    buffer_load_dwordx4 v127, s[12:15], s66 offen lds
    v_mfma_f32_16x16x32_bf16 v[176:179], a[208:211], a[236:239], v[176:179]
    ds_read_b128 a[184:187], v21 offset:8320
    v_mfma_f32_16x16x32_bf16 v[192:195], a[208:211], a[240:243], v[192:195]
    ds_read_b128 a[188:191], v21 offset:8576
    v_mfma_f32_16x16x32_bf16 v[196:199], a[212:215], a[240:243], v[196:199]
    s_add_u32 m0, s72, 67184
    s_lshl_b32 s65, s64, 7
    v_mfma_f32_16x16x32_bf16 v[200:203], a[216:219], a[240:243], v[200:203]
    ds_read_b128 a[192:195], v21 offset:16640
    v_mfma_f32_16x16x32_bf16 v[204:207], a[220:223], a[240:243], v[204:207]
    ds_read_b128 a[196:199], v21 offset:16896
    v_mfma_f32_16x16x32_bf16 v[220:223], a[220:223], a[244:247], v[220:223]
    buffer_load_dwordx4 v17, s[4:7], s65 offen offset:0 lds
    v_mfma_f32_16x16x32_bf16 v[216:219], a[216:219], a[244:247], v[216:219]
Lpad74:
    s_cbranch_execz Lhret
    ds_read_b128 a[200:203], v21 offset:24960
    v_mfma_f32_16x16x32_bf16 v[212:215], a[212:215], a[244:247], v[212:215]
    ds_read_b128 a[204:207], v21 offset:25216
    v_mfma_f32_16x16x32_bf16 v[208:211], a[208:211], a[244:247], v[208:211]
    s_add_u32 s64, s64, 1
    s_cmp_eq_u32 s64, 10
    s_cselect_b32 s64, 0, s64
    s_add_u32 m0, s72, 68784
    v_mfma_f32_16x16x32_bf16 v[224:227], a[208:211], a[248:251], v[224:227]
    buffer_load_dwordx4 v17, s[4:7], s65 offen offset:2560 lds
    v_mfma_f32_16x16x32_bf16 v[228:231], a[212:215], a[248:251], v[228:231]
    v_mfma_f32_16x16x32_bf16 v[232:235], a[216:219], a[248:251], v[232:235]
    v_mfma_f32_16x16x32_bf16 v[236:239], a[220:223], a[248:251], v[236:239]
    v_mfma_f32_16x16x32_bf16 v[252:255], a[220:223], a[252:255], v[252:255]
    v_mfma_f32_16x16x32_bf16 v[248:251], a[216:219], a[252:255], v[248:251]
    v_mfma_f32_16x16x32_bf16 v[244:247], a[212:215], a[252:255], v[244:247]
    v_mfma_f32_16x16x32_bf16 v[240:243], a[208:211], a[252:255], v[240:243]
    s_waitcnt lgkmcnt(0)
    v_mfma_f32_16x16x32_bf16 v[128:131], a[160:163], a[176:179], v[128:131]
    ds_read_b64_tr_b16 a[208:209], v22 offset:4256
    s_add_u32 m0, s72, 75504
    v_mfma_f32_16x16x32_bf16 v[132:135], a[164:167], a[176:179], v[132:135]
    ds_read_b64_tr_b16 a[210:211], v22 offset:4512
    v_mfma_f32_16x16x32_bf16 v[136:139], a[168:171], a[176:179], v[136:139]
    buffer_load_dwordx4 v114, s[4:7], s65 offen offset:0 lds
    v_mfma_f32_16x16x32_bf16 v[140:143], a[172:175], a[176:179], v[140:143]
    ds_read_b64_tr_b16 a[212:213], v22 offset:4288
    v_mfma_f32_16x16x32_bf16 v[156:159], a[172:175], a[180:183], v[156:159]
    ds_read_b64_tr_b16 a[214:215], v22 offset:4544
    v_mfma_f32_16x16x32_bf16 v[152:155], a[168:171], a[180:183], v[152:155]
    s_lshl_b32 s76, s75, 7
    buffer_load_dwordx4 v[52:55], v112, s[4:7], s76 offen
    v_mfma_f32_16x16x32_bf16 v[148:151], a[164:167], a[180:183], v[148:151]
    ds_read_b64_tr_b16 a[216:217], v22 offset:6368
    s_add_u32 m0, s72, 77104
    v_mfma_f32_16x16x32_bf16 v[144:147], a[160:163], a[180:183], v[144:147]
    ds_read_b64_tr_b16 a[218:219], v22 offset:6624
    v_mfma_f32_16x16x32_bf16 v[160:163], a[160:163], a[184:187], v[160:163]
    buffer_load_dwordx4 v114, s[4:7], s65 offen offset:2560 lds
    v_mfma_f32_16x16x32_bf16 v[164:167], a[164:167], a[184:187], v[164:167]
    ds_read_b64_tr_b16 a[220:221], v22 offset:6400
    v_mfma_f32_16x16x32_bf16 v[168:171], a[168:171], a[184:187], v[168:171]
    ds_read_b64_tr_b16 a[222:223], v22 offset:6656
    v_add_u32 v22, 0, v20
    v_mfma_f32_16x16x32_bf16 v[172:175], a[172:175], a[184:187], v[172:175]
    s_add_u32 s75, s75, 1
    s_cmp_eq_u32 s75, 10
    s_cselect_b32 s75, 0, s75
    v_mfma_f32_16x16x32_bf16 v[188:191], a[172:175], a[188:191], v[188:191]
    ds_read_b128 a[224:227], v21 offset:32
    s_add_u32 m0, s72, 83824
    v_mfma_f32_16x16x32_bf16 v[184:187], a[168:171], a[188:191], v[184:187]
Lpad75:
    s_cbranch_execz Lhret
    ds_read_b128 a[228:231], v21 offset:288
    v_mfma_f32_16x16x32_bf16 v[180:183], a[164:167], a[188:191], v[180:183]
    buffer_load_dwordx4 v115, s[4:7], s65 offen offset:0 lds
    v_mfma_f32_16x16x32_bf16 v[176:179], a[160:163], a[188:191], v[176:179]
    ds_read_b128 a[232:235], v21 offset:8352
    s_add_u32 m0, s72, 85424
    v_mfma_f32_16x16x32_bf16 v[192:195], a[160:163], a[192:195], v[192:195]
    ds_read_b128 a[236:239], v21 offset:8608
    v_mfma_f32_16x16x32_bf16 v[196:199], a[164:167], a[192:195], v[196:199]
    buffer_load_dwordx4 v115, s[4:7], s65 offen offset:2560 lds
    v_mfma_f32_16x16x32_bf16 v[200:203], a[168:171], a[192:195], v[200:203]
    ds_read_b128 a[240:243], v21 offset:16672
    s_add_u32 m0, s72, 92144
    v_mfma_f32_16x16x32_bf16 v[204:207], a[172:175], a[192:195], v[204:207]
    ds_read_b128 a[244:247], v21 offset:16928
    v_mfma_f32_16x16x32_bf16 v[220:223], a[172:175], a[196:199], v[220:223]
    buffer_load_dwordx4 v126, s[4:7], s65 offen offset:0 lds
    v_mfma_f32_16x16x32_bf16 v[216:219], a[168:171], a[196:199], v[216:219]
    ds_read_b128 a[248:251], v21 offset:24992
    s_add_u32 m0, s72, 93744
    v_mfma_f32_16x16x32_bf16 v[212:215], a[164:167], a[196:199], v[212:215]
    ds_read_b128 a[252:255], v21 offset:25248
    v_add_u32 v21, 0, v19
    v_mfma_f32_16x16x32_bf16 v[208:211], a[160:163], a[196:199], v[208:211]
    buffer_load_dwordx4 v126, s[4:7], s65 offen offset:2560 lds
    v_mfma_f32_16x16x32_bf16 v[224:227], a[160:163], a[200:203], v[224:227]
    v_mfma_f32_16x16x32_bf16 v[228:231], a[164:167], a[200:203], v[228:231]
    v_mfma_f32_16x16x32_bf16 v[232:235], a[168:171], a[200:203], v[232:235]
    v_mfma_f32_16x16x32_bf16 v[236:239], a[172:175], a[200:203], v[236:239]
    v_mfma_f32_16x16x32_bf16 v[252:255], a[172:175], a[204:207], v[252:255]
    v_mfma_f32_16x16x32_bf16 v[248:251], a[168:171], a[204:207], v[248:251]
    v_mfma_f32_16x16x32_bf16 v[244:247], a[164:167], a[204:207], v[244:247]
    v_mfma_f32_16x16x32_bf16 v[240:243], a[160:163], a[204:207], v[240:243]
    s_waitcnt vmcnt(13)
    s_waitcnt lgkmcnt(0)
    s_barrier
    v_mfma_f32_16x16x32_bf16 v[128:131], a[208:211], a[224:227], v[128:131]
    ds_read_b64_tr_b16 a[160:161], v22 offset:0
    v_mfma_f32_16x16x32_bf16 v[132:135], a[212:215], a[224:227], v[132:135]
    ds_read_b64_tr_b16 a[162:163], v22 offset:256
    v_mfma_f32_16x16x32_bf16 v[136:139], a[216:219], a[224:227], v[136:139]
    s_add_u32 m0, s73, 100448
    s_mul_i32 s66, s64, 221184
    v_mfma_f32_16x16x32_bf16 v[140:143], a[220:223], a[224:227], v[140:143]
    ds_read_b64_tr_b16 a[164:165], v22 offset:32
    v_mfma_f32_16x16x32_bf16 v[156:159], a[220:223], a[228:231], v[156:159]
    ds_read_b64_tr_b16 a[166:167], v22 offset:288
    v_mfma_f32_16x16x32_bf16 v[152:155], a[216:219], a[228:231], v[152:155]
    buffer_load_dwordx4 v18, s[8:11], s66 offen lds
    v_mfma_f32_16x16x32_bf16 v[148:151], a[212:215], a[228:231], v[148:151]
Lpad76:
    s_cbranch_execz Lhret
    ds_read_b64_tr_b16 a[168:169], v22 offset:2112
    v_mfma_f32_16x16x32_bf16 v[144:147], a[208:211], a[228:231], v[144:147]
    ds_read_b64_tr_b16 a[170:171], v22 offset:2368
    v_mfma_f32_16x16x32_bf16 v[160:163], a[208:211], a[232:235], v[160:163]
    s_lshl_b32 s76, s75, 7
    buffer_load_dwordx4 v[56:59], v112, s[4:7], s76 offen
    v_mfma_f32_16x16x32_bf16 v[164:167], a[212:215], a[232:235], v[164:167]
    ds_read_b64_tr_b16 a[172:173], v22 offset:2144
    s_add_u32 m0, s73, 101504
    v_mfma_f32_16x16x32_bf16 v[168:171], a[216:219], a[232:235], v[168:171]
    ds_read_b64_tr_b16 a[174:175], v22 offset:2400
    v_mfma_f32_16x16x32_bf16 v[172:175], a[220:223], a[232:235], v[172:175]
    buffer_load_dwordx4 v127, s[8:11], s66 offen lds
    v_mfma_f32_16x16x32_bf16 v[188:191], a[220:223], a[236:239], v[188:191]
    ds_read_b128 a[176:179], v21 offset:0
    v_mfma_f32_16x16x32_bf16 v[184:187], a[216:219], a[236:239], v[184:187]
    ds_read_b128 a[180:183], v21 offset:256
    v_mfma_f32_16x16x32_bf16 v[180:183], a[212:215], a[236:239], v[180:183]
    s_add_u32 s75, s75, 1
    s_cmp_eq_u32 s75, 10
    s_cselect_b32 s75, 0, s75
    v_mfma_f32_16x16x32_bf16 v[176:179], a[208:211], a[236:239], v[176:179]
    ds_read_b128 a[184:187], v21 offset:8320
    s_add_u32 m0, s73, 102560
    v_mfma_f32_16x16x32_bf16 v[192:195], a[208:211], a[240:243], v[192:195]
    ds_read_b128 a[188:191], v21 offset:8576
    v_mfma_f32_16x16x32_bf16 v[196:199], a[212:215], a[240:243], v[196:199]
    buffer_load_dwordx4 v18, s[12:15], s66 offen lds
    v_mfma_f32_16x16x32_bf16 v[200:203], a[216:219], a[240:243], v[200:203]
    ds_read_b128 a[192:195], v21 offset:16640
    s_add_u32 m0, s73, 103616
    v_mfma_f32_16x16x32_bf16 v[204:207], a[220:223], a[240:243], v[204:207]
    ds_read_b128 a[196:199], v21 offset:16896
    v_mfma_f32_16x16x32_bf16 v[220:223], a[220:223], a[244:247], v[220:223]
    buffer_load_dwordx4 v127, s[12:15], s66 offen lds
    v_mfma_f32_16x16x32_bf16 v[216:219], a[216:219], a[244:247], v[216:219]
    ds_read_b128 a[200:203], v21 offset:24960
    v_mfma_f32_16x16x32_bf16 v[212:215], a[212:215], a[244:247], v[212:215]
    ds_read_b128 a[204:207], v21 offset:25216
    v_mfma_f32_16x16x32_bf16 v[208:211], a[208:211], a[244:247], v[208:211]
    s_add_u32 m0, s72, 117408
    s_lshl_b32 s65, s64, 7
    v_mfma_f32_16x16x32_bf16 v[224:227], a[208:211], a[248:251], v[224:227]
    buffer_load_dwordx4 v17, s[4:7], s65 offen offset:0 lds
    v_mfma_f32_16x16x32_bf16 v[228:231], a[212:215], a[248:251], v[228:231]
    s_add_u32 s64, s64, 1
    s_cmp_eq_u32 s64, 10
    s_cselect_b32 s64, 0, s64
    s_add_u32 m0, s72, 119008
    v_mfma_f32_16x16x32_bf16 v[232:235], a[216:219], a[248:251], v[232:235]
    buffer_load_dwordx4 v17, s[4:7], s65 offen offset:2560 lds
    v_mfma_f32_16x16x32_bf16 v[236:239], a[220:223], a[248:251], v[236:239]
Lpad77:
    s_cbranch_execz Lhret
    v_mfma_f32_16x16x32_bf16 v[252:255], a[220:223], a[252:255], v[252:255]
    v_mfma_f32_16x16x32_bf16 v[248:251], a[216:219], a[252:255], v[248:251]
    v_mfma_f32_16x16x32_bf16 v[244:247], a[212:215], a[252:255], v[244:247]
    v_mfma_f32_16x16x32_bf16 v[240:243], a[208:211], a[252:255], v[240:243]
    s_waitcnt lgkmcnt(0)
    v_mfma_f32_16x16x32_bf16 v[128:131], a[160:163], a[176:179], v[128:131]
    ds_read_b64_tr_b16 a[208:209], v22 offset:4256
    s_add_u32 m0, s72, 125728
    v_mfma_f32_16x16x32_bf16 v[132:135], a[164:167], a[176:179], v[132:135]
    ds_read_b64_tr_b16 a[210:211], v22 offset:4512
    v_mfma_f32_16x16x32_bf16 v[136:139], a[168:171], a[176:179], v[136:139]
    buffer_load_dwordx4 v114, s[4:7], s65 offen offset:0 lds
    v_mfma_f32_16x16x32_bf16 v[140:143], a[172:175], a[176:179], v[140:143]
    ds_read_b64_tr_b16 a[212:213], v22 offset:4288
    v_mfma_f32_16x16x32_bf16 v[156:159], a[172:175], a[180:183], v[156:159]
    ds_read_b64_tr_b16 a[214:215], v22 offset:4544
    v_mfma_f32_16x16x32_bf16 v[152:155], a[168:171], a[180:183], v[152:155]
    s_lshl_b32 s76, s75, 7
    buffer_load_dwordx4 v[60:63], v112, s[4:7], s76 offen
    v_mfma_f32_16x16x32_bf16 v[148:151], a[164:167], a[180:183], v[148:151]
    ds_read_b64_tr_b16 a[216:217], v22 offset:6368
    s_add_u32 m0, s72, 127328
    v_mfma_f32_16x16x32_bf16 v[144:147], a[160:163], a[180:183], v[144:147]
    ds_read_b64_tr_b16 a[218:219], v22 offset:6624
    v_mfma_f32_16x16x32_bf16 v[160:163], a[160:163], a[184:187], v[160:163]
    buffer_load_dwordx4 v114, s[4:7], s65 offen offset:2560 lds
    v_mfma_f32_16x16x32_bf16 v[164:167], a[164:167], a[184:187], v[164:167]
    ds_read_b64_tr_b16 a[220:221], v22 offset:6400
    v_mfma_f32_16x16x32_bf16 v[168:171], a[168:171], a[184:187], v[168:171]
    ds_read_b64_tr_b16 a[222:223], v22 offset:6656
    v_add_u32 v22, 50224, v20
    v_mfma_f32_16x16x32_bf16 v[172:175], a[172:175], a[184:187], v[172:175]
    s_add_u32 s75, s75, 1
    s_cmp_eq_u32 s75, 10
    s_cselect_b32 s75, 0, s75
    v_mfma_f32_16x16x32_bf16 v[188:191], a[172:175], a[188:191], v[188:191]
    ds_read_b128 a[224:227], v21 offset:32
    s_add_u32 m0, s72, 134048
    v_mfma_f32_16x16x32_bf16 v[184:187], a[168:171], a[188:191], v[184:187]
    ds_read_b128 a[228:231], v21 offset:288
    v_mfma_f32_16x16x32_bf16 v[180:183], a[164:167], a[188:191], v[180:183]
    buffer_load_dwordx4 v115, s[4:7], s65 offen offset:0 lds
    v_mfma_f32_16x16x32_bf16 v[176:179], a[160:163], a[188:191], v[176:179]
    ds_read_b128 a[232:235], v21 offset:8352
    s_add_u32 m0, s72, 135648
    v_mfma_f32_16x16x32_bf16 v[192:195], a[160:163], a[192:195], v[192:195]
    ds_read_b128 a[236:239], v21 offset:8608
    v_mfma_f32_16x16x32_bf16 v[196:199], a[164:167], a[192:195], v[196:199]
    buffer_load_dwordx4 v115, s[4:7], s65 offen offset:2560 lds
    v_mfma_f32_16x16x32_bf16 v[200:203], a[168:171], a[192:195], v[200:203]
Lpad78:
    s_cbranch_execz Lhret
    ds_read_b128 a[240:243], v21 offset:16672
    s_add_u32 m0, s72, 142368
    v_mfma_f32_16x16x32_bf16 v[204:207], a[172:175], a[192:195], v[204:207]
    ds_read_b128 a[244:247], v21 offset:16928
    v_mfma_f32_16x16x32_bf16 v[220:223], a[172:175], a[196:199], v[220:223]
    buffer_load_dwordx4 v126, s[4:7], s65 offen offset:0 lds
    v_mfma_f32_16x16x32_bf16 v[216:219], a[168:171], a[196:199], v[216:219]
    ds_read_b128 a[248:251], v21 offset:24992
    s_add_u32 m0, s72, 143968
    v_mfma_f32_16x16x32_bf16 v[212:215], a[164:167], a[196:199], v[212:215]
    ds_read_b128 a[252:255], v21 offset:25248
    v_add_u32 v21, 50224, v19
    v_mfma_f32_16x16x32_bf16 v[208:211], a[160:163], a[196:199], v[208:211]
    buffer_load_dwordx4 v126, s[4:7], s65 offen offset:2560 lds
    v_mfma_f32_16x16x32_bf16 v[224:227], a[160:163], a[200:203], v[224:227]
    v_mfma_f32_16x16x32_bf16 v[228:231], a[164:167], a[200:203], v[228:231]
    v_mfma_f32_16x16x32_bf16 v[232:235], a[168:171], a[200:203], v[232:235]
    v_mfma_f32_16x16x32_bf16 v[236:239], a[172:175], a[200:203], v[236:239]
    v_mfma_f32_16x16x32_bf16 v[252:255], a[172:175], a[204:207], v[252:255]
    v_mfma_f32_16x16x32_bf16 v[248:251], a[168:171], a[204:207], v[248:251]
    v_mfma_f32_16x16x32_bf16 v[244:247], a[164:167], a[204:207], v[244:247]
    v_mfma_f32_16x16x32_bf16 v[240:243], a[160:163], a[204:207], v[240:243]
    s_waitcnt vmcnt(14)
    s_waitcnt lgkmcnt(0)
    s_barrier
    v_mfma_f32_16x16x32_bf16 v[128:131], a[208:211], a[224:227], v[128:131]
    ds_read_b64_tr_b16 a[160:161], v22 offset:0
    v_mfma_f32_16x16x32_bf16 v[132:135], a[212:215], a[224:227], v[132:135]
    ds_read_b64_tr_b16 a[162:163], v22 offset:256
    v_mfma_f32_16x16x32_bf16 v[136:139], a[216:219], a[224:227], v[136:139]
    s_add_u32 m0, s73, 0
    s_mul_i32 s66, s64, 221184
    v_mfma_f32_16x16x32_bf16 v[140:143], a[220:223], a[224:227], v[140:143]
    ds_read_b64_tr_b16 a[164:165], v22 offset:32
    v_mfma_f32_16x16x32_bf16 v[156:159], a[220:223], a[228:231], v[156:159]
    ds_read_b64_tr_b16 a[166:167], v22 offset:288
    v_mfma_f32_16x16x32_bf16 v[152:155], a[216:219], a[228:231], v[152:155]
    buffer_load_dwordx4 v18, s[8:11], s66 offen lds
    v_mfma_f32_16x16x32_bf16 v[148:151], a[212:215], a[228:231], v[148:151]
    ds_read_b64_tr_b16 a[168:169], v22 offset:2112
    s_add_u32 m0, s73, 1056
    v_mfma_f32_16x16x32_bf16 v[144:147], a[208:211], a[228:231], v[144:147]
    ds_read_b64_tr_b16 a[170:171], v22 offset:2368
    v_mfma_f32_16x16x32_bf16 v[160:163], a[208:211], a[232:235], v[160:163]
    buffer_load_dwordx4 v127, s[8:11], s66 offen lds
    v_mfma_f32_16x16x32_bf16 v[164:167], a[212:215], a[232:235], v[164:167]
    ds_read_b64_tr_b16 a[172:173], v22 offset:2144
    s_add_u32 m0, s73, 2112
    v_mfma_f32_16x16x32_bf16 v[168:171], a[216:219], a[232:235], v[168:171]
    ds_read_b64_tr_b16 a[174:175], v22 offset:2400
Lpad79:
    s_cbranch_execz Lhret
    v_mfma_f32_16x16x32_bf16 v[172:175], a[220:223], a[232:235], v[172:175]
    buffer_load_dwordx4 v18, s[12:15], s66 offen lds
    v_mfma_f32_16x16x32_bf16 v[188:191], a[220:223], a[236:239], v[188:191]
    ds_read_b128 a[176:179], v21 offset:0
    s_add_u32 m0, s73, 3168
    v_mfma_f32_16x16x32_bf16 v[184:187], a[216:219], a[236:239], v[184:187]
    ds_read_b128 a[180:183], v21 offset:256
    v_mfma_f32_16x16x32_bf16 v[180:183], a[212:215], a[236:239], v[180:183]
    buffer_load_dwordx4 v127, s[12:15], s66 offen lds
    v_mfma_f32_16x16x32_bf16 v[176:179], a[208:211], a[236:239], v[176:179]
    ds_read_b128 a[184:187], v21 offset:8320
    v_mfma_f32_16x16x32_bf16 v[192:195], a[208:211], a[240:243], v[192:195]
    ds_read_b128 a[188:191], v21 offset:8576
    v_mfma_f32_16x16x32_bf16 v[196:199], a[212:215], a[240:243], v[196:199]
    s_add_u32 m0, s72, 16960
    s_lshl_b32 s65, s64, 7
    v_mfma_f32_16x16x32_bf16 v[200:203], a[216:219], a[240:243], v[200:203]
    ds_read_b128 a[192:195], v21 offset:16640
    v_mfma_f32_16x16x32_bf16 v[204:207], a[220:223], a[240:243], v[204:207]
    ds_read_b128 a[196:199], v21 offset:16896
    v_mfma_f32_16x16x32_bf16 v[220:223], a[220:223], a[244:247], v[220:223]
    buffer_load_dwordx4 v17, s[4:7], s65 offen offset:0 lds
    v_mfma_f32_16x16x32_bf16 v[216:219], a[216:219], a[244:247], v[216:219]
    ds_read_b128 a[200:203], v21 offset:24960
    v_mfma_f32_16x16x32_bf16 v[212:215], a[212:215], a[244:247], v[212:215]
    ds_read_b128 a[204:207], v21 offset:25216
    v_mfma_f32_16x16x32_bf16 v[208:211], a[208:211], a[244:247], v[208:211]
    s_add_u32 s64, s64, 1
    s_cmp_eq_u32 s64, 10
    s_cselect_b32 s64, 0, s64
    s_add_u32 m0, s72, 18560
    v_mfma_f32_16x16x32_bf16 v[224:227], a[208:211], a[248:251], v[224:227]
    buffer_load_dwordx4 v17, s[4:7], s65 offen offset:2560 lds
    v_mfma_f32_16x16x32_bf16 v[228:231], a[212:215], a[248:251], v[228:231]
    s_lshl_b32 s76, s3, 11
    s_add_u32 m0, s76, 150672
    s_nop 0
    buffer_load_dwordx4 v24, s[44:47], 0 offen offset:0 lds
    v_mfma_f32_16x16x32_bf16 v[232:235], a[216:219], a[248:251], v[232:235]
    s_lshl_b32 s76, s3, 11
    s_add_u32 m0, s76, 150672
    s_nop 0
    buffer_load_dwordx4 v24, s[44:47], 0 offen offset:1024 lds
    v_mfma_f32_16x16x32_bf16 v[236:239], a[220:223], a[248:251], v[236:239]
    v_mfma_f32_16x16x32_bf16 v[252:255], a[220:223], a[252:255], v[252:255]
    v_mfma_f32_16x16x32_bf16 v[248:251], a[216:219], a[252:255], v[248:251]
    v_mfma_f32_16x16x32_bf16 v[244:247], a[212:215], a[252:255], v[244:247]
    v_mfma_f32_16x16x32_bf16 v[240:243], a[208:211], a[252:255], v[240:243]
    s_waitcnt lgkmcnt(0)
    v_mfma_f32_16x16x32_bf16 v[128:131], a[160:163], a[176:179], v[128:131]
    ds_read_b64_tr_b16 a[208:209], v22 offset:4256
    s_add_u32 m0, s72, 25280
Lpad80:
    s_cbranch_execz Lhret
    v_mfma_f32_16x16x32_bf16 v[132:135], a[164:167], a[176:179], v[132:135]
    ds_read_b64_tr_b16 a[210:211], v22 offset:4512
    v_mfma_f32_16x16x32_bf16 v[136:139], a[168:171], a[176:179], v[136:139]
    buffer_load_dwordx4 v114, s[4:7], s65 offen offset:0 lds
    v_mfma_f32_16x16x32_bf16 v[140:143], a[172:175], a[176:179], v[140:143]
    ds_read_b64_tr_b16 a[212:213], v22 offset:4288
    v_mfma_f32_16x16x32_bf16 v[156:159], a[172:175], a[180:183], v[156:159]
    ds_read_b64_tr_b16 a[214:215], v22 offset:4544
    v_mfma_f32_16x16x32_bf16 v[152:155], a[168:171], a[180:183], v[152:155]
    s_lshl_b32 s76, s75, 7
    buffer_load_dwordx4 v[64:67], v112, s[4:7], s76 offen
    v_mfma_f32_16x16x32_bf16 v[148:151], a[164:167], a[180:183], v[148:151]
    ds_read_b64_tr_b16 a[216:217], v22 offset:6368
    s_add_u32 m0, s72, 26880
    v_mfma_f32_16x16x32_bf16 v[144:147], a[160:163], a[180:183], v[144:147]
    ds_read_b64_tr_b16 a[218:219], v22 offset:6624
    v_mfma_f32_16x16x32_bf16 v[160:163], a[160:163], a[184:187], v[160:163]
    buffer_load_dwordx4 v114, s[4:7], s65 offen offset:2560 lds
    v_mfma_f32_16x16x32_bf16 v[164:167], a[164:167], a[184:187], v[164:167]
    ds_read_b64_tr_b16 a[220:221], v22 offset:6400
    v_mfma_f32_16x16x32_bf16 v[168:171], a[168:171], a[184:187], v[168:171]
    ds_read_b64_tr_b16 a[222:223], v22 offset:6656
    v_add_u32 v22, 100448, v20
    v_mfma_f32_16x16x32_bf16 v[172:175], a[172:175], a[184:187], v[172:175]
    s_add_u32 s75, s75, 1
    s_cmp_eq_u32 s75, 10
    s_cselect_b32 s75, 0, s75
    v_mfma_f32_16x16x32_bf16 v[188:191], a[172:175], a[188:191], v[188:191]
    ds_read_b128 a[224:227], v21 offset:32
    s_add_u32 m0, s72, 33600
    v_mfma_f32_16x16x32_bf16 v[184:187], a[168:171], a[188:191], v[184:187]
    ds_read_b128 a[228:231], v21 offset:288
    v_mfma_f32_16x16x32_bf16 v[180:183], a[164:167], a[188:191], v[180:183]
    buffer_load_dwordx4 v115, s[4:7], s65 offen offset:0 lds
    v_mfma_f32_16x16x32_bf16 v[176:179], a[160:163], a[188:191], v[176:179]
    ds_read_b128 a[232:235], v21 offset:8352
    v_mfma_f32_16x16x32_bf16 v[192:195], a[160:163], a[192:195], v[192:195]
    ds_read_b128 a[236:239], v21 offset:8608
    v_mfma_f32_16x16x32_bf16 v[196:199], a[164:167], a[192:195], v[196:199]
    buffer_load_dwordx2 v[36:37], v35, s[20:23], 0 offen sc1
    v_mfma_f32_16x16x32_bf16 v[200:203], a[168:171], a[192:195], v[200:203]
    ds_read_b128 a[240:243], v21 offset:16672
    s_add_u32 m0, s72, 35200
    v_mfma_f32_16x16x32_bf16 v[204:207], a[172:175], a[192:195], v[204:207]
    ds_read_b128 a[244:247], v21 offset:16928
    v_mfma_f32_16x16x32_bf16 v[220:223], a[172:175], a[196:199], v[220:223]
    buffer_load_dwordx4 v115, s[4:7], s65 offen offset:2560 lds
    v_mfma_f32_16x16x32_bf16 v[216:219], a[168:171], a[196:199], v[216:219]
    ds_read_b128 a[248:251], v21 offset:24992
    s_add_u32 m0, s72, 41920
Lpad81:
    s_cbranch_execz Lhret
    v_mfma_f32_16x16x32_bf16 v[212:215], a[164:167], a[196:199], v[212:215]
    ds_read_b128 a[252:255], v21 offset:25248
    v_add_u32 v21, 100448, v19
    v_mfma_f32_16x16x32_bf16 v[208:211], a[160:163], a[196:199], v[208:211]
    buffer_load_dwordx4 v126, s[4:7], s65 offen offset:0 lds
    v_mfma_f32_16x16x32_bf16 v[224:227], a[160:163], a[200:203], v[224:227]
    s_add_u32 m0, s72, 43520
    v_mfma_f32_16x16x32_bf16 v[228:231], a[164:167], a[200:203], v[228:231]
    buffer_load_dwordx4 v126, s[4:7], s65 offen offset:2560 lds
    v_mfma_f32_16x16x32_bf16 v[232:235], a[168:171], a[200:203], v[232:235]
    v_mfma_f32_16x16x32_bf16 v[236:239], a[172:175], a[200:203], v[236:239]
    v_mfma_f32_16x16x32_bf16 v[252:255], a[172:175], a[204:207], v[252:255]
    v_mfma_f32_16x16x32_bf16 v[248:251], a[168:171], a[204:207], v[248:251]
    v_mfma_f32_16x16x32_bf16 v[244:247], a[164:167], a[204:207], v[244:247]
    v_mfma_f32_16x16x32_bf16 v[240:243], a[160:163], a[204:207], v[240:243]
    s_waitcnt vmcnt(16)
    s_waitcnt lgkmcnt(0)
    s_barrier
    v_mfma_f32_16x16x32_bf16 v[128:131], a[208:211], a[224:227], v[128:131]
    ds_read_b64_tr_b16 a[160:161], v22 offset:0
    v_mfma_f32_16x16x32_bf16 v[132:135], a[212:215], a[224:227], v[132:135]
    ds_read_b64_tr_b16 a[162:163], v22 offset:256
    v_mfma_f32_16x16x32_bf16 v[136:139], a[216:219], a[224:227], v[136:139]
    s_lshl_b32 s76, s75, 7
    buffer_load_dwordx4 v[68:71], v112, s[4:7], s76 offen
    v_mfma_f32_16x16x32_bf16 v[140:143], a[220:223], a[224:227], v[140:143]
    ds_read_b64_tr_b16 a[164:165], v22 offset:32
    v_mfma_f32_16x16x32_bf16 v[156:159], a[220:223], a[228:231], v[156:159]
    ds_read_b64_tr_b16 a[166:167], v22 offset:288
    v_mfma_f32_16x16x32_bf16 v[152:155], a[216:219], a[228:231], v[152:155]
    s_add_u32 s75, s75, 1
    s_cmp_eq_u32 s75, 10
    s_cselect_b32 s75, 0, s75
    v_mfma_f32_16x16x32_bf16 v[148:151], a[212:215], a[228:231], v[148:151]
    ds_read_b64_tr_b16 a[168:169], v22 offset:2112
    v_mfma_f32_16x16x32_bf16 v[144:147], a[208:211], a[228:231], v[144:147]
    ds_read_b64_tr_b16 a[170:171], v22 offset:2368
    v_mfma_f32_16x16x32_bf16 v[160:163], a[208:211], a[232:235], v[160:163]
    s_lshl_b32 s76, s75, 7
    buffer_load_dwordx4 v[72:75], v112, s[4:7], s76 offen
    v_mfma_f32_16x16x32_bf16 v[164:167], a[212:215], a[232:235], v[164:167]
    ds_read_b64_tr_b16 a[172:173], v22 offset:2144
    v_mfma_f32_16x16x32_bf16 v[168:171], a[216:219], a[232:235], v[168:171]
    ds_read_b64_tr_b16 a[174:175], v22 offset:2400
    v_mfma_f32_16x16x32_bf16 v[172:175], a[220:223], a[232:235], v[172:175]
    s_add_u32 s75, s75, 1
    s_cmp_eq_u32 s75, 10
    s_cselect_b32 s75, 0, s75
    v_mfma_f32_16x16x32_bf16 v[188:191], a[220:223], a[236:239], v[188:191]
    ds_read_b128 a[176:179], v21 offset:0
    v_mfma_f32_16x16x32_bf16 v[184:187], a[216:219], a[236:239], v[184:187]
    ds_read_b128 a[180:183], v21 offset:256
    v_mfma_f32_16x16x32_bf16 v[180:183], a[212:215], a[236:239], v[180:183]
Lpad82:
    s_cbranch_execz Lhret
    s_lshl_b32 s76, s75, 7
    buffer_load_dwordx4 v[76:79], v112, s[4:7], s76 offen
    v_mfma_f32_16x16x32_bf16 v[176:179], a[208:211], a[236:239], v[176:179]
    ds_read_b128 a[184:187], v21 offset:8320
    v_mfma_f32_16x16x32_bf16 v[192:195], a[208:211], a[240:243], v[192:195]
    ds_read_b128 a[188:191], v21 offset:8576
    v_mfma_f32_16x16x32_bf16 v[196:199], a[212:215], a[240:243], v[196:199]
    s_add_u32 s75, s75, 1
    s_cmp_eq_u32 s75, 10
    s_cselect_b32 s75, 0, s75
    v_mfma_f32_16x16x32_bf16 v[200:203], a[216:219], a[240:243], v[200:203]
    ds_read_b128 a[192:195], v21 offset:16640
    v_mfma_f32_16x16x32_bf16 v[204:207], a[220:223], a[240:243], v[204:207]
    ds_read_b128 a[196:199], v21 offset:16896
    v_mfma_f32_16x16x32_bf16 v[220:223], a[220:223], a[244:247], v[220:223]
    ds_read_b128 a[200:203], v21 offset:24960
    v_mfma_f32_16x16x32_bf16 v[216:219], a[216:219], a[244:247], v[216:219]
    ds_read_b128 a[204:207], v21 offset:25216
    v_mfma_f32_16x16x32_bf16 v[212:215], a[212:215], a[244:247], v[212:215]
    v_mfma_f32_16x16x32_bf16 v[208:211], a[208:211], a[244:247], v[208:211]
    v_mfma_f32_16x16x32_bf16 v[224:227], a[208:211], a[248:251], v[224:227]
    v_mfma_f32_16x16x32_bf16 v[228:231], a[212:215], a[248:251], v[228:231]
    v_mfma_f32_16x16x32_bf16 v[232:235], a[216:219], a[248:251], v[232:235]
    v_mfma_f32_16x16x32_bf16 v[236:239], a[220:223], a[248:251], v[236:239]
    v_mfma_f32_16x16x32_bf16 v[252:255], a[220:223], a[252:255], v[252:255]
    v_mfma_f32_16x16x32_bf16 v[248:251], a[216:219], a[252:255], v[248:251]
    v_mfma_f32_16x16x32_bf16 v[244:247], a[212:215], a[252:255], v[244:247]
    v_mfma_f32_16x16x32_bf16 v[240:243], a[208:211], a[252:255], v[240:243]
    s_waitcnt lgkmcnt(0)
    v_mfma_f32_16x16x32_bf16 v[128:131], a[160:163], a[176:179], v[128:131]
    ds_read_b64_tr_b16 a[208:209], v22 offset:4256
    s_waitcnt vmcnt(6)
    v_mfma_f32_16x16x32_bf16 v[132:135], a[164:167], a[176:179], v[132:135]
    ds_read_b64_tr_b16 a[210:211], v22 offset:4512
    v_cmp_ne_u64 vcc, s[56:57], v[36:37]
    v_mfma_f32_16x16x32_bf16 v[136:139], a[168:171], a[176:179], v[136:139]
    s_nop 1
    s_cmp_eq_u32 vcc_lo, 0
    s_cselect_b32 s79, s80, 2130706432
    v_mfma_f32_16x16x32_bf16 v[140:143], a[172:175], a[176:179], v[140:143]
    ds_read_b64_tr_b16 a[212:213], v22 offset:4288
    v_mfma_f32_16x16x32_bf16 v[156:159], a[172:175], a[180:183], v[156:159]
    ds_read_b64_tr_b16 a[214:215], v22 offset:4544
    v_mfma_f32_16x16x32_bf16 v[152:155], a[168:171], a[180:183], v[152:155]
    s_add_u32 s70, s79, 0
    buffer_load_dwordx4 a[0:3], v24, s[20:23], s70 offen offset:0 sc1
    v_mfma_f32_16x16x32_bf16 v[148:151], a[164:167], a[180:183], v[148:151]
    ds_read_b64_tr_b16 a[216:217], v22 offset:6368
    v_mfma_f32_16x16x32_bf16 v[144:147], a[160:163], a[180:183], v[144:147]
    ds_read_b64_tr_b16 a[218:219], v22 offset:6624
    v_mfma_f32_16x16x32_bf16 v[160:163], a[160:163], a[184:187], v[160:163]
    buffer_load_dwordx4 a[4:7], v24, s[20:23], s70 offen offset:1024 sc1
    v_mfma_f32_16x16x32_bf16 v[164:167], a[164:167], a[184:187], v[164:167]
Lpad83:
    s_cbranch_execz Lhret
    ds_read_b64_tr_b16 a[220:221], v22 offset:6400
    v_mfma_f32_16x16x32_bf16 v[168:171], a[168:171], a[184:187], v[168:171]
    ds_read_b64_tr_b16 a[222:223], v22 offset:6656
    v_add_u32 v22, 0, v20
    v_mfma_f32_16x16x32_bf16 v[172:175], a[172:175], a[184:187], v[172:175]
    buffer_load_dwordx4 a[8:11], v24, s[20:23], s70 offen offset:2048 sc1
    v_mfma_f32_16x16x32_bf16 v[188:191], a[172:175], a[188:191], v[188:191]
    ds_read_b128 a[224:227], v21 offset:32
    v_mfma_f32_16x16x32_bf16 v[184:187], a[168:171], a[188:191], v[184:187]
    ds_read_b128 a[228:231], v21 offset:288
    v_mfma_f32_16x16x32_bf16 v[180:183], a[164:167], a[188:191], v[180:183]
    buffer_load_dwordx4 a[12:15], v24, s[20:23], s70 offen offset:3072 sc1
    v_mfma_f32_16x16x32_bf16 v[176:179], a[160:163], a[188:191], v[176:179]
    ds_read_b128 a[232:235], v21 offset:8352
    v_mfma_f32_16x16x32_bf16 v[192:195], a[160:163], a[192:195], v[192:195]
    ds_read_b128 a[236:239], v21 offset:8608
    v_mfma_f32_16x16x32_bf16 v[196:199], a[164:167], a[192:195], v[196:199]
    s_add_u32 s70, s79, 4096
    buffer_load_dwordx4 a[16:19], v24, s[20:23], s70 offen offset:0 sc1
    v_mfma_f32_16x16x32_bf16 v[200:203], a[168:171], a[192:195], v[200:203]
    ds_read_b128 a[240:243], v21 offset:16672
    v_mfma_f32_16x16x32_bf16 v[204:207], a[172:175], a[192:195], v[204:207]
    ds_read_b128 a[244:247], v21 offset:16928
    v_mfma_f32_16x16x32_bf16 v[220:223], a[172:175], a[196:199], v[220:223]
    buffer_load_dwordx4 a[20:23], v24, s[20:23], s70 offen offset:1024 sc1
    v_mfma_f32_16x16x32_bf16 v[216:219], a[168:171], a[196:199], v[216:219]
    ds_read_b128 a[248:251], v21 offset:24992
    v_mfma_f32_16x16x32_bf16 v[212:215], a[164:167], a[196:199], v[212:215]
    ds_read_b128 a[252:255], v21 offset:25248
Lpad84:
    s_cbranch_execz Lhret
    v_add_u32 v21, 0, v19
    v_mfma_f32_16x16x32_bf16 v[208:211], a[160:163], a[196:199], v[208:211]
    v_mfma_f32_16x16x32_bf16 v[224:227], a[160:163], a[200:203], v[224:227]
    v_mfma_f32_16x16x32_bf16 v[228:231], a[164:167], a[200:203], v[228:231]
    v_mfma_f32_16x16x32_bf16 v[232:235], a[168:171], a[200:203], v[232:235]
    v_mfma_f32_16x16x32_bf16 v[236:239], a[172:175], a[200:203], v[236:239]
    v_mfma_f32_16x16x32_bf16 v[252:255], a[172:175], a[204:207], v[252:255]
    v_mfma_f32_16x16x32_bf16 v[248:251], a[168:171], a[204:207], v[248:251]
    v_mfma_f32_16x16x32_bf16 v[244:247], a[164:167], a[204:207], v[244:247]
    v_mfma_f32_16x16x32_bf16 v[240:243], a[160:163], a[204:207], v[240:243]
    s_waitcnt vmcnt(9)
    s_waitcnt lgkmcnt(0)
    s_barrier
    v_mfma_f32_16x16x32_bf16 v[128:131], a[208:211], a[224:227], v[128:131]
    ds_read_b64_tr_b16 a[160:161], v22 offset:0
    v_mfma_f32_16x16x32_bf16 v[132:135], a[212:215], a[224:227], v[132:135]
    ds_read_b64_tr_b16 a[162:163], v22 offset:256
    v_mfma_f32_16x16x32_bf16 v[136:139], a[216:219], a[224:227], v[136:139]
    buffer_load_dwordx2 v[36:37], v35, s[20:23], 0 offen sc1
    v_mfma_f32_16x16x32_bf16 v[140:143], a[220:223], a[224:227], v[140:143]
    ds_read_b64_tr_b16 a[164:165], v22 offset:32
    v_mfma_f32_16x16x32_bf16 v[156:159], a[220:223], a[228:231], v[156:159]
    ds_read_b64_tr_b16 a[166:167], v22 offset:288
    v_mfma_f32_16x16x32_bf16 v[152:155], a[216:219], a[228:231], v[152:155]
    s_add_u32 s70, s79, 4096
    buffer_load_dwordx4 a[24:27], v24, s[20:23], s70 offen offset:2048 sc1
    v_mfma_f32_16x16x32_bf16 v[148:151], a[212:215], a[228:231], v[148:151]
    ds_read_b64_tr_b16 a[168:169], v22 offset:2112
    v_mfma_f32_16x16x32_bf16 v[144:147], a[208:211], a[228:231], v[144:147]
    ds_read_b64_tr_b16 a[170:171], v22 offset:2368
    v_mfma_f32_16x16x32_bf16 v[160:163], a[208:211], a[232:235], v[160:163]
    buffer_load_dwordx4 a[28:31], v24, s[20:23], s70 offen offset:3072 sc1
    v_mfma_f32_16x16x32_bf16 v[164:167], a[212:215], a[232:235], v[164:167]
    ds_read_b64_tr_b16 a[172:173], v22 offset:2144
    v_mfma_f32_16x16x32_bf16 v[168:171], a[216:219], a[232:235], v[168:171]
    ds_read_b64_tr_b16 a[174:175], v22 offset:2400
    v_mfma_f32_16x16x32_bf16 v[172:175], a[220:223], a[232:235], v[172:175]
    s_add_u32 s70, s79, 8192
    buffer_load_dwordx4 a[32:35], v24, s[20:23], s70 offen offset:0 sc1
    v_mfma_f32_16x16x32_bf16 v[188:191], a[220:223], a[236:239], v[188:191]
    ds_read_b128 a[176:179], v21 offset:0
    v_mfma_f32_16x16x32_bf16 v[184:187], a[216:219], a[236:239], v[184:187]
    ds_read_b128 a[180:183], v21 offset:256
    v_mfma_f32_16x16x32_bf16 v[180:183], a[212:215], a[236:239], v[180:183]
    buffer_load_dwordx4 a[36:39], v24, s[20:23], s70 offen offset:1024 sc1
    v_mfma_f32_16x16x32_bf16 v[176:179], a[208:211], a[236:239], v[176:179]
    ds_read_b128 a[184:187], v21 offset:8320
    v_mfma_f32_16x16x32_bf16 v[192:195], a[208:211], a[240:243], v[192:195]
    ds_read_b128 a[188:191], v21 offset:8576
    v_mfma_f32_16x16x32_bf16 v[196:199], a[212:215], a[240:243], v[196:199]
Lpad85:
    s_cbranch_execz Lhret
    buffer_load_dwordx4 a[40:43], v24, s[20:23], s70 offen offset:2048 sc1
    v_mfma_f32_16x16x32_bf16 v[200:203], a[216:219], a[240:243], v[200:203]
    ds_read_b128 a[192:195], v21 offset:16640
    v_mfma_f32_16x16x32_bf16 v[204:207], a[220:223], a[240:243], v[204:207]
    ds_read_b128 a[196:199], v21 offset:16896
    v_mfma_f32_16x16x32_bf16 v[220:223], a[220:223], a[244:247], v[220:223]
    buffer_load_dwordx4 a[44:47], v24, s[20:23], s70 offen offset:3072 sc1
    v_mfma_f32_16x16x32_bf16 v[216:219], a[216:219], a[244:247], v[216:219]
    ds_read_b128 a[200:203], v21 offset:24960
    v_mfma_f32_16x16x32_bf16 v[212:215], a[212:215], a[244:247], v[212:215]
    ds_read_b128 a[204:207], v21 offset:25216
    v_mfma_f32_16x16x32_bf16 v[208:211], a[208:211], a[244:247], v[208:211]
    v_mfma_f32_16x16x32_bf16 v[224:227], a[208:211], a[248:251], v[224:227]
    v_mfma_f32_16x16x32_bf16 v[228:231], a[212:215], a[248:251], v[228:231]
    v_mfma_f32_16x16x32_bf16 v[232:235], a[216:219], a[248:251], v[232:235]
    v_mfma_f32_16x16x32_bf16 v[236:239], a[220:223], a[248:251], v[236:239]
    v_mfma_f32_16x16x32_bf16 v[252:255], a[220:223], a[252:255], v[252:255]
    v_mfma_f32_16x16x32_bf16 v[248:251], a[216:219], a[252:255], v[248:251]
    v_mfma_f32_16x16x32_bf16 v[244:247], a[212:215], a[252:255], v[244:247]
    v_mfma_f32_16x16x32_bf16 v[240:243], a[208:211], a[252:255], v[240:243]
    s_waitcnt lgkmcnt(0)
    v_mfma_f32_16x16x32_bf16 v[128:131], a[160:163], a[176:179], v[128:131]
    ds_read_b64_tr_b16 a[208:209], v22 offset:4256
    v_mfma_f32_16x16x32_bf16 v[132:135], a[164:167], a[176:179], v[132:135]
    ds_read_b64_tr_b16 a[210:211], v22 offset:4512
    v_mfma_f32_16x16x32_bf16 v[136:139], a[168:171], a[176:179], v[136:139]
    s_add_u32 s70, s79, 12288
    buffer_load_dwordx4 a[48:51], v24, s[20:23], s70 offen offset:0 sc1
    v_mfma_f32_16x16x32_bf16 v[140:143], a[172:175], a[176:179], v[140:143]
    ds_read_b64_tr_b16 a[212:213], v22 offset:4288
    v_mfma_f32_16x16x32_bf16 v[156:159], a[172:175], a[180:183], v[156:159]
    ds_read_b64_tr_b16 a[214:215], v22 offset:4544
    v_mfma_f32_16x16x32_bf16 v[152:155], a[168:171], a[180:183], v[152:155]
    buffer_load_dwordx4 a[52:55], v24, s[20:23], s70 offen offset:1024 sc1
    v_mfma_f32_16x16x32_bf16 v[148:151], a[164:167], a[180:183], v[148:151]
    ds_read_b64_tr_b16 a[216:217], v22 offset:6368
    v_mfma_f32_16x16x32_bf16 v[144:147], a[160:163], a[180:183], v[144:147]
    ds_read_b64_tr_b16 a[218:219], v22 offset:6624
    v_mfma_f32_16x16x32_bf16 v[160:163], a[160:163], a[184:187], v[160:163]
    buffer_load_dwordx4 a[56:59], v24, s[20:23], s70 offen offset:2048 sc1
    v_mfma_f32_16x16x32_bf16 v[164:167], a[164:167], a[184:187], v[164:167]
    ds_read_b64_tr_b16 a[220:221], v22 offset:6400
    v_mfma_f32_16x16x32_bf16 v[168:171], a[168:171], a[184:187], v[168:171]
    ds_read_b64_tr_b16 a[222:223], v22 offset:6656
    v_mfma_f32_16x16x32_bf16 v[172:175], a[172:175], a[184:187], v[172:175]
    buffer_load_dwordx4 a[60:63], v24, s[20:23], s70 offen offset:3072 sc1
    v_mfma_f32_16x16x32_bf16 v[188:191], a[172:175], a[188:191], v[188:191]
    ds_read_b128 a[224:227], v21 offset:32
Lpad86:
    s_cbranch_execz Lhret
    v_mfma_f32_16x16x32_bf16 v[184:187], a[168:171], a[188:191], v[184:187]
    ds_read_b128 a[228:231], v21 offset:288
    v_mfma_f32_16x16x32_bf16 v[180:183], a[164:167], a[188:191], v[180:183]
    s_add_u32 s70, s79, 16384
    buffer_load_dwordx4 a[64:67], v24, s[20:23], s70 offen offset:0 sc1
    v_mfma_f32_16x16x32_bf16 v[176:179], a[160:163], a[188:191], v[176:179]
    ds_read_b128 a[232:235], v21 offset:8352
    v_mfma_f32_16x16x32_bf16 v[192:195], a[160:163], a[192:195], v[192:195]
    ds_read_b128 a[236:239], v21 offset:8608
    v_mfma_f32_16x16x32_bf16 v[196:199], a[164:167], a[192:195], v[196:199]
    buffer_load_dwordx4 a[68:71], v24, s[20:23], s70 offen offset:1024 sc1
    v_mfma_f32_16x16x32_bf16 v[200:203], a[168:171], a[192:195], v[200:203]
    ds_read_b128 a[240:243], v21 offset:16672
    s_waitcnt vmcnt(12)
    v_mfma_f32_16x16x32_bf16 v[204:207], a[172:175], a[192:195], v[204:207]
    ds_read_b128 a[244:247], v21 offset:16928
    v_cmp_ne_u64 vcc, s[56:57], v[36:37]
    v_mfma_f32_16x16x32_bf16 v[220:223], a[172:175], a[196:199], v[220:223]
    s_mov_b32 s71, s79
    s_nop 0
    v_mfma_f32_16x16x32_bf16 v[216:219], a[168:171], a[196:199], v[216:219]
    ds_read_b128 a[248:251], v21 offset:24992
    v_mfma_f32_16x16x32_bf16 v[212:215], a[164:167], a[196:199], v[212:215]
    ds_read_b128 a[252:255], v21 offset:25248
    v_mfma_f32_16x16x32_bf16 v[208:211], a[160:163], a[196:199], v[208:211]
    s_cmp_eq_u32 vcc_lo, 0
    s_cselect_b32 s79, s80, s79
    v_mfma_f32_16x16x32_bf16 v[224:227], a[160:163], a[200:203], v[224:227]
    v_mfma_f32_16x16x32_bf16 v[228:231], a[164:167], a[200:203], v[228:231]
    v_mfma_f32_16x16x32_bf16 v[232:235], a[168:171], a[200:203], v[232:235]
    v_mfma_f32_16x16x32_bf16 v[236:239], a[172:175], a[200:203], v[236:239]
    v_mfma_f32_16x16x32_bf16 v[252:255], a[172:175], a[204:207], v[252:255]
    v_mfma_f32_16x16x32_bf16 v[248:251], a[168:171], a[204:207], v[248:251]
    v_mfma_f32_16x16x32_bf16 v[244:247], a[164:167], a[204:207], v[244:247]
    v_mfma_f32_16x16x32_bf16 v[240:243], a[160:163], a[204:207], v[240:243]
    s_waitcnt lgkmcnt(0)
    s_barrier
    v_mfma_f32_16x16x32_bf16 v[128:131], a[208:211], a[224:227], v[128:131]
    s_add_u32 s70, s79, 16384
    buffer_load_dwordx4 a[72:75], v24, s[20:23], s70 offen offset:2048 sc1
    v_mfma_f32_16x16x32_bf16 v[132:135], a[212:215], a[224:227], v[132:135]
    buffer_load_dwordx4 a[76:79], v24, s[20:23], s70 offen offset:3072 sc1
    v_mfma_f32_16x16x32_bf16 v[136:139], a[216:219], a[224:227], v[136:139]
    s_add_u32 s70, s79, 20480
    buffer_load_dwordx4 a[80:83], v24, s[20:23], s70 offen offset:0 sc1
    v_mfma_f32_16x16x32_bf16 v[140:143], a[220:223], a[224:227], v[140:143]
    buffer_load_dwordx4 a[84:87], v24, s[20:23], s70 offen offset:1024 sc1
    v_mfma_f32_16x16x32_bf16 v[156:159], a[220:223], a[228:231], v[156:159]
    buffer_load_dwordx4 a[88:91], v24, s[20:23], s70 offen offset:2048 sc1
    v_mfma_f32_16x16x32_bf16 v[152:155], a[216:219], a[228:231], v[152:155]
    buffer_load_dwordx4 a[92:95], v24, s[20:23], s70 offen offset:3072 sc1
    v_mfma_f32_16x16x32_bf16 v[148:151], a[212:215], a[228:231], v[148:151]
Lpad87:
    s_cbranch_execz Lhret
    s_add_u32 s70, s79, 24576
    buffer_load_dwordx4 a[96:99], v24, s[20:23], s70 offen offset:0 sc1
    v_mfma_f32_16x16x32_bf16 v[144:147], a[208:211], a[228:231], v[144:147]
    v_mfma_f32_16x16x32_bf16 v[160:163], a[208:211], a[232:235], v[160:163]
    v_mfma_f32_16x16x32_bf16 v[164:167], a[212:215], a[232:235], v[164:167]
    v_mfma_f32_16x16x32_bf16 v[168:171], a[216:219], a[232:235], v[168:171]
    v_mfma_f32_16x16x32_bf16 v[172:175], a[220:223], a[232:235], v[172:175]
    v_mfma_f32_16x16x32_bf16 v[188:191], a[220:223], a[236:239], v[188:191]
    v_mfma_f32_16x16x32_bf16 v[184:187], a[216:219], a[236:239], v[184:187]
    v_mfma_f32_16x16x32_bf16 v[180:183], a[212:215], a[236:239], v[180:183]
    v_mfma_f32_16x16x32_bf16 v[176:179], a[208:211], a[236:239], v[176:179]
    v_mfma_f32_16x16x32_bf16 v[192:195], a[208:211], a[240:243], v[192:195]
    v_mfma_f32_16x16x32_bf16 v[196:199], a[212:215], a[240:243], v[196:199]
    v_mfma_f32_16x16x32_bf16 v[200:203], a[216:219], a[240:243], v[200:203]
    v_mfma_f32_16x16x32_bf16 v[204:207], a[220:223], a[240:243], v[204:207]
    v_mfma_f32_16x16x32_bf16 v[220:223], a[220:223], a[244:247], v[220:223]
    v_mfma_f32_16x16x32_bf16 v[216:219], a[216:219], a[244:247], v[216:219]
    v_mfma_f32_16x16x32_bf16 v[212:215], a[212:215], a[244:247], v[212:215]
    v_mfma_f32_16x16x32_bf16 v[208:211], a[208:211], a[244:247], v[208:211]
    v_mfma_f32_16x16x32_bf16 v[224:227], a[208:211], a[248:251], v[224:227]
    v_mfma_f32_16x16x32_bf16 v[228:231], a[212:215], a[248:251], v[228:231]
    v_mfma_f32_16x16x32_bf16 v[232:235], a[216:219], a[248:251], v[232:235]
    v_mfma_f32_16x16x32_bf16 v[236:239], a[220:223], a[248:251], v[236:239]
    v_mfma_f32_16x16x32_bf16 v[252:255], a[220:223], a[252:255], v[252:255]
    v_mfma_f32_16x16x32_bf16 v[248:251], a[216:219], a[252:255], v[248:251]
    v_mfma_f32_16x16x32_bf16 v[244:247], a[212:215], a[252:255], v[244:247]
    v_mfma_f32_16x16x32_bf16 v[240:243], a[208:211], a[252:255], v[240:243]
    s_mov_b32 s94, 0xbfb8aa3b
    s_mov_b32 s95, 0xbfb8aa3b
    s_mov_b32 s98, 1.0
    s_mov_b32 s99, 1.0
    s_nop 3
    s_add_u32 s70, s79, 24576
    buffer_load_dwordx4 a[100:103], v24, s[20:23], s70 offen offset:1024 sc1
    v_pk_mul_f32 v[4:5], v[128:129], s[94:95]
    v_pk_mul_f32 v[6:7], v[130:131], s[94:95]
    v_pk_mul_f32 v[8:9], v[132:133], s[94:95]
    v_pk_mul_f32 v[10:11], v[134:135], s[94:95]
    v_exp_f32 v4, v4
    v_exp_f32 v5, v5
    v_exp_f32 v6, v6
    v_exp_f32 v7, v7
    v_exp_f32 v8, v8
    v_exp_f32 v9, v9
    v_exp_f32 v10, v10
    v_exp_f32 v11, v11
    v_pk_mul_f32 v[128:129], v[128:129], v[136:137]
    v_pk_mul_f32 v[130:131], v[130:131], v[138:139]
    v_pk_mul_f32 v[132:133], v[132:133], v[140:141]
    v_pk_mul_f32 v[134:135], v[134:135], v[142:143]
    v_pk_add_f32 v[4:5], v[4:5], s[98:99]
    v_pk_add_f32 v[6:7], v[6:7], s[98:99]
    v_pk_add_f32 v[8:9], v[8:9], s[98:99]
Lpad88:
    s_cbranch_execz Lhret
    v_pk_add_f32 v[10:11], v[10:11], s[98:99]
    v_rcp_f32 v4, v4
    v_rcp_f32 v5, v5
    v_rcp_f32 v6, v6
    v_rcp_f32 v7, v7
    v_rcp_f32 v8, v8
    v_rcp_f32 v9, v9
    v_rcp_f32 v10, v10
    v_rcp_f32 v11, v11
    s_mov_b32 s93, 0
    v_pk_mul_f32 v[128:129], v[128:129], v[4:5]
    v_pk_mul_f32 v[130:131], v[130:131], v[6:7]
    v_pk_mul_f32 v[132:133], v[132:133], v[8:9]
    v_pk_mul_f32 v[134:135], v[134:135], v[10:11]
    v_cvt_pk_bf16_f32 v12, v128, v129
    v_cvt_pk_bf16_f32 v13, v130, v131
    v_cvt_pk_bf16_f32 v14, v132, v133
    v_cvt_pk_bf16_f32 v15, v134, v135
    buffer_store_dwordx4 v[12:15], v23, s[20:23], s93 offen sc1
    s_add_u32 s70, s79, 24576
    buffer_load_dwordx4 a[104:107], v24, s[20:23], s70 offen offset:2048 sc1
    v_pk_mul_f32 v[128:129], v[144:145], s[94:95]
    v_pk_mul_f32 v[130:131], v[146:147], s[94:95]
    v_pk_mul_f32 v[132:133], v[148:149], s[94:95]
    v_pk_mul_f32 v[134:135], v[150:151], s[94:95]
    v_exp_f32 v128, v128
    v_exp_f32 v129, v129
    v_exp_f32 v130, v130
    v_exp_f32 v131, v131
    v_exp_f32 v132, v132
    v_exp_f32 v133, v133
    v_exp_f32 v134, v134
    v_exp_f32 v135, v135
    v_pk_mul_f32 v[144:145], v[144:145], v[152:153]
    v_pk_mul_f32 v[146:147], v[146:147], v[154:155]
    v_pk_mul_f32 v[148:149], v[148:149], v[156:157]
    v_pk_mul_f32 v[150:151], v[150:151], v[158:159]
    v_pk_add_f32 v[128:129], v[128:129], s[98:99]
    v_pk_add_f32 v[130:131], v[130:131], s[98:99]
    v_pk_add_f32 v[132:133], v[132:133], s[98:99]
    v_pk_add_f32 v[134:135], v[134:135], s[98:99]
    v_rcp_f32 v128, v128
    v_rcp_f32 v129, v129
    v_rcp_f32 v130, v130
    v_rcp_f32 v131, v131
    v_rcp_f32 v132, v132
    v_rcp_f32 v133, v133
    v_rcp_f32 v134, v134
    v_rcp_f32 v135, v135
    s_mov_b32 s93, 55296
    v_pk_mul_f32 v[144:145], v[144:145], v[128:129]
    v_pk_mul_f32 v[146:147], v[146:147], v[130:131]
    v_pk_mul_f32 v[148:149], v[148:149], v[132:133]
    v_pk_mul_f32 v[150:151], v[150:151], v[134:135]
    v_cvt_pk_bf16_f32 v136, v144, v145
    v_cvt_pk_bf16_f32 v137, v146, v147
    v_cvt_pk_bf16_f32 v138, v148, v149
    v_cvt_pk_bf16_f32 v139, v150, v151
    buffer_store_dwordx4 v[136:139], v23, s[20:23], s93 offen sc1
    s_add_u32 s70, s79, 24576
Lpad89:
    s_cbranch_execz Lhret
    buffer_load_dwordx4 a[108:111], v24, s[20:23], s70 offen offset:3072 sc1
    v_pk_mul_f32 v[144:145], v[160:161], s[94:95]
    v_pk_mul_f32 v[146:147], v[162:163], s[94:95]
    v_pk_mul_f32 v[148:149], v[164:165], s[94:95]
    v_pk_mul_f32 v[150:151], v[166:167], s[94:95]
    v_exp_f32 v144, v144
    v_exp_f32 v145, v145
    v_exp_f32 v146, v146
    v_exp_f32 v147, v147
    v_exp_f32 v148, v148
    v_exp_f32 v149, v149
    v_exp_f32 v150, v150
    v_exp_f32 v151, v151
    v_pk_mul_f32 v[160:161], v[160:161], v[168:169]
    v_pk_mul_f32 v[162:163], v[162:163], v[170:171]
    v_pk_mul_f32 v[164:165], v[164:165], v[172:173]
    v_pk_mul_f32 v[166:167], v[166:167], v[174:175]
    v_pk_add_f32 v[144:145], v[144:145], s[98:99]
    v_pk_add_f32 v[146:147], v[146:147], s[98:99]
    v_pk_add_f32 v[148:149], v[148:149], s[98:99]
    v_pk_add_f32 v[150:151], v[150:151], s[98:99]
    v_rcp_f32 v144, v144
    v_rcp_f32 v145, v145
    v_rcp_f32 v146, v146
    v_rcp_f32 v147, v147
    v_rcp_f32 v148, v148
    v_rcp_f32 v149, v149
    v_rcp_f32 v150, v150
    v_rcp_f32 v151, v151
    s_mov_b32 s93, 221184
    v_pk_mul_f32 v[160:161], v[160:161], v[144:145]
    v_pk_mul_f32 v[162:163], v[162:163], v[146:147]
    v_pk_mul_f32 v[164:165], v[164:165], v[148:149]
    v_pk_mul_f32 v[166:167], v[166:167], v[150:151]
    v_cvt_pk_bf16_f32 v152, v160, v161
    v_cvt_pk_bf16_f32 v153, v162, v163
    v_cvt_pk_bf16_f32 v154, v164, v165
    v_cvt_pk_bf16_f32 v155, v166, v167
    buffer_store_dwordx4 v[152:155], v23, s[20:23], s93 offen sc1
    s_add_u32 s70, s79, 28672
    buffer_load_dwordx4 a[112:115], v24, s[20:23], s70 offen offset:0 sc1
    v_pk_mul_f32 v[160:161], v[176:177], s[94:95]
    v_pk_mul_f32 v[162:163], v[178:179], s[94:95]
    v_pk_mul_f32 v[164:165], v[180:181], s[94:95]
    v_pk_mul_f32 v[166:167], v[182:183], s[94:95]
    v_exp_f32 v160, v160
    v_exp_f32 v161, v161
    v_exp_f32 v162, v162
    v_exp_f32 v163, v163
    v_exp_f32 v164, v164
    v_exp_f32 v165, v165
    v_exp_f32 v166, v166
    v_exp_f32 v167, v167
    v_pk_mul_f32 v[176:177], v[176:177], v[184:185]
    v_pk_mul_f32 v[178:179], v[178:179], v[186:187]
    v_pk_mul_f32 v[180:181], v[180:181], v[188:189]
    v_pk_mul_f32 v[182:183], v[182:183], v[190:191]
    v_pk_add_f32 v[160:161], v[160:161], s[98:99]
    v_pk_add_f32 v[162:163], v[162:163], s[98:99]
    v_pk_add_f32 v[164:165], v[164:165], s[98:99]
Lpad90:
    s_cbranch_execz Lhret
    v_pk_add_f32 v[166:167], v[166:167], s[98:99]
    v_rcp_f32 v160, v160
    v_rcp_f32 v161, v161
    v_rcp_f32 v162, v162
    v_rcp_f32 v163, v163
    v_rcp_f32 v164, v164
    v_rcp_f32 v165, v165
    v_rcp_f32 v166, v166
    v_rcp_f32 v167, v167
    s_mov_b32 s93, 276480
    v_pk_mul_f32 v[176:177], v[176:177], v[160:161]
    v_pk_mul_f32 v[178:179], v[178:179], v[162:163]
    v_pk_mul_f32 v[180:181], v[180:181], v[164:165]
    v_pk_mul_f32 v[182:183], v[182:183], v[166:167]
    v_cvt_pk_bf16_f32 v168, v176, v177
    v_cvt_pk_bf16_f32 v169, v178, v179
    v_cvt_pk_bf16_f32 v170, v180, v181
    v_cvt_pk_bf16_f32 v171, v182, v183
    buffer_store_dwordx4 v[168:171], v23, s[20:23], s93 offen sc1
    s_add_u32 s70, s79, 28672
    buffer_load_dwordx4 a[116:119], v24, s[20:23], s70 offen offset:1024 sc1
    v_pk_mul_f32 v[176:177], v[192:193], s[94:95]
    v_pk_mul_f32 v[178:179], v[194:195], s[94:95]
    v_pk_mul_f32 v[180:181], v[196:197], s[94:95]
    v_pk_mul_f32 v[182:183], v[198:199], s[94:95]
    v_exp_f32 v176, v176
    v_exp_f32 v177, v177
    v_exp_f32 v178, v178
    v_exp_f32 v179, v179
    v_exp_f32 v180, v180
    v_exp_f32 v181, v181
    v_exp_f32 v182, v182
    v_exp_f32 v183, v183
    v_pk_mul_f32 v[192:193], v[192:193], v[200:201]
    v_pk_mul_f32 v[194:195], v[194:195], v[202:203]
    v_pk_mul_f32 v[196:197], v[196:197], v[204:205]
    v_pk_mul_f32 v[198:199], v[198:199], v[206:207]
    v_pk_add_f32 v[176:177], v[176:177], s[98:99]
    v_pk_add_f32 v[178:179], v[178:179], s[98:99]
    v_pk_add_f32 v[180:181], v[180:181], s[98:99]
    v_pk_add_f32 v[182:183], v[182:183], s[98:99]
    v_rcp_f32 v176, v176
    v_rcp_f32 v177, v177
    v_rcp_f32 v178, v178
    v_rcp_f32 v179, v179
    v_rcp_f32 v180, v180
    v_rcp_f32 v181, v181
    v_rcp_f32 v182, v182
    v_rcp_f32 v183, v183
    s_mov_b32 s93, 442368
    v_pk_mul_f32 v[192:193], v[192:193], v[176:177]
    v_pk_mul_f32 v[194:195], v[194:195], v[178:179]
    v_pk_mul_f32 v[196:197], v[196:197], v[180:181]
    v_pk_mul_f32 v[198:199], v[198:199], v[182:183]
    v_cvt_pk_bf16_f32 v184, v192, v193
    v_cvt_pk_bf16_f32 v185, v194, v195
    v_cvt_pk_bf16_f32 v186, v196, v197
    v_cvt_pk_bf16_f32 v187, v198, v199
    buffer_store_dwordx4 v[184:187], v23, s[20:23], s93 offen sc1
    s_add_u32 s70, s79, 28672
Lpad91:
    s_cbranch_execz Lhret
    buffer_load_dwordx4 a[120:123], v24, s[20:23], s70 offen offset:2048 sc1
    v_pk_mul_f32 v[192:193], v[208:209], s[94:95]
    v_pk_mul_f32 v[194:195], v[210:211], s[94:95]
    v_pk_mul_f32 v[196:197], v[212:213], s[94:95]
    v_pk_mul_f32 v[198:199], v[214:215], s[94:95]
    v_exp_f32 v192, v192
    v_exp_f32 v193, v193
    v_exp_f32 v194, v194
    v_exp_f32 v195, v195
    v_exp_f32 v196, v196
    v_exp_f32 v197, v197
    v_exp_f32 v198, v198
    v_exp_f32 v199, v199
    v_pk_mul_f32 v[208:209], v[208:209], v[216:217]
    v_pk_mul_f32 v[210:211], v[210:211], v[218:219]
    v_pk_mul_f32 v[212:213], v[212:213], v[220:221]
    v_pk_mul_f32 v[214:215], v[214:215], v[222:223]
    v_pk_add_f32 v[192:193], v[192:193], s[98:99]
    v_pk_add_f32 v[194:195], v[194:195], s[98:99]
    v_pk_add_f32 v[196:197], v[196:197], s[98:99]
    v_pk_add_f32 v[198:199], v[198:199], s[98:99]
    v_rcp_f32 v192, v192
    v_rcp_f32 v193, v193
    v_rcp_f32 v194, v194
    v_rcp_f32 v195, v195
    v_rcp_f32 v196, v196
    v_rcp_f32 v197, v197
    v_rcp_f32 v198, v198
    v_rcp_f32 v199, v199
    s_mov_b32 s93, 497664
    v_pk_mul_f32 v[208:209], v[208:209], v[192:193]
    v_pk_mul_f32 v[210:211], v[210:211], v[194:195]
    v_pk_mul_f32 v[212:213], v[212:213], v[196:197]
    v_pk_mul_f32 v[214:215], v[214:215], v[198:199]
    v_cvt_pk_bf16_f32 v200, v208, v209
    v_cvt_pk_bf16_f32 v201, v210, v211
    v_cvt_pk_bf16_f32 v202, v212, v213
    v_cvt_pk_bf16_f32 v203, v214, v215
    buffer_store_dwordx4 v[200:203], v23, s[20:23], s93 offen sc1
    s_add_u32 s70, s79, 28672
    buffer_load_dwordx4 a[124:127], v24, s[20:23], s70 offen offset:3072 sc1
    v_pk_mul_f32 v[208:209], v[224:225], s[94:95]
    v_pk_mul_f32 v[210:211], v[226:227], s[94:95]
    v_pk_mul_f32 v[212:213], v[228:229], s[94:95]
    v_pk_mul_f32 v[214:215], v[230:231], s[94:95]
    v_exp_f32 v208, v208
    v_exp_f32 v209, v209
    v_exp_f32 v210, v210
    v_exp_f32 v211, v211
    v_exp_f32 v212, v212
    v_exp_f32 v213, v213
    v_exp_f32 v214, v214
    v_exp_f32 v215, v215
    v_pk_mul_f32 v[224:225], v[224:225], v[232:233]
    v_pk_mul_f32 v[226:227], v[226:227], v[234:235]
    v_pk_mul_f32 v[228:229], v[228:229], v[236:237]
    v_pk_mul_f32 v[230:231], v[230:231], v[238:239]
    v_pk_add_f32 v[208:209], v[208:209], s[98:99]
    v_pk_add_f32 v[210:211], v[210:211], s[98:99]
    v_pk_add_f32 v[212:213], v[212:213], s[98:99]
Lpad92:
    s_cbranch_execz Lhret
    v_pk_add_f32 v[214:215], v[214:215], s[98:99]
    v_rcp_f32 v208, v208
    v_rcp_f32 v209, v209
    v_rcp_f32 v210, v210
    v_rcp_f32 v211, v211
    v_rcp_f32 v212, v212
    v_rcp_f32 v213, v213
    v_rcp_f32 v214, v214
    v_rcp_f32 v215, v215
    s_mov_b32 s93, 663552
    v_pk_mul_f32 v[224:225], v[224:225], v[208:209]
    v_pk_mul_f32 v[226:227], v[226:227], v[210:211]
    v_pk_mul_f32 v[228:229], v[228:229], v[212:213]
    v_pk_mul_f32 v[230:231], v[230:231], v[214:215]
    v_cvt_pk_bf16_f32 v216, v224, v225
    v_cvt_pk_bf16_f32 v217, v226, v227
    v_cvt_pk_bf16_f32 v218, v228, v229
    v_cvt_pk_bf16_f32 v219, v230, v231
    buffer_store_dwordx4 v[216:219], v23, s[20:23], s93 offen sc1
    s_add_u32 s70, s79, 32768
    buffer_load_dwordx4 a[128:131], v24, s[20:23], s70 offen offset:0 sc1
    v_pk_mul_f32 v[224:225], v[240:241], s[94:95]
    v_pk_mul_f32 v[226:227], v[242:243], s[94:95]
    v_pk_mul_f32 v[228:229], v[244:245], s[94:95]
    v_pk_mul_f32 v[230:231], v[246:247], s[94:95]
    v_exp_f32 v224, v224
    v_exp_f32 v225, v225
    v_exp_f32 v226, v226
    v_exp_f32 v227, v227
    v_exp_f32 v228, v228
    v_exp_f32 v229, v229
    v_exp_f32 v230, v230
    v_exp_f32 v231, v231
    v_pk_mul_f32 v[240:241], v[240:241], v[248:249]
    v_pk_mul_f32 v[242:243], v[242:243], v[250:251]
    v_pk_mul_f32 v[244:245], v[244:245], v[252:253]
    v_pk_mul_f32 v[246:247], v[246:247], v[254:255]
    v_pk_add_f32 v[224:225], v[224:225], s[98:99]
    v_pk_add_f32 v[226:227], v[226:227], s[98:99]
    v_pk_add_f32 v[228:229], v[228:229], s[98:99]
    v_pk_add_f32 v[230:231], v[230:231], s[98:99]
    v_rcp_f32 v224, v224
    v_rcp_f32 v225, v225
    v_rcp_f32 v226, v226
    v_rcp_f32 v227, v227
    v_rcp_f32 v228, v228
    v_rcp_f32 v229, v229
    v_rcp_f32 v230, v230
    v_rcp_f32 v231, v231
    s_mov_b32 s93, 718848
    v_pk_mul_f32 v[240:241], v[240:241], v[224:225]
    v_pk_mul_f32 v[242:243], v[242:243], v[226:227]
    v_pk_mul_f32 v[244:245], v[244:245], v[228:229]
    v_pk_mul_f32 v[246:247], v[246:247], v[230:231]
    v_cvt_pk_bf16_f32 v232, v240, v241
    v_cvt_pk_bf16_f32 v233, v242, v243
    v_cvt_pk_bf16_f32 v234, v244, v245
    v_cvt_pk_bf16_f32 v235, v246, v247
    buffer_store_dwordx4 v[232:235], v23, s[20:23], s93 offen sc1
    s_add_u32 s70, s79, 32768
Lpad93:
    s_cbranch_execz Lhret
    buffer_load_dwordx4 a[132:135], v24, s[20:23], s70 offen offset:1024 sc1
    buffer_load_dwordx4 a[136:139], v24, s[20:23], s70 offen offset:2048 sc1
    buffer_load_dwordx4 a[140:143], v24, s[20:23], s70 offen offset:3072 sc1
    s_add_u32 s70, s79, 36864
    buffer_load_dwordx4 a[144:147], v24, s[20:23], s70 offen offset:0 sc1
    buffer_load_dwordx4 a[148:151], v24, s[20:23], s70 offen offset:1024 sc1
    buffer_load_dwordx4 a[152:155], v24, s[20:23], s70 offen offset:2048 sc1
    s_waitcnt vmcnt(6)
    s_barrier
    v_mov_b32 v10, s56
    v_mov_b32 v11, s57
    v_lshl_add_u32 v12, v1, 3, s87
    s_mov_b64 exec, 0xffff
    buffer_store_dwordx2 v[10:11], v12, s[20:23], 0 offen sc1
    s_mov_b64 exec, -1
    s_cmp_lg_u32 s71, s80
    s_cbranch_scc1 Lws29
Lwb31:
    s_add_u32 s70, s79, 36864
    buffer_load_dwordx4 a[156:159], v24, s[20:23], s70 offen offset:3072 sc1
    s_add_u32 s70, s79, 40960
    buffer_load_dwordx4 a[160:163], v24, s[20:23], s70 offen offset:0 sc1
    buffer_load_dwordx4 a[164:167], v24, s[20:23], s70 offen offset:1024 sc1
    buffer_load_dwordx4 a[168:171], v24, s[20:23], s70 offen offset:2048 sc1
    buffer_load_dwordx4 a[172:175], v24, s[20:23], s70 offen offset:3072 sc1
    s_getpc_b64 s[68:69]
Lq34:
    s_lshl_b32 s92, s3, 2
    s_sub_u32 s92, Lq34-Ltabh-16, s92
    s_sub_u32 s92, s68, s92
    s_subb_u32 s93, s69, 0
    s_add_u32 s68, s68, Lr34-Lq34
    s_addc_u32 s69, s69, 0
    s_mov_b64 exec, 0
    s_setpc_b64 s[92:93]
Lr34:
    s_add_u32 s70, s79, 45056
    buffer_load_dwordx4 a[176:179], v24, s[20:23], s70 offen offset:0 sc1
    s_lshl_b32 s92, s75, 7
    v_add_u32 v4, s92, v124
    s_add_u32 s75, s75, 1
    s_cmp_eq_u32 s75, 10
    s_cselect_b32 s75, 0, s75
    ds_read_b128 v[80:83], v4
    s_lshl_b32 s92, s75, 7
    v_add_u32 v4, s92, v124
    s_add_u32 s75, s75, 1
    s_cmp_eq_u32 s75, 10
    s_cselect_b32 s75, 0, s75
    ds_read_b128 v[84:87], v4
    s_lshl_b32 s92, s75, 7
    v_add_u32 v4, s92, v124
    buffer_load_dwordx4 a[180:183], v24, s[20:23], s70 offen offset:1024 sc1
    s_add_u32 s75, s75, 1
    s_cmp_eq_u32 s75, 10
    s_cselect_b32 s75, 0, s75
    ds_read_b128 v[88:91], v4
    s_lshl_b32 s92, s75, 7
    v_add_u32 v4, s92, v124
    s_add_u32 s75, s75, 1
    s_cmp_eq_u32 s75, 10
    s_cselect_b32 s75, 0, s75
    ds_read_b128 v[92:95], v4
    s_lshl_b32 s92, s75, 7
    v_add_u32 v4, s92, v124
    s_add_u32 s75, s75, 1
    s_cmp_eq_u32 s75, 10
    s_cselect_b32 s75, 0, s75
    ds_read_b128 v[96:99], v4
    buffer_load_dwordx4 a[184:187], v24, s[20:23], s70 offen offset:2048 sc1
Lpad94:
    s_cbranch_execz Lhret
    s_lshl_b32 s92, s75, 7
    v_add_u32 v4, s92, v124
    s_add_u32 s75, s75, 1
    s_cmp_eq_u32 s75, 10
    s_cselect_b32 s75, 0, s75
    ds_read_b128 v[100:103], v4
    s_lshl_b32 s92, s75, 7
    v_add_u32 v4, s92, v124
    s_add_u32 s75, s75, 1
    s_cmp_eq_u32 s75, 10
    s_cselect_b32 s75, 0, s75
    ds_read_b128 v[104:107], v4
    s_lshl_b32 s92, s75, 7
    v_add_u32 v4, s92, v124
    buffer_load_dwordx4 a[188:191], v24, s[20:23], s70 offen offset:3072 sc1
    s_add_u32 s75, s75, 1
    s_cmp_eq_u32 s75, 10
    s_cselect_b32 s75, 0, s75
    ds_read_b128 v[108:111], v4
    s_lshl_b32 s92, s75, 7
    v_add_u32 v4, s92, v124
    s_add_u32 s75, s75, 1
    s_cmp_eq_u32 s75, 10
    s_cselect_b32 s75, 0, s75
    ds_read_b128 v[116:119], v4
    s_lshl_b32 s92, s75, 7
    v_add_u32 v4, s92, v124
    s_add_u32 s75, s75, 1
    s_cmp_eq_u32 s75, 10
    s_cselect_b32 s75, 0, s75
    ds_read_b128 v[120:123], v4
    s_add_u32 s70, s79, 49152
    buffer_load_dwordx4 a[192:195], v24, s[20:23], s70 offen offset:0 sc1
    s_waitcnt lgkmcnt(0)
    v_dot2_f32_bf16 v6, v40, v80, 0
    v_dot2_f32_bf16 v6, v41, v81, v6
    v_dot2_f32_bf16 v6, v42, v82, v6
    v_dot2_f32_bf16 v6, v43, v83, v6
    v_dot2_f32_bf16 v6, v44, v84, v6
    v_dot2_f32_bf16 v6, v45, v85, v6
    v_dot2_f32_bf16 v6, v46, v86, v6
    v_dot2_f32_bf16 v6, v47, v87, v6
Lpad95:
    s_cbranch_execz Lhret
    v_dot2_f32_bf16 v6, v48, v88, v6
    buffer_load_dwordx4 a[196:199], v24, s[20:23], s70 offen offset:1024 sc1
    v_dot2_f32_bf16 v6, v49, v89, v6
    v_dot2_f32_bf16 v6, v50, v90, v6
    v_dot2_f32_bf16 v6, v51, v91, v6
    v_dot2_f32_bf16 v6, v52, v92, v6
    v_dot2_f32_bf16 v6, v53, v93, v6
    v_dot2_f32_bf16 v6, v54, v94, v6
    v_dot2_f32_bf16 v6, v55, v95, v6
    v_dot2_f32_bf16 v6, v56, v96, v6
    v_dot2_f32_bf16 v6, v57, v97, v6
    buffer_load_dwordx4 a[200:203], v24, s[20:23], s70 offen offset:2048 sc1
    v_dot2_f32_bf16 v6, v58, v98, v6
    v_dot2_f32_bf16 v6, v59, v99, v6
    v_dot2_f32_bf16 v6, v60, v100, v6
    v_dot2_f32_bf16 v6, v61, v101, v6
    v_dot2_f32_bf16 v6, v62, v102, v6
    v_dot2_f32_bf16 v6, v63, v103, v6
    v_dot2_f32_bf16 v6, v64, v104, v6
    v_dot2_f32_bf16 v6, v65, v105, v6
    v_dot2_f32_bf16 v6, v66, v106, v6
    v_dot2_f32_bf16 v6, v67, v107, v6
    buffer_load_dwordx4 a[204:207], v24, s[20:23], s70 offen offset:3072 sc1
    v_dot2_f32_bf16 v6, v68, v108, v6
    v_dot2_f32_bf16 v6, v69, v109, v6
    v_dot2_f32_bf16 v6, v70, v110, v6
    v_dot2_f32_bf16 v6, v71, v111, v6
    v_dot2_f32_bf16 v6, v72, v116, v6
    v_dot2_f32_bf16 v6, v73, v117, v6
    v_dot2_f32_bf16 v6, v74, v118, v6
    v_dot2_f32_bf16 v6, v75, v119, v6
    v_dot2_f32_bf16 v6, v76, v120, v6
    v_dot2_f32_bf16 v6, v77, v121, v6
    s_add_u32 s70, s79, 53248
    buffer_load_dwordx4 a[208:211], v24, s[20:23], s70 offen offset:0 sc1
    v_dot2_f32_bf16 v6, v78, v122, v6
    v_dot2_f32_bf16 v6, v79, v123, v6
    s_nop 2
    v_add_f32_dpp v7, v6, v6 quad_perm:[1,0,3,2] row_mask:0xf bank_mask:0xf
    s_nop 1
    v_add_f32_dpp v6, v7, v7 quad_perm:[2,3,0,1] row_mask:0xf bank_mask:0xf
    s_nop 1
    v_add_f32_dpp v7, v6, v6 row_half_mirror row_mask:0xf bank_mask:0xf
    v_mul_f32 v7, 0xbfb8aa3b, v7
    v_exp_f32 v7, v7
    buffer_load_dwordx4 a[212:215], v24, s[20:23], s70 offen offset:1024 sc1
    s_nop 0
    v_add_f32 v7, 1.0, v7
    v_rcp_f32 v7, v7
    v_lshrrev_b32 v8, 3, v125
    v_lshlrev_b32 v8, 7, v8
    v_lshrrev_b32 v125, 1, v1
    v_lshl_add_u32 v125, v125, 2, v8
Lpad96:
    s_cbranch_execz Lhret
    v_add_u32 v125, 12320768, v125
    s_cmp_lt_u32 s77, 64
    s_cselect_b32 s92, 0, 2130706432
    s_mov_b32 exec_lo, 0x55555555
    s_mov_b32 exec_hi, 0x55555555
    buffer_store_dword v7, v125, s[20:23], s92 offen sc1
    s_mov_b64 exec, -1
    s_mov_b32 s69, s3
    s_mov_b32 s72, 0
    buffer_load_dwordx4 a[216:219], v24, s[20:23], s70 offen offset:2048 sc1
    s_mov_b32 s73, 0
    s_mov_b32 s74, 7680
    s_mov_b32 s75, 15360
    s_add_u32 s93, s3, 3
    s_and_b32 s93, s93, 3
    s_lshl_b32 s93, s93, 4
    s_lshl_b32 s92, s83, 6
    s_add_u32 s93, s93, s92
    v_mul_u32_u24 v4, 26, v1
    v_lshrrev_b32 v4, 8, v4
    v_mul_u32_u24 v5, 10, v4
    buffer_load_dwordx4 a[220:223], v24, s[20:23], s70 offen offset:3072 sc1
    v_sub_u32 v5, v1, v5
    v_lshlrev_b32 v8, 4, v5
    v_add_u32 v6, s93, v4
    s_movk_i32 s92, 1280
    v_mad_u32_u24 v6, v6, s92, v8
    s_mul_i32 s92, s82, 160
    v_add_u32 v6, s92, v6
    v_cmp_gt_u32 vcc, 60, v1
    v_mov_b32 v7, 2130706432
    v_mul_u32_u24 v20, 176, v4
    s_add_u32 s70, s79, 57344
    buffer_load_dwordx4 a[224:227], v24, s[20:23], s70 offen offset:0 sc1
    v_cndmask_b32 v17, v7, v6, vcc
    v_cmp_gt_u32 vcc, 40, v1
    s_mul_i32 s92, s3, 3344
    s_add_u32 s92, s92, 97280
    v_cndmask_b32 v15, v7, v6, vcc
    v_add3_u32 v20, v20, v8, s92
    v_and_b32 v4, 15, v1
    v_lshrrev_b32 v5, 4, v1
    v_mul_u32_u24 v21, 176, v4
    v_lshl_add_u32 v21, v5, 3, v21
    buffer_load_dwordx4 a[228:231], v24, s[20:23], s70 offen offset:1024 sc1
    v_add_u32 v21, s92, v21
    v_add_u32 v6, s93, v4
    v_lshlrev_b32 v6, 4, v6
    v_add_u32 v18, 12320768, v6
    s_add_u32 s92, s3, 1
    s_and_b32 s92, s92, 3
    s_mul_i32 s92, s92, 5120
    v_add_u32 v19, s92, v24
    s_mul_i32 s94, s3, 2880
    s_add_u32 s94, s94, 84992
    buffer_load_dwordx4 a[232:235], v24, s[20:23], s70 offen offset:2048 sc1
    v_lshrrev_b32 v4, 3, v1
    v_and_b32 v5, 7, v1
    v_lshlrev_b32 v6, 4, v5
    v_cmp_gt_u32 vcc, 32, v1
    v_lshl_add_u32 v9, v4, 12, v6
    v_mov_b32 v8, 2130706432
    v_add_u32 v7, 65536, v9
    v_cndmask_b32 v23, v8, v7, vcc
    v_mul_u32_u24 v4, 144, v4
Lpad97:
    s_cbranch_execz Lhret
    v_add3_u32 v13, v4, v6, s94
    buffer_load_dwordx4 a[236:239], v24, s[20:23], s70 offen offset:3072 sc1
    v_lshrrev_b32 v4, 2, v1
    v_mul_u32_u24 v4, 144, v4
    v_and_b32 v5, 3, v1
    v_lshl_add_u32 v4, v5, 3, v4
    s_add_u32 s94, s3, 3
    s_and_b32 s94, s94, 3
    s_lshl_b32 s94, s94, 5
    s_add_u32 s94, s94, 84992
    v_add_u32 v22, s94, v4
    buffer_load_dwordx2 v[36:37], v32, s[20:23], 0 offen sc1
    s_add_u32 s70, s79, 61440
    buffer_load_dwordx4 a[240:243], v24, s[20:23], s70 offen offset:0 sc1
    buffer_load_dwordx4 a[244:247], v24, s[20:23], s70 offen offset:1024 sc1
    buffer_load_dwordx4 a[248:251], v24, s[20:23], s70 offen offset:2048 sc1
    buffer_load_dwordx4 a[252:255], v24, s[20:23], s70 offen offset:3072 sc1
    s_add_u32 s70, s79, 65536
    buffer_load_dwordx4 v[232:235], v24, s[20:23], s70 offen offset:0 sc1
    s_add_u32 s70, s81, 65536
    buffer_load_dwordx4 v[236:239], v24, s[20:23], s70 offen offset:1024 sc1
    buffer_load_dwordx4 v[240:243], v24, s[20:23], s70 offen offset:2048 sc1
    buffer_load_dwordx4 v[244:247], v24, s[20:23], s70 offen offset:3072 sc1
    s_add_u32 s70, s81, 69632
    buffer_load_dwordx4 v[248:251], v24, s[20:23], s70 offen offset:0 sc1
    buffer_load_dwordx4 v[252:255], v24, s[20:23], s70 offen offset:1024 sc1
    buffer_load_dwordx4 v[220:223], v17, s[4:7], 0 offen
    buffer_load_dwordx4 v[224:227], v17, s[4:7], s74 offen
    buffer_load_dwordx4 v[228:231], v15, s[4:7], s75 offen
    s_cmp_lg_u32 s3, 0
    s_cbranch_scc1 Lhw
    s_mov_b32 s96, 0
    s_waitcnt vmcnt(13)
Lpp35:
    v_cmp_ne_u64 vcc, s[56:57], v[36:37]
    s_nop 3
    s_cmp_eq_u64 vcc, 0
    s_cbranch_scc1 Lpd36
    s_sleep 1
    buffer_load_dwordx2 v[36:37], v32, s[20:23], 0 offen sc1
    s_waitcnt vmcnt(0)
    s_add_u32 s96, s96, 1
    s_cmp_lt_u32 s96, 0x8000
    s_cbranch_scc1 Lpp35
Lpd36:
Lhw:
    s_barrier
Lg2loads:
    s_mul_i32 s92, s69, 55296
    s_add_u32 s92, s92, s84
    s_cmp_ge_u32 s72, 64
    s_cselect_b32 s64, 2130706432, s92
    s_add_u32 s65, s64, 4096
    s_add_u32 s66, s64, 8192
    s_add_u32 s67, s64, 12288
    s_cmp_ge_u32 s3, 2
    s_cselect_b32 s68, 2130706432, s67
    s_add_u32 s69, s69, 1
    s_and_b32 s69, s69, 3
    buffer_load_dwordx4 v[200:203], v24, s[20:23], s64 offen offset:0 sc1
    buffer_load_dwordx4 v[204:207], v24, s[20:23], s64 offen offset:1024 sc1
    buffer_load_dwordx4 v[208:211], v24, s[20:23], s64 offen offset:2048 sc1
    buffer_load_dwordx4 v[212:215], v24, s[20:23], s64 offen offset:3072 sc1
    buffer_load_dwordx4 v[216:219], v24, s[20:23], s65 offen offset:0 sc1
Lpad98:
    s_cbranch_execz Lhret
    buffer_load_dwordx4 v[72:75], v24, s[20:23], s65 offen offset:1024 sc1
    buffer_load_dwordx4 v[76:79], v24, s[20:23], s65 offen offset:2048 sc1
    buffer_load_dwordx4 v[80:83], v24, s[20:23], s65 offen offset:3072 sc1
    buffer_load_dwordx4 v[84:87], v24, s[20:23], s66 offen offset:0 sc1
    buffer_load_dwordx4 v[88:91], v24, s[20:23], s66 offen offset:1024 sc1
Lg2start:
Lpad99:
    s_cbranch_execz Lhret
    s_waitcnt vmcnt(9)
    v_mfma_f32_16x16x32_bf16 v[136:139], a[0:3], v[200:203], 0
    v_mfma_f32_16x16x32_bf16 v[140:143], a[4:7], v[200:203], 0
    v_mfma_f32_16x16x32_bf16 v[144:147], a[8:11], v[200:203], 0
    v_mfma_f32_16x16x32_bf16 v[148:151], a[12:15], v[200:203], 0
    v_mfma_f32_16x16x32_bf16 v[152:155], a[16:19], v[200:203], 0
    s_waitcnt vmcnt(8)
    v_mfma_f32_16x16x32_bf16 v[136:139], a[20:23], v[204:207], v[136:139]
    buffer_load_dwordx4 v[200:203], v24, s[20:23], s66 offen offset:2048 sc1
    v_mfma_f32_16x16x32_bf16 v[140:143], a[24:27], v[204:207], v[140:143]
    ds_write_b128 v20, v[220:223] offset:0
    v_mfma_f32_16x16x32_bf16 v[144:147], a[28:31], v[204:207], v[144:147]
    v_mfma_f32_16x16x32_bf16 v[148:151], a[32:35], v[204:207], v[148:151]
    v_mfma_f32_16x16x32_bf16 v[152:155], a[36:39], v[204:207], v[152:155]
    s_waitcnt vmcnt(8)
    v_mfma_f32_16x16x32_bf16 v[136:139], a[40:43], v[208:211], v[136:139]
    buffer_load_dwordx4 v[204:207], v24, s[20:23], s66 offen offset:3072 sc1
    v_mfma_f32_16x16x32_bf16 v[140:143], a[44:47], v[208:211], v[140:143]
    ds_write_b128 v20, v[224:227] offset:1056
    v_mfma_f32_16x16x32_bf16 v[144:147], a[48:51], v[208:211], v[144:147]
    v_mfma_f32_16x16x32_bf16 v[148:151], a[52:55], v[208:211], v[148:151]
    v_mfma_f32_16x16x32_bf16 v[152:155], a[56:59], v[208:211], v[152:155]
    s_waitcnt vmcnt(8)
    v_mfma_f32_16x16x32_bf16 v[136:139], a[60:63], v[212:215], v[136:139]
    buffer_load_dwordx4 v[208:211], v24, s[20:23], s67 offen offset:0 sc1
    v_mfma_f32_16x16x32_bf16 v[140:143], a[64:67], v[212:215], v[140:143]
    ds_write_b128 v20, v[228:231] offset:2112
    v_mfma_f32_16x16x32_bf16 v[144:147], a[68:71], v[212:215], v[144:147]
    v_mfma_f32_16x16x32_bf16 v[148:151], a[72:75], v[212:215], v[148:151]
    v_mfma_f32_16x16x32_bf16 v[152:155], a[76:79], v[212:215], v[152:155]
    s_waitcnt vmcnt(8)
    v_mfma_f32_16x16x32_bf16 v[136:139], a[80:83], v[216:219], v[136:139]
    buffer_load_dwordx4 v[212:215], v24, s[20:23], s68 offen offset:1024 sc1
    v_mfma_f32_16x16x32_bf16 v[140:143], a[84:87], v[216:219], v[140:143]
    s_mul_i32 s92, s69, 55296
    s_add_u32 s92, s92, s84
    v_mfma_f32_16x16x32_bf16 v[144:147], a[88:91], v[216:219], v[144:147]
    s_cmp_ge_u32 s72, 64
    s_cselect_b32 s64, 2130706432, s92
    v_mfma_f32_16x16x32_bf16 v[148:151], a[92:95], v[216:219], v[148:151]
    v_mfma_f32_16x16x32_bf16 v[152:155], a[96:99], v[216:219], v[152:155]
    s_waitcnt vmcnt(8)
    v_mfma_f32_16x16x32_bf16 v[136:139], a[100:103], v[72:75], v[136:139]
    buffer_load_dwordx4 v[216:219], v24, s[20:23], s64 offen offset:0 sc1
    v_mfma_f32_16x16x32_bf16 v[140:143], a[104:107], v[72:75], v[140:143]
    s_add_u32 s65, s64, 4096
    s_add_u32 s66, s64, 8192
    v_mfma_f32_16x16x32_bf16 v[144:147], a[108:111], v[72:75], v[144:147]
    s_add_u32 s67, s64, 12288
    s_cmp_ge_u32 s3, 2
    s_cselect_b32 s68, 2130706432, s67
    v_mfma_f32_16x16x32_bf16 v[148:151], a[112:115], v[72:75], v[148:151]
Lpad100:
    s_cbranch_execz Lhret
    s_add_u32 s69, s69, 1
    s_and_b32 s69, s69, 3
    v_mfma_f32_16x16x32_bf16 v[152:155], a[116:119], v[72:75], v[152:155]
    s_waitcnt vmcnt(8)
    v_mfma_f32_16x16x32_bf16 v[136:139], a[120:123], v[76:79], v[136:139]
    buffer_load_dwordx4 v[72:75], v24, s[20:23], s64 offen offset:1024 sc1
    v_mfma_f32_16x16x32_bf16 v[140:143], a[124:127], v[76:79], v[140:143]
    ds_read_b64 v[60:61], v21 offset:0
    v_mfma_f32_16x16x32_bf16 v[144:147], a[128:131], v[76:79], v[144:147]
    ds_read_b64 v[62:63], v21 offset:32
    v_mfma_f32_16x16x32_bf16 v[148:151], a[132:135], v[76:79], v[148:151]
    ds_read_b64 v[64:65], v21 offset:64
    v_mfma_f32_16x16x32_bf16 v[152:155], a[136:139], v[76:79], v[152:155]
    ds_read_b64 v[66:67], v21 offset:96
    s_waitcnt vmcnt(8)
    v_mfma_f32_16x16x32_bf16 v[136:139], a[140:143], v[80:83], v[136:139]
    buffer_load_dwordx4 v[76:79], v24, s[20:23], s64 offen offset:2048 sc1
    v_mfma_f32_16x16x32_bf16 v[140:143], a[144:147], v[80:83], v[140:143]
    ds_read_b64 v[68:69], v21 offset:128
    v_mfma_f32_16x16x32_bf16 v[144:147], a[148:151], v[80:83], v[144:147]
    v_mfma_f32_16x16x32_bf16 v[148:151], a[152:155], v[80:83], v[148:151]
    v_mfma_f32_16x16x32_bf16 v[152:155], a[156:159], v[80:83], v[152:155]
    s_waitcnt vmcnt(8)
    v_mfma_f32_16x16x32_bf16 v[136:139], a[160:163], v[84:87], v[136:139]
    buffer_load_dwordx4 v[80:83], v24, s[20:23], s64 offen offset:3072 sc1
    v_mfma_f32_16x16x32_bf16 v[140:143], a[164:167], v[84:87], v[140:143]
    v_mov_b32 v10, s56
    v_mov_b32 v11, s57
    v_mfma_f32_16x16x32_bf16 v[144:147], a[168:171], v[84:87], v[144:147]
    v_lshl_add_u32 v12, v1, 3, s88
    s_waitcnt vmcnt(8)
    v_mfma_f32_16x16x32_bf16 v[148:151], a[172:175], v[84:87], v[148:151]
    s_mov_b64 exec, 0xffff
    buffer_store_dwordx2 v[10:11], v12, s[20:23], 0 offen sc1
    s_mov_b64 exec, -1
    v_mfma_f32_16x16x32_bf16 v[152:155], a[176:179], v[84:87], v[152:155]
    s_waitcnt vmcnt(9)
    v_mfma_f32_16x16x32_bf16 v[136:139], a[180:183], v[88:91], v[136:139]
    buffer_load_dwordx4 v[84:87], v24, s[20:23], s65 offen offset:0 sc1
    v_mfma_f32_16x16x32_bf16 v[140:143], a[184:187], v[88:91], v[140:143]
    v_mfma_f32_16x16x32_bf16 v[144:147], a[188:191], v[88:91], v[144:147]
    v_mfma_f32_16x16x32_bf16 v[148:151], a[192:195], v[88:91], v[148:151]
    v_mfma_f32_16x16x32_bf16 v[152:155], a[196:199], v[88:91], v[152:155]
    s_waitcnt vmcnt(9)
    v_mfma_f32_16x16x32_bf16 v[136:139], a[200:203], v[200:203], v[136:139]
    buffer_load_dwordx4 v[88:91], v24, s[20:23], s65 offen offset:1024 sc1
    v_mfma_f32_16x16x32_bf16 v[140:143], a[204:207], v[200:203], v[140:143]
    s_waitcnt lgkmcnt(0)
    v_lshlrev_b32 v96, 16, v60
    v_and_b32 v97, 0xffff0000, v60
    v_mfma_f32_16x16x32_bf16 v[144:147], a[208:211], v[200:203], v[144:147]
    v_lshlrev_b32 v98, 16, v61
    v_and_b32 v99, 0xffff0000, v61
    v_mfma_f32_16x16x32_bf16 v[148:151], a[212:215], v[200:203], v[148:151]
    v_lshlrev_b32 v100, 16, v62
Lpad101:
    s_cbranch_execz Lhret
    v_and_b32 v101, 0xffff0000, v62
    v_mfma_f32_16x16x32_bf16 v[152:155], a[216:219], v[200:203], v[152:155]
    v_lshlrev_b32 v102, 16, v63
    v_and_b32 v103, 0xffff0000, v63
    s_waitcnt vmcnt(9)
    v_mfma_f32_16x16x32_bf16 v[136:139], a[220:223], v[204:207], v[136:139]
    buffer_load_dwordx4 v[200:203], v24, s[20:23], s65 offen offset:2048 sc1
    v_mfma_f32_16x16x32_bf16 v[140:143], a[224:227], v[204:207], v[140:143]
    v_lshlrev_b32 v104, 16, v64
    v_and_b32 v105, 0xffff0000, v64
    v_mfma_f32_16x16x32_bf16 v[144:147], a[228:231], v[204:207], v[144:147]
    v_lshlrev_b32 v106, 16, v65
    v_and_b32 v107, 0xffff0000, v65
    v_mfma_f32_16x16x32_bf16 v[148:151], a[232:235], v[204:207], v[148:151]
    v_lshlrev_b32 v108, 16, v66
    v_and_b32 v109, 0xffff0000, v66
    v_mfma_f32_16x16x32_bf16 v[152:155], a[236:239], v[204:207], v[152:155]
    v_lshlrev_b32 v110, 16, v67
    v_and_b32 v111, 0xffff0000, v67
    s_waitcnt vmcnt(9)
    v_mfma_f32_16x16x32_bf16 v[136:139], a[240:243], v[208:211], v[136:139]
    buffer_load_dwordx4 v[204:207], v24, s[20:23], s65 offen offset:3072 sc1
    v_mfma_f32_16x16x32_bf16 v[140:143], a[244:247], v[208:211], v[140:143]
    v_lshlrev_b32 v112, 16, v68
    v_and_b32 v113, 0xffff0000, v68
    v_mfma_f32_16x16x32_bf16 v[144:147], a[248:251], v[208:211], v[144:147]
    v_lshlrev_b32 v114, 16, v69
    v_and_b32 v115, 0xffff0000, v69
    v_mfma_f32_16x16x32_bf16 v[148:151], a[252:255], v[208:211], v[148:151]
    v_mfma_f32_16x16x32_bf16 v[152:155], v[232:235], v[208:211], v[152:155]
    s_waitcnt vmcnt(9)
    v_mfma_f32_16x16x32_bf16 v[136:139], v[236:239], v[212:215], v[136:139]
    buffer_load_dwordx4 v[208:211], v24, s[20:23], s66 offen offset:0 sc1
    v_mfma_f32_16x16x32_bf16 v[140:143], v[240:243], v[212:215], v[140:143]
    v_mfma_f32_16x16x32_bf16 v[144:147], v[244:247], v[212:215], v[144:147]
    v_mfma_f32_16x16x32_bf16 v[148:151], v[248:251], v[212:215], v[148:151]
    v_mfma_f32_16x16x32_bf16 v[152:155], v[252:255], v[212:215], v[152:155]
    s_waitcnt vmcnt(9)
    v_mfma_f32_16x16x32_bf16 v[156:159], a[0:3], v[216:219], 0
    buffer_load_dwordx4 v[212:215], v24, s[20:23], s66 offen offset:1024 sc1
    v_mfma_f32_16x16x32_bf16 v[160:163], a[4:7], v[216:219], 0
    v_mfma_f32_16x16x32_bf16 v[164:167], a[8:11], v[216:219], 0
    v_mfma_f32_16x16x32_bf16 v[168:171], a[12:15], v[216:219], 0
    v_mfma_f32_16x16x32_bf16 v[172:175], a[16:19], v[216:219], 0
    s_waitcnt vmcnt(9)
    v_mfma_f32_16x16x32_bf16 v[156:159], a[20:23], v[72:75], v[156:159]
    buffer_load_dwordx4 v[216:219], v24, s[20:23], s66 offen offset:2048 sc1
    v_mfma_f32_16x16x32_bf16 v[160:163], a[24:27], v[72:75], v[160:163]
    v_mfma_f32_16x16x32_bf16 v[164:167], a[28:31], v[72:75], v[164:167]
    v_mfma_f32_16x16x32_bf16 v[168:171], a[32:35], v[72:75], v[168:171]
    v_mfma_f32_16x16x32_bf16 v[172:175], a[36:39], v[72:75], v[172:175]
    s_waitcnt vmcnt(9)
    v_mfma_f32_16x16x32_bf16 v[156:159], a[40:43], v[76:79], v[156:159]
    buffer_load_dwordx4 v[72:75], v24, s[20:23], s66 offen offset:3072 sc1
Lpad102:
    s_cbranch_execz Lhret
    v_mfma_f32_16x16x32_bf16 v[160:163], a[44:47], v[76:79], v[160:163]
    ds_write_b128 v33, v[136:139] offset:20480
    v_mfma_f32_16x16x32_bf16 v[164:167], a[48:51], v[76:79], v[164:167]
    v_mfma_f32_16x16x32_bf16 v[168:171], a[52:55], v[76:79], v[168:171]
    v_mfma_f32_16x16x32_bf16 v[172:175], a[56:59], v[76:79], v[172:175]
    s_waitcnt vmcnt(9)
    v_mfma_f32_16x16x32_bf16 v[156:159], a[60:63], v[80:83], v[156:159]
    buffer_load_dwordx4 v[76:79], v24, s[20:23], s67 offen offset:0 sc1
    v_mfma_f32_16x16x32_bf16 v[160:163], a[64:67], v[80:83], v[160:163]
    ds_write_b128 v33, v[140:143] offset:21504
    v_mfma_f32_16x16x32_bf16 v[164:167], a[68:71], v[80:83], v[164:167]
    v_mfma_f32_16x16x32_bf16 v[168:171], a[72:75], v[80:83], v[168:171]
    v_mfma_f32_16x16x32_bf16 v[172:175], a[76:79], v[80:83], v[172:175]
    s_waitcnt vmcnt(8)
    v_mfma_f32_16x16x32_bf16 v[156:159], a[80:83], v[84:87], v[156:159]
    buffer_load_dwordx4 v[80:83], v24, s[20:23], s68 offen offset:1024 sc1
    v_mfma_f32_16x16x32_bf16 v[160:163], a[84:87], v[84:87], v[160:163]
    s_mul_i32 s92, s69, 55296
    s_add_u32 s92, s92, s84
    v_mfma_f32_16x16x32_bf16 v[164:167], a[88:91], v[84:87], v[164:167]
    s_cmp_ge_u32 s72, 64
    s_cselect_b32 s64, 2130706432, s92
    v_mfma_f32_16x16x32_bf16 v[168:171], a[92:95], v[84:87], v[168:171]
    ds_write_b128 v33, v[144:147] offset:22528
    v_mfma_f32_16x16x32_bf16 v[172:175], a[96:99], v[84:87], v[172:175]
    s_waitcnt vmcnt(8)
    v_mfma_f32_16x16x32_bf16 v[156:159], a[100:103], v[88:91], v[156:159]
    buffer_load_dwordx4 v[84:87], v24, s[20:23], s64 offen offset:0 sc1
    v_mfma_f32_16x16x32_bf16 v[160:163], a[104:107], v[88:91], v[160:163]
    s_add_u32 s65, s64, 4096
    s_add_u32 s66, s64, 8192
    v_mfma_f32_16x16x32_bf16 v[164:167], a[108:111], v[88:91], v[164:167]
    s_add_u32 s67, s64, 12288
    s_cmp_ge_u32 s3, 2
    s_cselect_b32 s68, 2130706432, s67
    v_mfma_f32_16x16x32_bf16 v[168:171], a[112:115], v[88:91], v[168:171]
    s_add_u32 s69, s69, 1
    s_and_b32 s69, s69, 3
    v_mfma_f32_16x16x32_bf16 v[172:175], a[116:119], v[88:91], v[172:175]
    ds_write_b128 v33, v[148:151] offset:23552
    s_waitcnt vmcnt(8)
    v_mfma_f32_16x16x32_bf16 v[156:159], a[120:123], v[200:203], v[156:159]
    buffer_load_dwordx4 v[88:91], v24, s[20:23], s64 offen offset:1024 sc1
    v_mfma_f32_16x16x32_bf16 v[160:163], a[124:127], v[200:203], v[160:163]
    ds_write_b128 v33, v[152:155] offset:24576
    v_mfma_f32_16x16x32_bf16 v[164:167], a[128:131], v[200:203], v[164:167]
    v_mfma_f32_16x16x32_bf16 v[168:171], a[132:135], v[200:203], v[168:171]
    v_mfma_f32_16x16x32_bf16 v[172:175], a[136:139], v[200:203], v[172:175]
    s_waitcnt vmcnt(8)
    v_mfma_f32_16x16x32_bf16 v[156:159], a[140:143], v[204:207], v[156:159]
    buffer_load_dwordx4 v[200:203], v24, s[20:23], s64 offen offset:2048 sc1
    v_mfma_f32_16x16x32_bf16 v[160:163], a[144:147], v[204:207], v[160:163]
    v_mfma_f32_16x16x32_bf16 v[164:167], a[148:151], v[204:207], v[164:167]
Lpad103:
    s_cbranch_execz Lhret
    v_mfma_f32_16x16x32_bf16 v[168:171], a[152:155], v[204:207], v[168:171]
    v_mfma_f32_16x16x32_bf16 v[172:175], a[156:159], v[204:207], v[172:175]
    s_waitcnt vmcnt(8)
    v_mfma_f32_16x16x32_bf16 v[156:159], a[160:163], v[208:211], v[156:159]
    buffer_load_dwordx4 v[204:207], v24, s[20:23], s64 offen offset:3072 sc1
    v_mfma_f32_16x16x32_bf16 v[160:163], a[164:167], v[208:211], v[160:163]
    s_waitcnt lgkmcnt(0)
    s_barrier
    v_mfma_f32_16x16x32_bf16 v[164:167], a[168:171], v[208:211], v[164:167]
    ds_read_b128 v[40:43], v19 offset:20480
    v_mfma_f32_16x16x32_bf16 v[168:171], a[172:175], v[208:211], v[168:171]
    ds_read_b128 v[44:47], v19 offset:21504
    v_mfma_f32_16x16x32_bf16 v[172:175], a[176:179], v[208:211], v[172:175]
    ds_read_b128 v[48:51], v19 offset:22528
    s_waitcnt vmcnt(8)
    v_mfma_f32_16x16x32_bf16 v[156:159], a[180:183], v[212:215], v[156:159]
    buffer_load_dwordx4 v[208:211], v24, s[20:23], s65 offen offset:0 sc1
    v_mfma_f32_16x16x32_bf16 v[160:163], a[184:187], v[212:215], v[160:163]
    ds_read_b128 v[52:55], v19 offset:23552
    v_mfma_f32_16x16x32_bf16 v[164:167], a[188:191], v[212:215], v[164:167]
    ds_read_b128 v[56:59], v19 offset:24576
    v_mfma_f32_16x16x32_bf16 v[168:171], a[192:195], v[212:215], v[168:171]
    v_mfma_f32_16x16x32_bf16 v[172:175], a[196:199], v[212:215], v[172:175]
    s_waitcnt vmcnt(8)
    v_mfma_f32_16x16x32_bf16 v[156:159], a[200:203], v[216:219], v[156:159]
    buffer_load_dwordx4 v[212:215], v24, s[20:23], s65 offen offset:1024 sc1
    v_mfma_f32_16x16x32_bf16 v[160:163], a[204:207], v[216:219], v[160:163]
    v_mfma_f32_16x16x32_bf16 v[164:167], a[208:211], v[216:219], v[164:167]
    v_mfma_f32_16x16x32_bf16 v[168:171], a[212:215], v[216:219], v[168:171]
    v_mfma_f32_16x16x32_bf16 v[172:175], a[216:219], v[216:219], v[172:175]
    s_waitcnt vmcnt(8)
    v_mfma_f32_16x16x32_bf16 v[156:159], a[220:223], v[72:75], v[156:159]
    buffer_load_dwordx4 v[216:219], v24, s[20:23], s65 offen offset:2048 sc1
    v_mfma_f32_16x16x32_bf16 v[160:163], a[224:227], v[72:75], v[160:163]
    v_mfma_f32_16x16x32_bf16 v[164:167], a[228:231], v[72:75], v[164:167]
    v_mfma_f32_16x16x32_bf16 v[168:171], a[232:235], v[72:75], v[168:171]
    v_mfma_f32_16x16x32_bf16 v[172:175], a[236:239], v[72:75], v[172:175]
    s_waitcnt vmcnt(8)
    v_mfma_f32_16x16x32_bf16 v[156:159], a[240:243], v[76:79], v[156:159]
    buffer_load_dwordx4 v[72:75], v24, s[20:23], s65 offen offset:3072 sc1
    v_mfma_f32_16x16x32_bf16 v[160:163], a[244:247], v[76:79], v[160:163]
    v_mfma_f32_16x16x32_bf16 v[164:167], a[248:251], v[76:79], v[164:167]
    v_mfma_f32_16x16x32_bf16 v[168:171], a[252:255], v[76:79], v[168:171]
    v_mfma_f32_16x16x32_bf16 v[172:175], v[232:235], v[76:79], v[172:175]
    s_waitcnt vmcnt(8)
    v_mfma_f32_16x16x32_bf16 v[156:159], v[236:239], v[80:83], v[156:159]
    buffer_load_dwordx4 v[76:79], v24, s[20:23], s66 offen offset:0 sc1
    v_mfma_f32_16x16x32_bf16 v[160:163], v[240:243], v[80:83], v[160:163]
    v_mfma_f32_16x16x32_bf16 v[164:167], v[244:247], v[80:83], v[164:167]
    v_mfma_f32_16x16x32_bf16 v[168:171], v[248:251], v[80:83], v[168:171]
    v_mfma_f32_16x16x32_bf16 v[172:175], v[252:255], v[80:83], v[172:175]
    s_waitcnt vmcnt(8)
Lpad104:
    s_cbranch_execz Lhret
    v_mfma_f32_16x16x32_bf16 v[136:139], a[0:3], v[84:87], 0
    buffer_load_dwordx4 v[80:83], v24, s[20:23], s66 offen offset:1024 sc1
    v_mfma_f32_16x16x32_bf16 v[140:143], a[4:7], v[84:87], 0
    v_mfma_f32_16x16x32_bf16 v[144:147], a[8:11], v[84:87], 0
    v_mfma_f32_16x16x32_bf16 v[148:151], a[12:15], v[84:87], 0
    v_mfma_f32_16x16x32_bf16 v[152:155], a[16:19], v[84:87], 0
    s_waitcnt vmcnt(8)
    v_mfma_f32_16x16x32_bf16 v[136:139], a[20:23], v[88:91], v[136:139]
    buffer_load_dwordx4 v[84:87], v24, s[20:23], s66 offen offset:2048 sc1
    v_mfma_f32_16x16x32_bf16 v[140:143], a[24:27], v[88:91], v[140:143]
    v_mfma_f32_16x16x32_bf16 v[144:147], a[28:31], v[88:91], v[144:147]
    v_mfma_f32_16x16x32_bf16 v[148:151], a[32:35], v[88:91], v[148:151]
    v_mfma_f32_16x16x32_bf16 v[152:155], a[36:39], v[88:91], v[152:155]
    s_waitcnt vmcnt(8)
    v_mfma_f32_16x16x32_bf16 v[136:139], a[40:43], v[200:203], v[136:139]
    buffer_load_dwordx4 v[88:91], v24, s[20:23], s66 offen offset:3072 sc1
    v_mfma_f32_16x16x32_bf16 v[140:143], a[44:47], v[200:203], v[140:143]
    s_waitcnt lgkmcnt(0)
    v_add_f32 v156, v156, v40
    v_add_f32 v157, v157, v41
    v_mfma_f32_16x16x32_bf16 v[144:147], a[48:51], v[200:203], v[144:147]
    v_add_f32 v158, v158, v42
    v_add_f32 v159, v159, v43
    v_mfma_f32_16x16x32_bf16 v[148:151], a[52:55], v[200:203], v[148:151]
    v_add_f32 v160, v160, v44
    v_add_f32 v161, v161, v45
    v_mfma_f32_16x16x32_bf16 v[152:155], a[56:59], v[200:203], v[152:155]
    v_add_f32 v162, v162, v46
    v_add_f32 v163, v163, v47
    s_waitcnt vmcnt(8)
    v_mfma_f32_16x16x32_bf16 v[136:139], a[60:63], v[204:207], v[136:139]
    buffer_load_dwordx4 v[200:203], v24, s[20:23], s67 offen offset:0 sc1
    v_mfma_f32_16x16x32_bf16 v[140:143], a[64:67], v[204:207], v[140:143]
    v_add_f32 v164, v164, v48
    v_add_f32 v165, v165, v49
    v_mfma_f32_16x16x32_bf16 v[144:147], a[68:71], v[204:207], v[144:147]
    v_add_f32 v166, v166, v50
    v_add_f32 v167, v167, v51
    v_mfma_f32_16x16x32_bf16 v[148:151], a[72:75], v[204:207], v[148:151]
    v_add_f32 v168, v168, v52
    v_add_f32 v169, v169, v53
    v_mfma_f32_16x16x32_bf16 v[152:155], a[76:79], v[204:207], v[152:155]
    v_add_f32 v170, v170, v54
    v_add_f32 v171, v171, v55
    s_waitcnt vmcnt(8)
    v_mfma_f32_16x16x32_bf16 v[136:139], a[80:83], v[208:211], v[136:139]
    buffer_load_dwordx4 v[204:207], v24, s[20:23], s68 offen offset:1024 sc1
    v_mfma_f32_16x16x32_bf16 v[140:143], a[84:87], v[208:211], v[140:143]
    s_mul_i32 s92, s69, 55296
    s_add_u32 s92, s92, s84
    v_add_f32 v172, v172, v56
    v_mfma_f32_16x16x32_bf16 v[144:147], a[88:91], v[208:211], v[144:147]
    s_cmp_ge_u32 s72, 64
    s_cselect_b32 s64, 2130706432, s92
    v_add_f32 v173, v173, v57
    v_mfma_f32_16x16x32_bf16 v[148:151], a[92:95], v[208:211], v[148:151]
    v_add_f32 v174, v174, v58
    v_add_f32 v175, v175, v59
    v_mfma_f32_16x16x32_bf16 v[152:155], a[96:99], v[208:211], v[152:155]
    s_waitcnt vmcnt(8)
    v_mfma_f32_16x16x32_bf16 v[136:139], a[100:103], v[212:215], v[136:139]
    buffer_load_dwordx4 v[208:211], v24, s[20:23], s64 offen offset:0 sc1
Lpad105:
    s_cbranch_execz Lhret
    v_mfma_f32_16x16x32_bf16 v[140:143], a[104:107], v[212:215], v[140:143]
    s_add_u32 s65, s64, 4096
    s_add_u32 s66, s64, 8192
    v_mfma_f32_16x16x32_bf16 v[144:147], a[108:111], v[212:215], v[144:147]
    s_add_u32 s67, s64, 12288
    s_cmp_ge_u32 s3, 2
    s_cselect_b32 s68, 2130706432, s67
    v_mfma_f32_16x16x32_bf16 v[148:151], a[112:115], v[212:215], v[148:151]
    s_add_u32 s69, s69, 1
    s_and_b32 s69, s69, 3
    v_mfma_f32_16x16x32_bf16 v[152:155], a[116:119], v[212:215], v[152:155]
    ds_write_b128 v33, v[156:159] offset:0
    buffer_load_dwordx2 v[36:37], v38, s[20:23], 0 offen sc1
    s_waitcnt vmcnt(9)
    v_mfma_f32_16x16x32_bf16 v[136:139], a[120:123], v[216:219], v[136:139]
    buffer_load_dwordx4 v[212:215], v24, s[20:23], s64 offen offset:1024 sc1
    v_mfma_f32_16x16x32_bf16 v[140:143], a[124:127], v[216:219], v[140:143]
    ds_write_b128 v33, v[160:163] offset:1024
    v_mfma_f32_16x16x32_bf16 v[144:147], a[128:131], v[216:219], v[144:147]
    v_mfma_f32_16x16x32_bf16 v[148:151], a[132:135], v[216:219], v[148:151]
    v_mfma_f32_16x16x32_bf16 v[152:155], a[136:139], v[216:219], v[152:155]
    s_waitcnt vmcnt(9)
    v_mfma_f32_16x16x32_bf16 v[136:139], a[140:143], v[72:75], v[136:139]
    buffer_load_dwordx4 v[216:219], v24, s[20:23], s64 offen offset:2048 sc1
    v_mfma_f32_16x16x32_bf16 v[140:143], a[144:147], v[72:75], v[140:143]
    ds_write_b128 v33, v[164:167] offset:2048
    v_mfma_f32_16x16x32_bf16 v[144:147], a[148:151], v[72:75], v[144:147]
    v_mfma_f32_16x16x32_bf16 v[148:151], a[152:155], v[72:75], v[148:151]
    v_mfma_f32_16x16x32_bf16 v[152:155], a[156:159], v[72:75], v[152:155]
    s_waitcnt vmcnt(9)
    v_mfma_f32_16x16x32_bf16 v[136:139], a[160:163], v[76:79], v[136:139]
    buffer_load_dwordx4 v[72:75], v24, s[20:23], s64 offen offset:3072 sc1
    v_mfma_f32_16x16x32_bf16 v[140:143], a[164:167], v[76:79], v[140:143]
    ds_write_b128 v33, v[168:171] offset:3072
    v_mfma_f32_16x16x32_bf16 v[144:147], a[168:171], v[76:79], v[144:147]
    v_mfma_f32_16x16x32_bf16 v[148:151], a[172:175], v[76:79], v[148:151]
    v_mfma_f32_16x16x32_bf16 v[152:155], a[176:179], v[76:79], v[152:155]
    s_waitcnt vmcnt(9)
    v_mfma_f32_16x16x32_bf16 v[136:139], a[180:183], v[80:83], v[136:139]
    buffer_load_dwordx4 v[76:79], v24, s[20:23], s65 offen offset:0 sc1
    v_mfma_f32_16x16x32_bf16 v[140:143], a[184:187], v[80:83], v[140:143]
    ds_write_b128 v33, v[172:175] offset:4096
    v_mfma_f32_16x16x32_bf16 v[144:147], a[188:191], v[80:83], v[144:147]
    v_mfma_f32_16x16x32_bf16 v[148:151], a[192:195], v[80:83], v[148:151]
    v_mfma_f32_16x16x32_bf16 v[152:155], a[196:199], v[80:83], v[152:155]
    s_waitcnt vmcnt(9)
    v_mfma_f32_16x16x32_bf16 v[136:139], a[200:203], v[84:87], v[136:139]
    buffer_load_dwordx4 v[80:83], v24, s[20:23], s65 offen offset:1024 sc1
    v_mfma_f32_16x16x32_bf16 v[140:143], a[204:207], v[84:87], v[140:143]
    v_mfma_f32_16x16x32_bf16 v[144:147], a[208:211], v[84:87], v[144:147]
    v_mfma_f32_16x16x32_bf16 v[148:151], a[212:215], v[84:87], v[148:151]
    v_mfma_f32_16x16x32_bf16 v[152:155], a[216:219], v[84:87], v[152:155]
Lpad106:
    s_cbranch_execz Lhret
    s_waitcnt vmcnt(9)
    v_mfma_f32_16x16x32_bf16 v[136:139], a[220:223], v[88:91], v[136:139]
    buffer_load_dwordx4 v[84:87], v24, s[20:23], s65 offen offset:2048 sc1
    v_mfma_f32_16x16x32_bf16 v[140:143], a[224:227], v[88:91], v[140:143]
    s_waitcnt lgkmcnt(0)
    s_barrier
    v_mfma_f32_16x16x32_bf16 v[144:147], a[228:231], v[88:91], v[144:147]
    ds_read_b128 v[40:43], v19 offset:0
    v_mfma_f32_16x16x32_bf16 v[148:151], a[232:235], v[88:91], v[148:151]
    ds_read_b128 v[44:47], v19 offset:1024
    v_mfma_f32_16x16x32_bf16 v[152:155], a[236:239], v[88:91], v[152:155]
    ds_read_b128 v[48:51], v19 offset:2048
    s_waitcnt vmcnt(9)
    v_mfma_f32_16x16x32_bf16 v[136:139], a[240:243], v[200:203], v[136:139]
    buffer_load_dwordx4 v[88:91], v24, s[20:23], s65 offen offset:3072 sc1
    v_mfma_f32_16x16x32_bf16 v[140:143], a[244:247], v[200:203], v[140:143]
    ds_read_b128 v[52:55], v19 offset:3072
    v_mfma_f32_16x16x32_bf16 v[144:147], a[248:251], v[200:203], v[144:147]
    ds_read_b128 v[56:59], v19 offset:4096
    v_mfma_f32_16x16x32_bf16 v[148:151], a[252:255], v[200:203], v[148:151]
    v_mfma_f32_16x16x32_bf16 v[152:155], v[232:235], v[200:203], v[152:155]
    s_waitcnt vmcnt(9)
    v_mfma_f32_16x16x32_bf16 v[136:139], v[236:239], v[204:207], v[136:139]
    buffer_load_dwordx4 v[200:203], v24, s[20:23], s66 offen offset:0 sc1
    v_mfma_f32_16x16x32_bf16 v[140:143], v[240:243], v[204:207], v[140:143]
    s_waitcnt vmcnt(8)
Lpad107:
    s_cbranch_execz Lhret
    v_cmp_ne_u64 vcc, s[56:57], v[36:37]
    v_mfma_f32_16x16x32_bf16 v[144:147], v[244:247], v[204:207], v[144:147]
    s_nop 1
    v_mfma_f32_16x16x32_bf16 v[148:151], v[248:251], v[204:207], v[148:151]
    s_cmp_eq_u64 vcc, 0
    s_cselect_b32 s73, 2, 0
    s_cselect_b32 s94, s90, 2130706432
    s_cselect_b32 s95, 0, 2130706432
    v_mfma_f32_16x16x32_bf16 v[152:155], v[252:255], v[204:207], v[152:155]
    s_waitcnt vmcnt(9)
    v_mfma_f32_16x16x32_bf16 v[156:159], a[0:3], v[208:211], 0
    buffer_load_dwordx4 v[204:207], v24, s[20:23], s66 offen offset:1024 sc1
    v_mfma_f32_16x16x32_bf16 v[160:163], a[4:7], v[208:211], 0
    buffer_load_dwordx4 v[184:187], v9, s[20:23], s94 offen sc1
    v_mfma_f32_16x16x32_bf16 v[164:167], a[8:11], v[208:211], 0
    v_mfma_f32_16x16x32_bf16 v[168:171], a[12:15], v[208:211], 0
    v_mfma_f32_16x16x32_bf16 v[172:175], a[16:19], v[208:211], 0
    s_waitcnt vmcnt(9)
    v_mfma_f32_16x16x32_bf16 v[156:159], a[20:23], v[212:215], v[156:159]
    buffer_load_dwordx4 v[208:211], v24, s[20:23], s66 offen offset:2048 sc1
    v_mfma_f32_16x16x32_bf16 v[160:163], a[24:27], v[212:215], v[160:163]
    s_add_u32 s97, s94, 32768
    buffer_load_dwordx4 v[188:191], v9, s[20:23], s97 offen sc1
    v_mfma_f32_16x16x32_bf16 v[164:167], a[28:31], v[212:215], v[164:167]
    v_mfma_f32_16x16x32_bf16 v[168:171], a[32:35], v[212:215], v[168:171]
    v_mfma_f32_16x16x32_bf16 v[172:175], a[36:39], v[212:215], v[172:175]
    s_waitcnt vmcnt(10)
    v_mfma_f32_16x16x32_bf16 v[156:159], a[40:43], v[216:219], v[156:159]
    buffer_load_dwordx4 v[212:215], v24, s[20:23], s66 offen offset:3072 sc1
    v_mfma_f32_16x16x32_bf16 v[160:163], a[44:47], v[216:219], v[160:163]
    buffer_load_dwordx4 v[192:195], v23, s[20:23], s94 offen sc1
    v_mfma_f32_16x16x32_bf16 v[164:167], a[48:51], v[216:219], v[164:167]
    s_waitcnt lgkmcnt(0)
    v_add_f32 v136, v136, v40
    v_add_f32 v137, v137, v41
    v_mfma_f32_16x16x32_bf16 v[168:171], a[52:55], v[216:219], v[168:171]
    v_add_f32 v138, v138, v42
    v_add_f32 v139, v139, v43
    v_mfma_f32_16x16x32_bf16 v[172:175], a[56:59], v[216:219], v[172:175]
    v_add_f32 v140, v140, v44
    v_add_f32 v141, v141, v45
    s_waitcnt vmcnt(11)
    v_mfma_f32_16x16x32_bf16 v[156:159], a[60:63], v[72:75], v[156:159]
    buffer_load_dwordx4 v[216:219], v24, s[20:23], s67 offen offset:0 sc1
    v_mfma_f32_16x16x32_bf16 v[160:163], a[64:67], v[72:75], v[160:163]
    buffer_load_dword v180, v18, s[20:23], s95 offen sc1
    v_mfma_f32_16x16x32_bf16 v[164:167], a[68:71], v[72:75], v[164:167]
    v_add_f32 v142, v142, v46
    v_add_f32 v143, v143, v47
    v_mfma_f32_16x16x32_bf16 v[168:171], a[72:75], v[72:75], v[168:171]
    v_add_f32 v144, v144, v48
    v_add_f32 v145, v145, v49
    v_mfma_f32_16x16x32_bf16 v[172:175], a[76:79], v[72:75], v[172:175]
    v_add_f32 v146, v146, v50
    v_add_f32 v147, v147, v51
    s_waitcnt vmcnt(12)
    v_mfma_f32_16x16x32_bf16 v[156:159], a[80:83], v[76:79], v[156:159]
    buffer_load_dwordx4 v[72:75], v24, s[20:23], s68 offen offset:1024 sc1
    v_mfma_f32_16x16x32_bf16 v[160:163], a[84:87], v[76:79], v[160:163]
Lpad108:
    s_cbranch_execz Lhret
    v_add_f32 v148, v148, v52
    v_add_f32 v149, v149, v53
    v_mfma_f32_16x16x32_bf16 v[164:167], a[88:91], v[76:79], v[164:167]
    v_add_f32 v150, v150, v54
    v_add_f32 v151, v151, v55
    v_mfma_f32_16x16x32_bf16 v[168:171], a[92:95], v[76:79], v[168:171]
    v_add_f32 v152, v152, v56
    v_add_f32 v153, v153, v57
    v_mfma_f32_16x16x32_bf16 v[172:175], a[96:99], v[76:79], v[172:175]
    v_add_f32 v154, v154, v58
    v_add_f32 v155, v155, v59
    s_waitcnt vmcnt(12)
    v_mfma_f32_16x16x32_bf16 v[156:159], a[100:103], v[80:83], v[156:159]
    ds_write_b128 v33, v[136:139] offset:20480
    v_mfma_f32_16x16x32_bf16 v[160:163], a[104:107], v[80:83], v[160:163]
    v_mfma_f32_16x16x32_bf16 v[164:167], a[108:111], v[80:83], v[164:167]
    v_mfma_f32_16x16x32_bf16 v[168:171], a[112:115], v[80:83], v[168:171]
    v_mfma_f32_16x16x32_bf16 v[172:175], a[116:119], v[80:83], v[172:175]
    s_waitcnt vmcnt(11)
    v_mfma_f32_16x16x32_bf16 v[156:159], a[120:123], v[84:87], v[156:159]
    ds_write_b128 v33, v[140:143] offset:21504
    v_mfma_f32_16x16x32_bf16 v[160:163], a[124:127], v[84:87], v[160:163]
    v_mfma_f32_16x16x32_bf16 v[164:167], a[128:131], v[84:87], v[164:167]
    v_mfma_f32_16x16x32_bf16 v[168:171], a[132:135], v[84:87], v[168:171]
    v_mfma_f32_16x16x32_bf16 v[172:175], a[136:139], v[84:87], v[172:175]
    s_waitcnt vmcnt(10)
    v_mfma_f32_16x16x32_bf16 v[156:159], a[140:143], v[88:91], v[156:159]
    ds_write_b128 v33, v[144:147] offset:22528
    v_mfma_f32_16x16x32_bf16 v[160:163], a[144:147], v[88:91], v[160:163]
    buffer_load_dwordx2 v[36:37], v38, s[20:23], 0 offen sc1
    v_mfma_f32_16x16x32_bf16 v[164:167], a[148:151], v[88:91], v[164:167]
    v_mfma_f32_16x16x32_bf16 v[168:171], a[152:155], v[88:91], v[168:171]
    v_mfma_f32_16x16x32_bf16 v[172:175], a[156:159], v[88:91], v[172:175]
    s_waitcnt vmcnt(10)
    v_mfma_f32_16x16x32_bf16 v[156:159], a[160:163], v[200:203], v[156:159]
    ds_write_b128 v33, v[148:151] offset:23552
    v_mfma_f32_16x16x32_bf16 v[160:163], a[164:167], v[200:203], v[160:163]
    v_mfma_f32_16x16x32_bf16 v[164:167], a[168:171], v[200:203], v[164:167]
    v_mfma_f32_16x16x32_bf16 v[168:171], a[172:175], v[200:203], v[168:171]
    v_mfma_f32_16x16x32_bf16 v[172:175], a[176:179], v[200:203], v[172:175]
    s_waitcnt vmcnt(9)
    v_mfma_f32_16x16x32_bf16 v[156:159], a[180:183], v[204:207], v[156:159]
    ds_write_b128 v33, v[152:155] offset:24576
    v_mfma_f32_16x16x32_bf16 v[160:163], a[184:187], v[204:207], v[160:163]
    v_mfma_f32_16x16x32_bf16 v[164:167], a[188:191], v[204:207], v[164:167]
    v_mfma_f32_16x16x32_bf16 v[168:171], a[192:195], v[204:207], v[168:171]
    v_mfma_f32_16x16x32_bf16 v[172:175], a[196:199], v[204:207], v[172:175]
    s_waitcnt vmcnt(7)
    v_mfma_f32_16x16x32_bf16 v[156:159], a[200:203], v[208:211], v[156:159]
    v_mfma_f32_16x16x32_bf16 v[160:163], a[204:207], v[208:211], v[160:163]
    v_mfma_f32_16x16x32_bf16 v[164:167], a[208:211], v[208:211], v[164:167]
    v_mfma_f32_16x16x32_bf16 v[168:171], a[212:215], v[208:211], v[168:171]
    v_mfma_f32_16x16x32_bf16 v[172:175], a[216:219], v[208:211], v[172:175]
    s_waitcnt vmcnt(5)
    v_mfma_f32_16x16x32_bf16 v[156:159], a[220:223], v[212:215], v[156:159]
Lpad109:
    s_cbranch_execz Lhret
    s_waitcnt lgkmcnt(0)
    s_barrier
    v_mfma_f32_16x16x32_bf16 v[160:163], a[224:227], v[212:215], v[160:163]
    ds_read_b128 v[40:43], v19 offset:20480
    v_mfma_f32_16x16x32_bf16 v[164:167], a[228:231], v[212:215], v[164:167]
    ds_read_b128 v[44:47], v19 offset:21504
    v_mfma_f32_16x16x32_bf16 v[168:171], a[232:235], v[212:215], v[168:171]
    ds_read_b128 v[48:51], v19 offset:22528
    v_mfma_f32_16x16x32_bf16 v[172:175], a[236:239], v[212:215], v[172:175]
    ds_read_b128 v[52:55], v19 offset:23552
    s_waitcnt vmcnt(3)
    v_mfma_f32_16x16x32_bf16 v[156:159], a[240:243], v[216:219], v[156:159]
    ds_read_b128 v[56:59], v19 offset:24576
    v_mfma_f32_16x16x32_bf16 v[160:163], a[244:247], v[216:219], v[160:163]
    v_mfma_f32_16x16x32_bf16 v[164:167], a[248:251], v[216:219], v[164:167]
    v_mfma_f32_16x16x32_bf16 v[168:171], a[252:255], v[216:219], v[168:171]
    v_mfma_f32_16x16x32_bf16 v[172:175], v[232:235], v[216:219], v[172:175]
    s_waitcnt vmcnt(1)
    v_mfma_f32_16x16x32_bf16 v[156:159], v[236:239], v[72:75], v[156:159]
    v_mfma_f32_16x16x32_bf16 v[160:163], v[240:243], v[72:75], v[160:163]
    v_mfma_f32_16x16x32_bf16 v[164:167], v[244:247], v[72:75], v[164:167]
    v_mfma_f32_16x16x32_bf16 v[168:171], v[248:251], v[72:75], v[168:171]
    v_mfma_f32_16x16x32_bf16 v[172:175], v[252:255], v[72:75], v[172:175]
    s_cmp_eq_u32 s73, 2
    s_cbranch_scc1 Lyk37
    s_mov_b32 s96, 0
    s_waitcnt vmcnt(0)
Lpp38:
    v_cmp_ne_u64 vcc, s[56:57], v[36:37]
    s_nop 3
    s_cmp_eq_u64 vcc, 0
    s_cbranch_scc1 Lpd39
    s_sleep 1
    buffer_load_dwordx2 v[36:37], v38, s[20:23], 0 offen sc1
    s_waitcnt vmcnt(0)
    s_add_u32 s96, s96, 1
    s_cmp_lt_u32 s96, 0x8000
    s_cbranch_scc1 Lpp38
Lpd39:
    buffer_load_dwordx4 v[184:187], v9, s[20:23], s90 offen sc1
    s_add_u32 s97, s90, 32768
    buffer_load_dwordx4 v[188:191], v9, s[20:23], s97 offen sc1
    buffer_load_dwordx4 v[192:195], v23, s[20:23], s90 offen sc1
    buffer_load_dword v180, v18, s[20:23], 0 offen sc1
Lyk37:
    s_waitcnt vmcnt(0)
    ds_write_b128 v13, v[184:187]
    ds_write_b128 v13, v[188:191] offset:1152
    s_mov_b32 exec_hi, 0
    ds_write_b128 v13, v[192:195] offset:2304
    s_mov_b32 exec_hi, -1
    s_waitcnt lgkmcnt(3)
    s_nop 0
    v_pk_add_f32 v[156:157], v[156:157], v[40:41]
    v_pk_add_f32 v[158:159], v[158:159], v[42:43]
    v_pk_add_f32 v[160:161], v[160:161], v[44:45]
    v_pk_add_f32 v[162:163], v[162:163], v[46:47]
    v_pk_add_f32 v[164:165], v[164:165], v[48:49]
    v_pk_add_f32 v[166:167], v[166:167], v[50:51]
    v_pk_add_f32 v[168:169], v[168:169], v[52:53]
    v_pk_add_f32 v[170:171], v[170:171], v[54:55]
Lpad110:
    s_cbranch_execz Lhret
    v_pk_add_f32 v[172:173], v[172:173], v[56:57]
    v_pk_add_f32 v[174:175], v[174:175], v[58:59]
    s_waitcnt lgkmcnt(0)
    s_barrier
    ds_read_b64_tr_b16 v[200:201], v22 offset:0
    ds_read_b64_tr_b16 v[202:203], v22 offset:2304
    ds_read_b64_tr_b16 v[204:205], v22 offset:4608
    ds_read_b64_tr_b16 v[206:207], v22 offset:6912
    ds_read_b64_tr_b16 v[208:209], v22 offset:9216
    s_waitcnt lgkmcnt(4)
    v_lshlrev_b32 v40, 16, v200
    v_and_b32 v41, 0xffff0000, v200
    v_lshlrev_b32 v42, 16, v201
    v_and_b32 v43, 0xffff0000, v201
    v_pk_fma_f32 v[40:41], v[96:97], v[40:41], v[156:157] neg_lo:[0,0,1] neg_hi:[0,0,1]
    v_pk_fma_f32 v[42:43], v[98:99], v[42:43], v[158:159] neg_lo:[0,0,1] neg_hi:[0,0,1]
    v_pk_fma_f32 v[156:157], v[180:181], v[40:41], v[156:157] op_sel_hi:[0,1,1]
    v_pk_fma_f32 v[158:159], v[180:181], v[42:43], v[158:159] op_sel_hi:[0,1,1]
    v_cvt_pk_bf16_f32 v40, v156, v157
    v_cvt_pk_bf16_f32 v41, v158, v159
    ds_write_b64 v21, v[40:41] offset:0
    s_waitcnt lgkmcnt(4)
    v_lshlrev_b32 v44, 16, v202
    v_and_b32 v45, 0xffff0000, v202
    v_lshlrev_b32 v46, 16, v203
    v_and_b32 v47, 0xffff0000, v203
    v_pk_fma_f32 v[44:45], v[100:101], v[44:45], v[160:161] neg_lo:[0,0,1] neg_hi:[0,0,1]
    v_pk_fma_f32 v[46:47], v[102:103], v[46:47], v[162:163] neg_lo:[0,0,1] neg_hi:[0,0,1]
    v_pk_fma_f32 v[160:161], v[180:181], v[44:45], v[160:161] op_sel_hi:[0,1,1]
    v_pk_fma_f32 v[162:163], v[180:181], v[46:47], v[162:163] op_sel_hi:[0,1,1]
    v_cvt_pk_bf16_f32 v44, v160, v161
    v_cvt_pk_bf16_f32 v45, v162, v163
    ds_write_b64 v21, v[44:45] offset:32
    s_waitcnt lgkmcnt(4)
    v_lshlrev_b32 v48, 16, v204
    v_and_b32 v49, 0xffff0000, v204
    v_lshlrev_b32 v50, 16, v205
    v_and_b32 v51, 0xffff0000, v205
    v_pk_fma_f32 v[48:49], v[104:105], v[48:49], v[164:165] neg_lo:[0,0,1] neg_hi:[0,0,1]
    v_pk_fma_f32 v[50:51], v[106:107], v[50:51], v[166:167] neg_lo:[0,0,1] neg_hi:[0,0,1]
    v_pk_fma_f32 v[164:165], v[180:181], v[48:49], v[164:165] op_sel_hi:[0,1,1]
    v_pk_fma_f32 v[166:167], v[180:181], v[50:51], v[166:167] op_sel_hi:[0,1,1]
    v_cvt_pk_bf16_f32 v48, v164, v165
    v_cvt_pk_bf16_f32 v49, v166, v167
    ds_write_b64 v21, v[48:49] offset:64
    s_waitcnt lgkmcnt(4)
    v_lshlrev_b32 v52, 16, v206
    v_and_b32 v53, 0xffff0000, v206
    v_lshlrev_b32 v54, 16, v207
    v_and_b32 v55, 0xffff0000, v207
    v_pk_fma_f32 v[52:53], v[108:109], v[52:53], v[168:169] neg_lo:[0,0,1] neg_hi:[0,0,1]
    v_pk_fma_f32 v[54:55], v[110:111], v[54:55], v[170:171] neg_lo:[0,0,1] neg_hi:[0,0,1]
    v_pk_fma_f32 v[168:169], v[180:181], v[52:53], v[168:169] op_sel_hi:[0,1,1]
    v_pk_fma_f32 v[170:171], v[180:181], v[54:55], v[170:171] op_sel_hi:[0,1,1]
    v_cvt_pk_bf16_f32 v52, v168, v169
Lpad111:
    s_cbranch_execz Lhret
    v_cvt_pk_bf16_f32 v53, v170, v171
    ds_write_b64 v21, v[52:53] offset:96
    s_waitcnt lgkmcnt(4)
    v_lshlrev_b32 v56, 16, v208
    v_and_b32 v57, 0xffff0000, v208
    v_lshlrev_b32 v58, 16, v209
    v_and_b32 v59, 0xffff0000, v209
    v_pk_fma_f32 v[56:57], v[112:113], v[56:57], v[172:173] neg_lo:[0,0,1] neg_hi:[0,0,1]
    v_pk_fma_f32 v[58:59], v[114:115], v[58:59], v[174:175] neg_lo:[0,0,1] neg_hi:[0,0,1]
    v_pk_fma_f32 v[172:173], v[180:181], v[56:57], v[172:173] op_sel_hi:[0,1,1]
    v_pk_fma_f32 v[174:175], v[180:181], v[58:59], v[174:175] op_sel_hi:[0,1,1]
    v_cvt_pk_bf16_f32 v56, v172, v173
    v_cvt_pk_bf16_f32 v57, v174, v175
    ds_write_b64 v21, v[56:57] offset:128
    ds_read_b128 v[232:235], v20 offset:0
    ds_read_b128 v[236:239], v20 offset:1056
    ds_read_b128 v[240:243], v20 offset:2112
    s_waitcnt lgkmcnt(2)
    buffer_store_dwordx4 v[232:235], v17, s[36:39], 0 offen sc1
    s_waitcnt lgkmcnt(1)
    buffer_store_dwordx4 v[236:239], v17, s[36:39], s74 offen sc1
    s_waitcnt lgkmcnt(0)
    buffer_store_dwordx4 v[240:243], v15, s[36:39], s75 offen sc1
Lend:
    s_endpgm
Lns4:
    s_mov_b32 s96, 0
Lnp6:
    v_readfirstlane_b32 s56, v2
    v_readfirstlane_b32 s57, v3
    s_nop 3
    s_cmp_lg_u32 s56, 0
    s_cbranch_scc1 Lnd7
    s_sleep 2
    buffer_load_dwordx2 v[2:3], v16, s[48:51], 0 offen sc1
    s_waitcnt vmcnt(0)
    s_add_u32 s96, s96, 1
    s_cmp_lt_u32 s96, 0x8000
    s_cbranch_scc1 Lnp6
Lnd7:
    s_branch Lnb5
Lks8:
    s_mov_b32 s96, 0
Lks8x:
    s_sleep 1
    buffer_load_dwordx2 v[36:37], v35, s[20:23], 0 offen sc1
    s_waitcnt vmcnt(0)
    v_cmp_ne_u64 vcc, s[56:57], v[36:37]
    s_nop 3
    s_cmp_eq_u32 vcc_hi, 0
    s_cbranch_scc1 Lkb9
    s_add_u32 s96, s96, 1
    s_cmp_lt_u32 s96, 0x8000
    s_cbranch_scc1 Lks8x
    s_branch Lkb9
Lws17:
    s_cmp_eq_u32 s79, s80
    s_cbranch_scc1 Lwp18
    buffer_load_dwordx2 v[36:37], v35, s[20:23], 0 offen sc1
    s_mov_b32 s96, 0
    s_waitcnt vmcnt(0)
Lpp20:
    v_cmp_ne_u64 vcc, s[56:57], v[36:37]
    s_nop 3
    s_cmp_eq_u64 vcc, 0
    s_cbranch_scc1 Lpd21
    s_sleep 1
    buffer_load_dwordx2 v[36:37], v35, s[20:23], 0 offen sc1
    s_waitcnt vmcnt(0)
    s_add_u32 s96, s96, 1
    s_cmp_lt_u32 s96, 0x8000
    s_cbranch_scc1 Lpp20
Lpd21:
    s_mov_b32 s79, s80
    s_add_u32 s70, s79, 8192
    buffer_load_dwordx4 a[36:39], v24, s[20:23], s70 offen offset:1024 sc1
    buffer_load_dwordx4 a[40:43], v24, s[20:23], s70 offen offset:2048 sc1
Lpad112:
    s_cbranch_execz Lhret
    buffer_load_dwordx4 a[44:47], v24, s[20:23], s70 offen offset:3072 sc1
    s_add_u32 s70, s79, 12288
    buffer_load_dwordx4 a[48:51], v24, s[20:23], s70 offen offset:0 sc1
    buffer_load_dwordx4 a[52:55], v24, s[20:23], s70 offen offset:1024 sc1
    buffer_load_dwordx4 a[56:59], v24, s[20:23], s70 offen offset:2048 sc1
    buffer_load_dwordx4 a[60:63], v24, s[20:23], s70 offen offset:3072 sc1
    s_add_u32 s70, s79, 16384
    buffer_load_dwordx4 a[64:67], v24, s[20:23], s70 offen offset:0 sc1
    buffer_load_dwordx4 a[68:71], v24, s[20:23], s70 offen offset:1024 sc1
    buffer_load_dwordx4 a[72:75], v24, s[20:23], s70 offen offset:2048 sc1
    buffer_load_dwordx4 a[76:79], v24, s[20:23], s70 offen offset:3072 sc1
    s_add_u32 s70, s79, 20480
    buffer_load_dwordx4 a[80:83], v24, s[20:23], s70 offen offset:0 sc1
    buffer_load_dwordx4 a[84:87], v24, s[20:23], s70 offen offset:1024 sc1
    buffer_load_dwordx4 a[88:91], v24, s[20:23], s70 offen offset:2048 sc1
    buffer_load_dwordx4 a[92:95], v24, s[20:23], s70 offen offset:3072 sc1
    s_add_u32 s70, s79, 24576
    buffer_load_dwordx4 a[96:99], v24, s[20:23], s70 offen offset:0 sc1
    buffer_load_dwordx4 a[100:103], v24, s[20:23], s70 offen offset:1024 sc1
    buffer_load_dwordx4 a[104:107], v24, s[20:23], s70 offen offset:2048 sc1
    buffer_load_dwordx4 a[108:111], v24, s[20:23], s70 offen offset:3072 sc1
    s_add_u32 s70, s79, 28672
    buffer_load_dwordx4 a[112:115], v24, s[20:23], s70 offen offset:0 sc1
    buffer_load_dwordx4 a[116:119], v24, s[20:23], s70 offen offset:1024 sc1
    buffer_load_dwordx4 a[120:123], v24, s[20:23], s70 offen offset:2048 sc1
    buffer_load_dwordx4 a[124:127], v24, s[20:23], s70 offen offset:3072 sc1
    s_add_u32 s70, s79, 32768
    buffer_load_dwordx4 a[128:131], v24, s[20:23], s70 offen offset:0 sc1
Lwp18:
    s_add_u32 s70, s79, 0
    buffer_load_dwordx4 a[0:3], v24, s[20:23], s70 offen offset:0 sc1
    buffer_load_dwordx4 a[4:7], v24, s[20:23], s70 offen offset:1024 sc1
    buffer_load_dwordx4 a[8:11], v24, s[20:23], s70 offen offset:2048 sc1
    buffer_load_dwordx4 a[12:15], v24, s[20:23], s70 offen offset:3072 sc1
    s_add_u32 s70, s79, 4096
    buffer_load_dwordx4 a[16:19], v24, s[20:23], s70 offen offset:0 sc1
    buffer_load_dwordx4 a[20:23], v24, s[20:23], s70 offen offset:1024 sc1
    buffer_load_dwordx4 a[24:27], v24, s[20:23], s70 offen offset:2048 sc1
    buffer_load_dwordx4 a[28:31], v24, s[20:23], s70 offen offset:3072 sc1
    s_add_u32 s70, s79, 8192
    buffer_load_dwordx4 a[32:35], v24, s[20:23], s70 offen offset:0 sc1
    s_branch Lwb19
Lh2nd:
    s_waitcnt vmcnt(1)
    v_cmp_ne_u64 vcc, s[56:57], v[36:37]
    s_nop 3
    s_cmp_eq_u64 vcc, 0
    s_cbranch_scc0 Lh2ndb
    s_mov_b32 s69, s3
    s_mov_b32 s72, 0
    s_mul_i32 s92, s69, 55296
    s_add_u32 s92, s92, s84
    s_cmp_ge_u32 s72, 64
    s_cselect_b32 s64, 2130706432, s92
    s_add_u32 s65, s64, 4096
Lpad113:
    s_cbranch_execz Lhret
    s_add_u32 s66, s64, 8192
    s_add_u32 s67, s64, 12288
    s_cmp_ge_u32 s3, 2
    s_cselect_b32 s68, 2130706432, s67
    s_add_u32 s69, s69, 1
    s_and_b32 s69, s69, 3
    buffer_load_dwordx4 v[200:203], v24, s[20:23], s64 offen offset:0 sc1
    buffer_load_dwordx4 v[204:207], v24, s[20:23], s64 offen offset:1024 sc1
    buffer_load_dwordx4 v[208:211], v24, s[20:23], s64 offen offset:2048 sc1
    buffer_load_dwordx4 v[212:215], v24, s[20:23], s64 offen offset:3072 sc1
    buffer_load_dwordx4 v[216:219], v24, s[20:23], s65 offen offset:0 sc1
    buffer_load_dwordx4 v[72:75], v24, s[20:23], s65 offen offset:1024 sc1
    buffer_load_dwordx4 v[76:79], v24, s[20:23], s65 offen offset:2048 sc1
    buffer_load_dwordx4 v[80:83], v24, s[20:23], s65 offen offset:3072 sc1
    buffer_load_dwordx4 v[84:87], v24, s[20:23], s66 offen offset:0 sc1
    buffer_load_dwordx4 v[88:91], v24, s[20:23], s66 offen offset:1024 sc1
    s_branch Lh2ndb
Lns25:
    s_mov_b32 s96, 0
Lnp27:
    v_readfirstlane_b32 s56, v2
    v_readfirstlane_b32 s57, v3
    s_nop 3
    s_cmp_lg_u32 s56, 0
    s_cbranch_scc1 Lnd28
    s_sleep 2
    buffer_load_dwordx2 v[2:3], v16, s[48:51], 0 offen sc1
    s_waitcnt vmcnt(0)
    s_add_u32 s96, s96, 1
    s_cmp_lt_u32 s96, 0x8000
    s_cbranch_scc1 Lnp27
Lnd28:
    s_branch Lnb26
Lws29:
    s_cmp_eq_u32 s79, s80
    s_cbranch_scc1 Lwp30
    buffer_load_dwordx2 v[36:37], v35, s[20:23], 0 offen sc1
    s_mov_b32 s96, 0
    s_waitcnt vmcnt(0)
Lpp32:
    v_cmp_ne_u64 vcc, s[56:57], v[36:37]
    s_nop 3
    s_cmp_eq_u64 vcc, 0
    s_cbranch_scc1 Lpd33
    s_sleep 1
    buffer_load_dwordx2 v[36:37], v35, s[20:23], 0 offen sc1
    s_waitcnt vmcnt(0)
    s_add_u32 s96, s96, 1
    s_cmp_lt_u32 s96, 0x8000
    s_cbranch_scc1 Lpp32
Lpd33:
    s_mov_b32 s79, s80
    s_add_u32 s70, s79, 16384
    buffer_load_dwordx4 a[72:75], v24, s[20:23], s70 offen offset:2048 sc1
    buffer_load_dwordx4 a[76:79], v24, s[20:23], s70 offen offset:3072 sc1
    s_add_u32 s70, s79, 20480
    buffer_load_dwordx4 a[80:83], v24, s[20:23], s70 offen offset:0 sc1
    buffer_load_dwordx4 a[84:87], v24, s[20:23], s70 offen offset:1024 sc1
    buffer_load_dwordx4 a[88:91], v24, s[20:23], s70 offen offset:2048 sc1
    buffer_load_dwordx4 a[92:95], v24, s[20:23], s70 offen offset:3072 sc1
    s_add_u32 s70, s79, 24576
    buffer_load_dwordx4 a[96:99], v24, s[20:23], s70 offen offset:0 sc1
    buffer_load_dwordx4 a[100:103], v24, s[20:23], s70 offen offset:1024 sc1
    buffer_load_dwordx4 a[104:107], v24, s[20:23], s70 offen offset:2048 sc1
    buffer_load_dwordx4 a[108:111], v24, s[20:23], s70 offen offset:3072 sc1
    s_add_u32 s70, s79, 28672
    buffer_load_dwordx4 a[112:115], v24, s[20:23], s70 offen offset:0 sc1
    buffer_load_dwordx4 a[116:119], v24, s[20:23], s70 offen offset:1024 sc1
Lpad114:
    s_cbranch_execz Lhret
    buffer_load_dwordx4 a[120:123], v24, s[20:23], s70 offen offset:2048 sc1
    buffer_load_dwordx4 a[124:127], v24, s[20:23], s70 offen offset:3072 sc1
    s_add_u32 s70, s79, 32768
    buffer_load_dwordx4 a[128:131], v24, s[20:23], s70 offen offset:0 sc1
    buffer_load_dwordx4 a[132:135], v24, s[20:23], s70 offen offset:1024 sc1
    buffer_load_dwordx4 a[136:139], v24, s[20:23], s70 offen offset:2048 sc1
    buffer_load_dwordx4 a[140:143], v24, s[20:23], s70 offen offset:3072 sc1
    s_add_u32 s70, s79, 36864
    buffer_load_dwordx4 a[144:147], v24, s[20:23], s70 offen offset:0 sc1
    buffer_load_dwordx4 a[148:151], v24, s[20:23], s70 offen offset:1024 sc1
    buffer_load_dwordx4 a[152:155], v24, s[20:23], s70 offen offset:2048 sc1
Lwp30:
    s_add_u32 s70, s79, 0
    buffer_load_dwordx4 a[0:3], v24, s[20:23], s70 offen offset:0 sc1
    buffer_load_dwordx4 a[4:7], v24, s[20:23], s70 offen offset:1024 sc1
    buffer_load_dwordx4 a[8:11], v24, s[20:23], s70 offen offset:2048 sc1
    buffer_load_dwordx4 a[12:15], v24, s[20:23], s70 offen offset:3072 sc1
    s_add_u32 s70, s79, 4096
    buffer_load_dwordx4 a[16:19], v24, s[20:23], s70 offen offset:0 sc1
    buffer_load_dwordx4 a[20:23], v24, s[20:23], s70 offen offset:1024 sc1
    buffer_load_dwordx4 a[24:27], v24, s[20:23], s70 offen offset:2048 sc1
    buffer_load_dwordx4 a[28:31], v24, s[20:23], s70 offen offset:3072 sc1
    s_add_u32 s70, s79, 8192
    buffer_load_dwordx4 a[32:35], v24, s[20:23], s70 offen offset:0 sc1
    buffer_load_dwordx4 a[36:39], v24, s[20:23], s70 offen offset:1024 sc1
    buffer_load_dwordx4 a[40:43], v24, s[20:23], s70 offen offset:2048 sc1
    buffer_load_dwordx4 a[44:47], v24, s[20:23], s70 offen offset:3072 sc1
    s_add_u32 s70, s79, 12288
    buffer_load_dwordx4 a[48:51], v24, s[20:23], s70 offen offset:0 sc1
    buffer_load_dwordx4 a[52:55], v24, s[20:23], s70 offen offset:1024 sc1
    buffer_load_dwordx4 a[56:59], v24, s[20:23], s70 offen offset:2048 sc1
    buffer_load_dwordx4 a[60:63], v24, s[20:23], s70 offen offset:3072 sc1
    s_add_u32 s70, s79, 16384
    buffer_load_dwordx4 a[64:67], v24, s[20:23], s70 offen offset:0 sc1
    buffer_load_dwordx4 a[68:71], v24, s[20:23], s70 offen offset:1024 sc1
    s_branch Lwb31
.section .rodata,"a"
.p2align 6
.amdhsa_kernel gated_mix__ssm_conv_h3__glu_gated_swiglu__prompt_kernel
  .amdhsa_next_free_vgpr 512
  .amdhsa_next_free_sgpr 102
  .amdhsa_accum_offset 256
  .amdhsa_group_segment_fixed_size 0
  .amdhsa_kernarg_size 112
  .amdhsa_user_sgpr_count 2
  .amdhsa_user_sgpr_kernarg_segment_ptr 1
  .amdhsa_system_sgpr_workgroup_id_x 1
.end_amdhsa_kernel
```
